```python
import torch

def _softmax(x, axis=-1):
    return torch.softmax(x, dim=axis)
def _gelu(x):
    return torch.nn.functional.gelu(x, approximate="tanh")
def _silu(x):
    return torch.nn.functional.silu(x)
def _sigmoid(x):
    return torch.sigmoid(x)
def _layernorm(x, axis=-1, eps=1e-5):
    m = x.mean(dim=axis, keepdim=True)
    v = x.var(dim=axis, keepdim=True, unbiased=False)
    return (x - m) / torch.sqrt(v + eps)
def _scatter_add(tgt, idx, src, axis=0):
    return tgt.clone().index_add_(axis, idx, src)
def _segment_sum(src, seg, n):
    out = torch.zeros((n,) + src.shape[1:], dtype=src.dtype)
    return out.index_add_(0, seg, src)
def _pad(x, pw):
    flat = tuple(v for pair in reversed(pw) for v in pair)
    return torch.nn.functional.pad(x, flat)

kernel_name = 'parallel_sum__sliding_block__glu_gated_bilinear__prompt'

def setup_inputs():

    _w = (lambda a: (lambda t: t.to(torch.bfloat16) if t.is_floating_point() else t)(torch.as_tensor(a)))
    def _A_setup():
        B, S, D = 1, 2048, 448
        return {
            "x": _w((lambda *s: torch.randn(*s, dtype=torch.bfloat16) * 0.05)(B, S, D)),
            "wqkv": _w((lambda *s: torch.randn(*s, dtype=torch.bfloat16) * 0.05)(D, 3 * D)),
            "wo": _w((lambda *s: torch.randn(*s, dtype=torch.bfloat16) * 0.05)(D, D)),
        }
    _A_in = _A_setup()

    def _B_setup():
        B, S, D, F = 1, 2048, 448, 1792
        return {
            "x": _w((lambda *s: torch.randn(*s, dtype=torch.bfloat16) * 0.05)(B, S, D)),
            "w_gate": _w((lambda *s: torch.randn(*s, dtype=torch.bfloat16) * 0.8)(D, F) * (D ** -0.5)),
            "w_up": _w((lambda *s: torch.randn(*s, dtype=torch.bfloat16) * 0.8)(D, F) * (D ** -0.5)),
            "w_down": _w((lambda *s: torch.randn(*s, dtype=torch.bfloat16) * 0.8)(F, D) * (F ** -0.5)),
        }
    _B_in = _B_setup()

    return {
        "A_x": _A_in["x"],
        "A_wqkv": _A_in["wqkv"],
        "A_wo": _A_in["wo"],
        "B_x": _B_in["x"],
        "B_w_gate": _B_in["w_gate"],
        "B_w_up": _B_in["w_up"],
        "B_w_down": _B_in["w_down"],
    }

def reference(A_x, A_wqkv, A_wo, B_x, B_w_gate, B_w_up, B_w_down):
    def _A_ref(x, wqkv, wo):
        B, S, D = x.shape
        H = 16; Dh = D // H; W = 256
        qkv = (lambda x, *d: x.permute(*d))((x @ wqkv).reshape(B, S, 3, H, Dh), 2, 0, 3, 1, 4)
        q, k, v = qkv[0], qkv[1], qkv[2]
        scores = torch.einsum("bhqd,bhkd->bhqk", q, k) * (Dh ** -0.5)
        idx = torch.arange(S)
        mask = (idx[:, None] - idx[None, :] >= 0) & (idx[:, None] - idx[None, :] < W)
        scores = torch.where(mask[None, None], scores, -1e9)
        p = _softmax(scores, axis=-1)
        o = torch.einsum("bhqk,bhkd->bhqd", p, v)
        return (lambda x, *d: x.permute(*d))(o, 0, 2, 1, 3).reshape(B, S, D) @ wo

    def _B_ref(x, w_gate, w_up, w_down):
        g = torch.einsum("bsd,df->bsf", x, w_gate)
        u = torch.einsum("bsd,df->bsf", x, w_up)
        h = g * u
        return torch.einsum("bsf,fd->bsd", h, w_down)

    x = A_x
    xn = _layernorm(x, axis=-1)
    return x + _A_ref(xn, A_wqkv, A_wo) + _B_ref(xn, B_w_gate, B_w_up, B_w_down)
```

```asm
; @launch grid=(256,1,1) block=(256,1,1) lds=163840
.amdgcn_target "amdgcn-amd-amdhsa--gfx950"
    .text
    .globl parallel_sum__sliding_block__glu_gated_bilinear__prompt_kernel
    .p2align 8
    .type parallel_sum__sliding_block__glu_gated_bilinear__prompt_kernel,@function
parallel_sum__sliding_block__glu_gated_bilinear__prompt_kernel:
    s_load_dwordx2 s[4:5], s[0:1], 0
    s_load_dwordx16 s[60:75], s[0:1], 0
    s_load_dwordx4 s[80:83], s[0:1], 64
    s_cmp_ge_u32 s2, 256
    s_cbranch_scc1 L_exit
    v_and_b32 v86, 63, v0
    v_lshrrev_b32 v87, 6, v0
    s_lshr_b32 s41, s2, 3
    v_readfirstlane_b32 s40, v87
    s_and_b32 s42, s2, 7
    v_lshrrev_b32 v87, 3, v86
    v_and_b32 v88, 7, v86
    v_lshrrev_b32 v90, 4, v86
    v_xor_b32 v91, v88, v90
    v_mul_u32_u24 v92, 896, v87
    v_lshl_add_u32 v64, v91, 4, v92
    v_xor_b32_e64 v65, 64, v64
    v_add_u32 v66, 12288, v64
    v_add_u32 v67, 18432, v65
    v_add_u32 v65, 6144, v65
    s_and_b32 s57, s41, 7
    s_and_b32 s58, s41, 3
    s_and_b32 s43, s2, 2
    s_lshl1_add_u32 s58, s43, s58
    s_cmp_ge_u32 s41, 24
    s_cselect_b32 s57, s58, s57
    s_and_b32 s56, s2, 1
    s_lshl3_add_u32 s43, s56, s57
    s_lshl2_add_u32 s45, s43, s40
    s_mul_i32 s55, s40, 28672
    s_mul_i32 s93, s45, 28672
    s_lshr_b32 s56, s41, 3
    s_lshr_b32 s57, s42, 1
    s_lshl1_add_u32 s92, s56, s57
    s_cmp_ge_u32 s92, 7
    s_cselect_b32 s58, 7, 0
    s_sub_u32 s92, s92, s58
    s_mov_b32 s6, 1835008
    s_mov_b32 s7, 0x20000
    s_mov_b32 s94, s92
    s_getpc_b64 s[56:57]
L_pc:
    s_and_b32 s58, s41, 15
    s_mul_i32 s58, s58, 4608
    v_lshl_add_u32 v89, v86, 7, s58
    v_min_u32 v89, L_codeend-L_pc-4, v89
    s_cmp_eq_u32 s40, 1
    s_cbranch_scc0 L_nopf
    global_load_dword v89, v89, s[56:57]
L_nopf:
    s_waitcnt lgkmcnt(0)
    s_lshl_b32 s56, s94, 12
    s_add_u32 m0, s55, s56
    s_lshl_b32 s56, s94, 7
    s_add_u32 s56, s56, s93
    buffer_load_dwordx4 v64, s[4:7], s56 offen offset:0 lds
    buffer_load_dwordx4 v65, s[4:7], s56 offen offset:1024 lds
    buffer_load_dwordx4 v66, s[4:7], s56 offen offset:2048 lds
    buffer_load_dwordx4 v67, s[4:7], s56 offen offset:3072 lds
    s_add_u32 s94, s94, 1
    s_cmp_eq_u32 s94, 7
    s_cselect_b32 s94, 0, s94
    s_lshl_b32 s56, s94, 12
    s_add_u32 m0, s55, s56
    s_lshl_b32 s56, s94, 7
    s_add_u32 s56, s56, s93
    buffer_load_dwordx4 v64, s[4:7], s56 offen offset:0 lds
    buffer_load_dwordx4 v65, s[4:7], s56 offen offset:1024 lds
    buffer_load_dwordx4 v66, s[4:7], s56 offen offset:2048 lds
    buffer_load_dwordx4 v67, s[4:7], s56 offen offset:3072 lds
    s_add_u32 s94, s94, 1
    s_cmp_eq_u32 s94, 7
    s_cselect_b32 s94, 0, s94
    s_add_u32 s28, s82, 0
    s_addc_u32 s29, s83, 0
    s_lshr_b32 s56, s41, 3
    s_lshr_b32 s57, s42, 1
    s_lshl2_add_u32 s44, s56, s57
    s_lshr_b32 s57, s42, 2
    s_cmp_ge_u32 s41, 28
    s_cselect_b32 s56, 12, 14
    s_add_u32 s57, s57, s56
    s_cmp_ge_u32 s41, 24
    s_cselect_b32 s44, s57, s44
    s_mov_b32 s30, 15532032
    s_mov_b32 s31, 0x20000
    s_lshl2_add_u32 s97, s2, s40
    s_mov_b32 s57, 2146435072
    s_cmp_eq_u32 s97, 3
    s_cselect_b32 s56, 15466496, s57
    s_cselect_b32 s57, 0, s57
    v_mov_b32 v124, s56
    v_mov_b32_e64 v126, s57
    buffer_load_dword v125, v124, s[28:31], 0 offen sc1
    s_mov_b64 s[8:9], s[62:63]
    s_mov_b64 s[24:25], s[64:65]
    s_mov_b64 s[12:13], s[68:69]
    s_mov_b64 s[16:17], s[70:71]
    s_mov_b64 s[20:21], s[72:73]
    s_mov_b64 s[32:33], s[74:75]
    s_mov_b64 s[36:37], s[80:81]
    s_mov_b32 s14, 1605632
    s_mov_b32 s15, 0x20000
    s_mov_b32 s18, 1605632
    s_mov_b32 s19, 0x20000
    s_bitcmp1_b32 s41, 1
    s_cselect_b64 s[100:101], s[16:17], s[12:13]
    s_cselect_b64 s[16:17], s[12:13], s[16:17]
    s_mov_b64 s[12:13], s[100:101]
    s_cmp_lt_u32 s41, 28
    s_cselect_b32 s22, 1605632, 0
    s_cselect_b32 s26, 401408, 0
    s_mov_b32 s23, 0x20000
    s_mov_b32 s27, 0x20000
    s_mov_b32 s34, 1835008
    s_mov_b32 s35, 0x20000
    v_and_b32 v91, 1, v90
    v_lshlrev_b32 v91, 2, v91
    v_xor_b32 v91, v91, v88
    v_lshlrev_b32 v91, 4, v91
    s_lshl_b32 s57, s40, 3
    v_add_u32 v93, s57, v87
    v_mul_u32_u24 v121, 2688, v93
    v_add_u32 v116, v121, v91
    s_and_b32 s76, s41, 1
    s_mul_i32 s51, s76, 602112
    s_sub_u32 s52, 602112, s51
    s_mov_b32 s10, 1204224
    s_mov_b32 s11, 0x20000
    s_add_u32 s58, s44, 9
    s_add_u32 s57, s44, 7
    s_cmp_lt_u32 s44, 5
    s_cselect_b32 s58, s57, s58
    s_lshl_b32 s57, s44, 1
    s_sub_u32 s57, s57, 25
    s_cmp_lt_u32 s44, 14
    s_cselect_b32 s57, s44, s57
    s_cmp_ge_u32 s44, 12
    s_cselect_b32 s95, s57, s58
    s_lshl_b32 s46, s95, 7
    v_lshrrev_b32 v94, 5, v86
    v_and_b32_e64 v95, 31, v86
    v_bfe_u32 v85, v95, 1, 3
    v_xor_b32 v85, v85, v94
    v_lshlrev_b32 v85, 4, v85
    v_lshl_add_u32 v85, v95, 7, v85
    v_add_u32 v68, s55, v85
    v_xor_b32 v69, 32, v68
    v_xor_b32_e64 v70, 64, v68
    v_xor_b32 v71, 96, v68
    s_mov_b32 s79, 0x3f803f80
    s_mov_b32 s38, 256
    s_mov_b32 s39, 0x20000
    v_mov_b32 v76, 0
    v_mov_b32 v80, 0
    v_mov_b32 v77, 0
    v_mov_b32 v81, 0
    v_mov_b32 v78, 0
    v_mov_b32 v82, 0
    v_mov_b32 v79, 0
    v_mov_b32 v83, 0
    v_add_u32 v117, 84992, v116
    v_add_u32 v118, 169984, v116
    v_add_u32 v119, 254976, v116
    v_mul_u32_u24 v121, 3584, v93
    v_add_u32_e64 v240, v121, v91
    v_add_u32 v241, 113664, v240
    v_add_u32 v242, 227328, v240
    v_add_u32 v243, 340992, v240
    v_add_u32_e64 v248, v92, v91
    v_add_u32 v249, 6144, v248
    v_add_u32 v250, 12288, v248
    v_add_u32 v251, 18432, v248
    s_mul_i32 s53, s76, 802816
    s_sub_u32 s54, 802816, s53
    v_bfe_u32 v121, v86, 2, 2
    v_and_b32_e64 v122, 3, v86
    v_bfe_u32 v123, v86, 4, 1
    v_lshrrev_b32_e64 v127, 1, v122
    v_lshl_add_u32 v127, v123, 1, v127
    v_lshrrev_b32 v99, 1, v121
    v_lshlrev_b32 v99, 2, v99
    v_xor_b32 v127, v127, v99
    v_lshlrev_b32 v127, 4, v127
    v_lshl_add_u32 v127, v121, 7, v127
    v_and_b32_e64 v99, 1, v122
    v_lshl_add_u32 v127, v99, 3, v127
    v_xor_b32 v99, 64, v127
    v_lshlrev_b32 v84, 9, v94
    v_add_u32 v1, v84, v127
    v_add_u32 v2, v84, v99
    v_add_u32 v3, 57344, v1
    v_add_u32 v4, 57344, v2
    v_add_u32 v84, 114688, v84
    v_add_u32_e64 v96, v84, v127
    v_add_u32 v97, v84, v99
    s_lshl_b32 s62, s40, 12
    s_add_u32 s62, s62, 114688
    v_lshl_add_u32 v84, v94, 9, s62
    v_add_u32 v5, v84, v127
    v_add_u32 v6, v84, v99
    v_lshlrev_b32 v7, 4, v86
    v_lshlrev_b32 v85, 3, v95
    v_lshl_add_u32 v252, v94, 8, v85
    v_cmp_eq_u32_e64 vcc, 0, v86
    v_mov_b32 v120, 2146435072
    s_lshr_b32 s58, s41, 2
    v_cndmask_b32 v0, v120, 0, vcc
    s_lshl_b32 s58, s58, 7
    s_mul_i32 s89, s40, 100352
    s_add_u32 s89, s89, s58
    s_and_b32 s57, s41, 3
    s_mul_i32 s58, s57, 0
    s_lshr_b32 s58, s58, 1
    v_and_b32 v121, 15, v86
    v_add_u32 v122, s58, v121
    s_mul_i32 s57, s57, 0
    s_add_u32 s57, s57, 2
    v_add_u32 v123, s57, v121
    s_lshr_b32 s58, s41, 2
    s_mul_i32 s58, s58, 0
    v_add_u32 v122, s58, v122
    v_add_u32 v123, s58, v123
    v_and_b32 v123, 7, v123
    v_mul_u32_u24 v127, 43, v122
    v_lshrrev_b32 v127, 8, v127
    v_mul_u32_u24 v127, 6, v127
    v_sub_u32 v122, v122, v127
    s_mul_i32 s57, s40, 12
    s_and_b32 s58, s42, 2
    s_add_u32 s57, s57, s58
    v_and_b32 v127, 6, v122
    v_add3_u32 v122, v122, v127, s57
    s_xor_b32 s57, s57, 2
    v_and_b32 v127, 6, v123
    v_add3_u32 v127, v123, v127, s57
    s_lshl_b32 s57, s40, 1
    s_add_u32 s57, s57, 42
    v_cmp_gt_u32 vcc, 6, v123
    v_add_u32 v123, s57, v123
    s_lshl_b32 s57, s42, 2
    v_cndmask_b32 v123, v123, v127, vcc
    v_cmp_gt_u32_e64 vcc, 6, v121
    s_and_b32 s58, s41, 3
    s_add_u32 s57, s57, s58
    v_cndmask_b32 v122, v123, v122, vcc
    s_mul_i32 s57, s57, 229888
    s_add_u32 s57, s57, 7929856
    s_cmp_lt_u32 s41, 28
    s_cselect_b32 s57, s57, 15532032
    s_lshr_b32 s58, s41, 2
    s_lshl_b32 s58, s58, 7
    v_lshl_add_u32 v123, v122, 11, s57
    v_mul_u32_u24 v122, 28672, v122
    v_cmp_gt_u32 vcc, 16, v86
    v_add_u32 v122, s58, v122
    s_nop 0
    v_cndmask_b32 v31, v123, v122, vcc
    s_mul_i32 s72, s45, 28928
    s_lshl_b32 s74, s45, 9
    s_add_u32 s74, s74, 15400960
    s_mov_b32 s66, s95
    s_lshl_b32 s46, s66, 7
    s_lshl_b32 s57, s66, 2
    s_add_u32 s69, s57, s74
    s_lshl_b32 s57, s66, 12
    s_cmp_ge_u32 s66, 7
    s_cselect_b32 s58, 1871872, 0
    s_cselect_b32 s66, 1.0, 1049335798
    s_add_u32 s57, s57, s58
    s_add_u32 s63, s57, s72
    s_lshl_b32 s57, s44, 1
    s_sub_u32 s67, s57, 24
    s_lshl_b32 s47, s67, 7
    s_lshl_b32 s57, s67, 2
    s_add_u32 s70, s57, s74
    s_lshl_b32 s57, s67, 12
    s_cmp_ge_u32 s67, 7
    s_cselect_b32 s58, 1871872, 0
    s_cselect_b32 s67, 1.0, 1049335798
    s_add_u32 s57, s57, s58
    s_add_u32 s64, s57, s72
    s_lshl_b32 s56, s94, 12
    s_add_u32 m0, s55, s56
    s_lshl_b32 s56, s94, 7
    s_add_u32 s56, s56, s93
    buffer_load_dwordx4 v64, s[4:7], s56 offen offset:0 lds
    buffer_load_dwordx4 v65, s[4:7], s56 offen offset:1024 lds
    buffer_load_dwordx4 v66, s[4:7], s56 offen offset:2048 lds
    buffer_load_dwordx4 v67, s[4:7], s56 offen offset:3072 lds
    s_add_u32 s94, s94, 1
    s_cmp_eq_u32 s94, 7
    s_cselect_b32 s94, 0, s94
    s_mov_b64 s[100:101], s[12:13]
    s_mov_b32 s58, 1605628
    s_mov_b32 s56, 0
    s_cmp_ge_u32 s97, 502
    s_cselect_b64 s[100:101], s[16:17], s[100:101]
    s_cselect_b32 s58, 1605628, s58
    s_cselect_b32 s56, 502, s56
    s_sub_u32 s57, s97, s56
    s_mul_i32 s57, s57, 3200
    v_min_u32 v85, 24, v86
    v_lshl_add_u32 v85, v85, 7, s57
    v_min_u32 v85, s58, v85
    s_mov_b64 s[60:61], s[20:21]
    s_mov_b32 s58, 1605628
    s_mov_b32 s56, 0
    s_cmp_ge_u32 s97, 784
    s_cselect_b64 s[60:61], s[24:25], s[60:61]
    s_cselect_b32 s58, 401404, s58
    s_cselect_b32 s56, 784, s56
    s_sub_u32 s57, s97, s56
    s_mul_i32 s57, s57, 2048
    v_min_u32 v120, 15, v86
    v_lshl_add_u32 v120, v120, 7, s57
    v_min_u32 v120, s58, v120
    s_mov_b32 s68, 1
    s_lshl_b32 s48, s68, 7
    s_lshl_b32 s57, s68, 2
    s_add_u32 s71, s57, s74
    s_lshl_b32 s57, s68, 12
    s_cmp_ge_u32 s68, 7
    s_cselect_b32 s58, 1871872, 0
    s_cselect_b32 s68, 1.0, 1049335798
    s_add_u32 s57, s57, s58
    s_add_u32 s65, s57, s72
    s_sub_u32 s57, s95, 14
    s_lshl_b32 s57, s57, 10
    s_add_u32 s57, s57, s72
    s_add_u32 s58, s57, 3815424
    s_add_u32 s57, s57, 3801088
    s_cmp_ge_u32 s95, 14
    s_cselect_b32 s63, s57, s63
    s_cselect_b32 s64, s58, s64
    s_lshl_b32 s56, s92, 12
    v_add_u32 v72, s56, v68
    v_add_u32 v73, s56, v69
    v_add_u32 v74, s56, v70
    v_add_u32 v75, s56, v71
    s_add_u32 s92, s92, 1
    s_cmp_eq_u32 s92, 7
    s_cselect_b32 s92, 0, s92
    s_waitcnt vmcnt(9)
    ds_read_b128 v[32:35], v72
    ds_read_b128 v[36:39], v73
    ds_read_b128 v[40:43], v74
    ds_read_b128 v[44:47], v75
    s_lshl_b32 s56, s94, 12
    s_add_u32 m0, s55, s56
    s_lshl_b32 s56, s94, 7
    s_add_u32 s56, s56, s93
    buffer_load_dwordx4 v64, s[4:7], s56 offen offset:0 lds
    buffer_load_dwordx4 v65, s[4:7], s56 offen offset:1024 lds
    buffer_load_dwordx4 v66, s[4:7], s56 offen offset:2048 lds
    buffer_load_dwordx4 v67, s[4:7], s56 offen offset:3072 lds
    s_add_u32 s94, s94, 1
    s_nop 0
    s_cmp_eq_u32 s94, 7
    s_cselect_b32 s94, 0, s94
    s_bfe_u32 s57, s45, 65540
    s_lshl_b32 s49, s44, 1
    s_add_u32 s49, s49, s57
    s_xor_b32 s50, s49, 1
    s_add_u32 s58, s44, 12
    s_cmp_ge_u32 s44, 12
    s_cselect_b32 s50, s58, s50
    s_mul_i32 s58, s45, 114944
    s_add_u32 s58, s58, 7929856
    s_lshl_b32 s72, s49, 12
    s_add_u32 s72, s72, s58
    s_lshl_b32 s73, s50, 12
    s_add_u32 s73, s73, s58
    s_add_u32 s58, s74, 128
    s_lshl_b32 s74, s49, 2
    s_add_u32 s74, s74, s58
    s_lshl_b32 s75, s50, 2
    s_add_u32 s75, s75, s58
    s_lshl_b32 s49, s49, 7
    s_lshl_b32 s50, s50, 7
    s_lshl_b32 s56, s92, 12
    v_add_u32 v72, s56, v68
    v_add_u32 v73, s56, v69
    v_add_u32 v74, s56, v70
    v_add_u32 v75, s56, v71
    s_add_u32 s92, s92, 1
    s_cmp_eq_u32 s92, 7
    s_cselect_b32 s92, 0, s92
    s_waitcnt vmcnt(9)
    ds_read_b128 v[48:51], v72
    ds_read_b128 v[52:55], v73
    ds_read_b128 v[56:59], v74
    ds_read_b128 v[60:63], v75
    s_waitcnt lgkmcnt(4)
    v_dot2_f32_bf16 v76, v32, s79, v76
    v_dot2_f32_bf16 v80, v32, v32, v80
    v_dot2_f32_bf16 v77, v33, s79, v77
    v_dot2_f32_bf16 v81, v33, v33, v81
    v_dot2_f32_bf16 v78, v34, s79, v78
    v_dot2_f32_bf16 v82, v34, v34, v82
    v_dot2_f32_bf16 v79, v35, s79, v79
    v_dot2_f32_bf16 v83, v35, v35, v83
    v_dot2_f32_bf16 v76, v36, s79, v76
    v_dot2_f32_bf16 v80, v36, v36, v80
    v_dot2_f32_bf16 v77, v37, s79, v77
    v_dot2_f32_bf16 v81, v37, v37, v81
    v_dot2_f32_bf16 v78, v38, s79, v78
    v_dot2_f32_bf16 v82, v38, v38, v82
    v_dot2_f32_bf16 v79, v39, s79, v79
    v_dot2_f32_bf16 v83, v39, v39, v83
    v_dot2_f32_bf16 v76, v40, s79, v76
    v_dot2_f32_bf16 v80, v40, v40, v80
    v_dot2_f32_bf16 v77, v41, s79, v77
    v_dot2_f32_bf16 v81, v41, v41, v81
    v_dot2_f32_bf16 v78, v42, s79, v78
    v_dot2_f32_bf16 v82, v42, v42, v82
    v_dot2_f32_bf16 v79, v43, s79, v79
    v_dot2_f32_bf16 v83, v43, v43, v83
    v_dot2_f32_bf16 v76, v44, s79, v76
    v_dot2_f32_bf16 v80, v44, v44, v80
    v_dot2_f32_bf16 v77, v45, s79, v77
    v_dot2_f32_bf16 v81, v45, v45, v81
    v_dot2_f32_bf16 v78, v46, s79, v78
    v_dot2_f32_bf16 v82, v46, v46, v82
    v_dot2_f32_bf16 v79, v47, s79, v79
    v_dot2_f32_bf16 v83, v47, v47, v83
    s_lshl_b32 s56, s94, 12
    s_add_u32 m0, s55, s56
    s_lshl_b32 s56, s94, 7
    s_add_u32 s56, s56, s93
    buffer_load_dwordx4 v64, s[4:7], s56 offen offset:0 lds
    buffer_load_dwordx4 v65, s[4:7], s56 offen offset:1024 lds
    buffer_load_dwordx4 v66, s[4:7], s56 offen offset:2048 lds
    buffer_load_dwordx4 v67, s[4:7], s56 offen offset:3072 lds
    s_add_u32 s94, s94, 1
    s_cmp_eq_u32 s94, 7
    s_cselect_b32 s94, 0, s94
    v_lshlrev_b32 v121, 3, v94
    v_sub_u32_e64 v121, v95, v121
    v_mov_b32 v122, 0x3f80
    v_mov_b32 v123, 0x3f800000
    v_cmp_eq_u32 vcc, 0, v121
    v_cmp_eq_u32 s[58:59], 1, v121
    s_nop 0
    v_cndmask_b32 v8, 0, v122, vcc
    v_cndmask_b32 v8, v8, v123, s[58:59]
    v_cmp_eq_u32_e64 vcc, 2, v121
    v_cmp_eq_u32 s[58:59], 3, v121
    s_nop 0
    v_cndmask_b32 v9, 0, v122, vcc
    v_cndmask_b32 v9, v9, v123, s[58:59]
    v_cmp_eq_u32_e64 vcc, 4, v121
    v_cmp_eq_u32 s[58:59], 5, v121
    s_nop 0
    v_cndmask_b32 v10, 0, v122, vcc
    v_cndmask_b32 v10, v10, v123, s[58:59]
    s_lshl_b32 s56, s92, 12
    v_add_u32 v72, s56, v68
    v_add_u32 v73, s56, v69
    v_add_u32 v74, s56, v70
    v_add_u32 v75, s56, v71
    s_add_u32 s92, s92, 1
    s_cmp_eq_u32 s92, 7
    s_cselect_b32 s92, 0, s92
    s_waitcnt vmcnt(8)
    v_add_u32 v125, 1, v125
    v_cmp_eq_u32 vcc, 0, v125
    s_nop 1
    v_cndmask_b32 v125, v125, 1, vcc
    buffer_store_dword v125, v126, s[36:39], 0 offen sc1
    buffer_store_dword v125, v124, s[28:31], 0 offen sc1
    ds_read_b128 v[32:35], v72
    ds_read_b128 v[36:39], v73
    ds_read_b128 v[40:43], v74
    ds_read_b128 v[44:47], v75
    s_waitcnt lgkmcnt(4)
    s_nop 0
    v_dot2_f32_bf16 v76, v48, s79, v76
    v_dot2_f32_bf16 v80, v48, v48, v80
    v_dot2_f32_bf16 v77, v49, s79, v77
    v_dot2_f32_bf16 v81, v49, v49, v81
    v_dot2_f32_bf16 v78, v50, s79, v78
    v_dot2_f32_bf16 v82, v50, v50, v82
    v_dot2_f32_bf16 v79, v51, s79, v79
    v_dot2_f32_bf16 v83, v51, v51, v83
    v_dot2_f32_bf16 v76, v52, s79, v76
    v_dot2_f32_bf16 v80, v52, v52, v80
    v_dot2_f32_bf16 v77, v53, s79, v77
    v_dot2_f32_bf16 v81, v53, v53, v81
    v_dot2_f32_bf16 v78, v54, s79, v78
    v_dot2_f32_bf16 v82, v54, v54, v82
    v_dot2_f32_bf16 v79, v55, s79, v79
    v_dot2_f32_bf16 v83, v55, v55, v83
    v_dot2_f32_bf16 v76, v56, s79, v76
    v_dot2_f32_bf16 v80, v56, v56, v80
    v_dot2_f32_bf16 v77, v57, s79, v77
    v_dot2_f32_bf16 v81, v57, v57, v81
    v_dot2_f32_bf16 v78, v58, s79, v78
    v_dot2_f32_bf16 v82, v58, v58, v82
    v_dot2_f32_bf16 v79, v59, s79, v79
    v_dot2_f32_bf16 v83, v59, v59, v83
    v_dot2_f32_bf16 v76, v60, s79, v76
    v_dot2_f32_bf16 v80, v60, v60, v80
    v_dot2_f32_bf16 v77, v61, s79, v77
    v_dot2_f32_bf16 v81, v61, v61, v81
    v_dot2_f32_bf16 v78, v62, s79, v78
    v_dot2_f32_bf16 v82, v62, v62, v82
    v_dot2_f32_bf16 v79, v63, s79, v79
    v_dot2_f32_bf16 v83, v63, v63, v83
    s_lshl_b32 s56, s94, 12
    s_add_u32 m0, s55, s56
    s_lshl_b32 s56, s94, 7
    s_add_u32 s56, s56, s93
    buffer_load_dwordx4 v64, s[4:7], s56 offen offset:0 lds
    buffer_load_dwordx4 v65, s[4:7], s56 offen offset:1024 lds
    buffer_load_dwordx4 v66, s[4:7], s56 offen offset:2048 lds
    buffer_load_dwordx4 v67, s[4:7], s56 offen offset:3072 lds
    s_add_u32 s94, s94, 1
    s_cmp_eq_u32 s94, 7
    s_cselect_b32 s94, 0, s94
    v_cmp_eq_u32 vcc, 6, v121
    v_cmp_eq_u32 s[58:59], 7, v121
    s_nop 0
    v_cndmask_b32 v11, 0, v122, vcc
    v_cndmask_b32 v11, v11, v123, s[58:59]
    v_cmp_eq_u32_e64 vcc, 16, v121
    v_cmp_eq_u32 s[58:59], 17, v121
    s_nop 0
    v_cndmask_b32 v12, 0, v122, vcc
    v_cndmask_b32 v12, v12, v123, s[58:59]
    v_cmp_eq_u32_e64 vcc, 18, v121
    v_cmp_eq_u32 s[58:59], 19, v121
    s_nop 0
    v_cndmask_b32 v13, 0, v122, vcc
    v_cndmask_b32 v13, v13, v123, s[58:59]
    s_lshl_b32 s56, s92, 12
    v_add_u32 v72, s56, v68
    v_add_u32 v73, s56, v69
    v_add_u32 v74, s56, v70
    v_add_u32 v75, s56, v71
    s_add_u32 s92, s92, 1
    s_cmp_eq_u32 s92, 7
    s_cselect_b32 s92, 0, s92
    s_waitcnt vmcnt(10)
    ds_read_b128 v[48:51], v72
    ds_read_b128 v[52:55], v73
    ds_read_b128 v[56:59], v74
    ds_read_b128 v[60:63], v75
    s_waitcnt lgkmcnt(4)
    v_dot2_f32_bf16 v76, v32, s79, v76
    v_dot2_f32_bf16 v80, v32, v32, v80
    v_dot2_f32_bf16 v77, v33, s79, v77
    v_dot2_f32_bf16 v81, v33, v33, v81
    v_dot2_f32_bf16 v78, v34, s79, v78
    v_dot2_f32_bf16 v82, v34, v34, v82
    v_dot2_f32_bf16 v79, v35, s79, v79
    v_dot2_f32_bf16 v83, v35, v35, v83
    v_dot2_f32_bf16 v76, v36, s79, v76
    v_dot2_f32_bf16 v80, v36, v36, v80
    v_dot2_f32_bf16 v77, v37, s79, v77
    v_dot2_f32_bf16 v81, v37, v37, v81
    v_dot2_f32_bf16 v78, v38, s79, v78
    v_dot2_f32_bf16 v82, v38, v38, v82
    v_dot2_f32_bf16 v79, v39, s79, v79
    v_dot2_f32_bf16 v83, v39, v39, v83
    v_dot2_f32_bf16 v76, v40, s79, v76
    v_dot2_f32_bf16 v80, v40, v40, v80
    v_dot2_f32_bf16 v77, v41, s79, v77
    v_dot2_f32_bf16 v81, v41, v41, v81
    v_dot2_f32_bf16 v78, v42, s79, v78
    v_dot2_f32_bf16 v82, v42, v42, v82
    v_dot2_f32_bf16 v79, v43, s79, v79
    v_dot2_f32_bf16 v83, v43, v43, v83
    v_dot2_f32_bf16 v76, v44, s79, v76
    v_dot2_f32_bf16 v80, v44, v44, v80
    v_dot2_f32_bf16 v77, v45, s79, v77
    v_dot2_f32_bf16 v81, v45, v45, v81
    v_dot2_f32_bf16 v78, v46, s79, v78
    v_dot2_f32_bf16 v82, v46, v46, v82
    v_dot2_f32_bf16 v79, v47, s79, v79
    v_dot2_f32_bf16 v83, v47, v47, v83
    s_lshl_b32 s56, s94, 12
    s_add_u32 m0, s55, s56
    s_lshl_b32 s56, s94, 7
    s_add_u32 s56, s56, s93
    buffer_load_dwordx4 v64, s[4:7], s56 offen offset:0 lds
    buffer_load_dwordx4 v65, s[4:7], s56 offen offset:1024 lds
    buffer_load_dwordx4 v66, s[4:7], s56 offen offset:2048 lds
    buffer_load_dwordx4 v67, s[4:7], s56 offen offset:3072 lds
    s_add_u32 s94, s94, 1
    s_cmp_eq_u32 s94, 7
    s_cselect_b32 s94, 0, s94
    s_lshl_b32 s94, s40, 10
    s_add_u32 s95, s46, s51
    v_cmp_eq_u32 vcc, 20, v121
    v_cmp_eq_u32 s[58:59], 21, v121
    s_nop 0
    v_cndmask_b32 v14, 0, v122, vcc
    v_cndmask_b32 v14, v14, v123, s[58:59]
    v_cmp_eq_u32_e64 vcc, 22, v121
    v_cmp_eq_u32 s[58:59], 23, v121
    s_nop 0
    v_cndmask_b32 v15, 0, v122, vcc
    v_cndmask_b32 v15, v15, v123, s[58:59]
    s_lshl_b32 s56, s92, 12
    v_add_u32 v72, s56, v68
    v_add_u32 v73, s56, v69
    v_add_u32 v74, s56, v70
    v_add_u32 v75, s56, v71
    s_add_u32 s92, s92, 1
    s_cmp_eq_u32 s92, 7
    s_cselect_b32 s92, 0, s92
    s_waitcnt vmcnt(10)
    ds_read_b128 v[32:35], v72
    ds_read_b128 v[36:39], v73
    ds_read_b128 v[40:43], v74
    ds_read_b128 v[44:47], v75
    s_waitcnt lgkmcnt(4)
    v_dot2_f32_bf16 v76, v48, s79, v76
    v_dot2_f32_bf16 v80, v48, v48, v80
    v_dot2_f32_bf16 v77, v49, s79, v77
    v_dot2_f32_bf16 v81, v49, v49, v81
    v_dot2_f32_bf16 v78, v50, s79, v78
    v_dot2_f32_bf16 v82, v50, v50, v82
    v_dot2_f32_bf16 v79, v51, s79, v79
    v_dot2_f32_bf16 v83, v51, v51, v83
    v_dot2_f32_bf16 v76, v52, s79, v76
    v_dot2_f32_bf16 v80, v52, v52, v80
    v_dot2_f32_bf16 v77, v53, s79, v77
    v_dot2_f32_bf16 v81, v53, v53, v81
    v_dot2_f32_bf16 v78, v54, s79, v78
    v_dot2_f32_bf16 v82, v54, v54, v82
    v_dot2_f32_bf16 v79, v55, s79, v79
    v_dot2_f32_bf16 v83, v55, v55, v83
    v_dot2_f32_bf16 v76, v56, s79, v76
    v_dot2_f32_bf16 v80, v56, v56, v80
    v_dot2_f32_bf16 v77, v57, s79, v77
    v_dot2_f32_bf16 v81, v57, v57, v81
    v_dot2_f32_bf16 v78, v58, s79, v78
    v_dot2_f32_bf16 v82, v58, v58, v82
    v_dot2_f32_bf16 v79, v59, s79, v79
    v_dot2_f32_bf16 v83, v59, v59, v83
    v_dot2_f32_bf16 v76, v60, s79, v76
    v_dot2_f32_bf16 v80, v60, v60, v80
    v_dot2_f32_bf16 v77, v61, s79, v77
    v_dot2_f32_bf16 v81, v61, v61, v81
    v_dot2_f32_bf16 v78, v62, s79, v78
    v_dot2_f32_bf16 v82, v62, v62, v82
    v_dot2_f32_bf16 v79, v63, s79, v79
    v_dot2_f32_bf16 v83, v63, v63, v83
    s_add_u32 m0, s94, 114688
    s_add_u32 s56, s95, 0
    s_nop 0
    buffer_load_dwordx4 v116, s[8:11], s56 offen lds
    s_add_u32 m0, s94, 118784
    s_add_u32 s56, s95, 86016
    buffer_load_dwordx4 v116, s[8:11], s56 offen lds
    s_add_u32 m0, s94, 122880
    s_add_u32 s56, s95, 172032
    buffer_load_dwordx4 v116, s[8:11], s56 offen lds
    s_add_u32 m0, s94, 126976
    s_add_u32 s56, s95, 258048
    buffer_load_dwordx4 v116, s[8:11], s56 offen lds
    s_lshl_b32 s56, s92, 12
    v_add_u32 v72, s56, v68
    v_add_u32 v73, s56, v69
    v_add_u32 v74, s56, v70
    v_add_u32 v75, s56, v71
    s_add_u32 s92, s92, 1
    s_cmp_eq_u32 s92, 7
    s_cselect_b32 s92, 0, s92
    s_waitcnt vmcnt(8)
    ds_read_b128 v[48:51], v72
    ds_read_b128 v[52:55], v73
    ds_read_b128 v[56:59], v74
    ds_read_b128 v[60:63], v75
    s_waitcnt lgkmcnt(4)
    v_dot2_f32_bf16 v76, v32, s79, v76
    v_dot2_f32_bf16 v80, v32, v32, v80
    v_dot2_f32_bf16 v77, v33, s79, v77
    v_dot2_f32_bf16 v81, v33, v33, v81
    v_dot2_f32_bf16 v78, v34, s79, v78
    v_dot2_f32_bf16 v82, v34, v34, v82
    v_dot2_f32_bf16 v79, v35, s79, v79
    v_dot2_f32_bf16 v83, v35, v35, v83
    v_dot2_f32_bf16 v76, v36, s79, v76
    v_dot2_f32_bf16 v80, v36, v36, v80
    v_dot2_f32_bf16 v77, v37, s79, v77
    v_dot2_f32_bf16 v81, v37, v37, v81
    v_dot2_f32_bf16 v78, v38, s79, v78
    v_dot2_f32_bf16 v82, v38, v38, v82
    v_dot2_f32_bf16 v79, v39, s79, v79
    v_dot2_f32_bf16 v83, v39, v39, v83
    v_dot2_f32_bf16 v76, v40, s79, v76
    v_dot2_f32_bf16 v80, v40, v40, v80
    v_dot2_f32_bf16 v77, v41, s79, v77
    v_dot2_f32_bf16 v81, v41, v41, v81
    v_dot2_f32_bf16 v78, v42, s79, v78
    v_dot2_f32_bf16 v82, v42, v42, v82
    v_dot2_f32_bf16 v79, v43, s79, v79
    v_dot2_f32_bf16 v83, v43, v43, v83
    v_dot2_f32_bf16 v76, v44, s79, v76
    v_dot2_f32_bf16 v80, v44, v44, v80
    v_dot2_f32_bf16 v77, v45, s79, v77
    v_dot2_f32_bf16 v81, v45, v45, v81
    v_dot2_f32_bf16 v78, v46, s79, v78
    v_dot2_f32_bf16 v82, v46, v46, v82
    v_dot2_f32_bf16 v79, v47, s79, v79
    v_dot2_f32_bf16 v83, v47, v47, v83
    s_add_u32 m0, s94, 131072
    s_add_u32 s56, s95, 344064
    buffer_load_dwordx4 v116, s[8:11], s56 offen lds
    s_add_u32 m0, s94, 135168
    s_add_u32 s56, s95, 430080
    buffer_load_dwordx4 v116, s[8:11], s56 offen lds
    s_add_u32 m0, s94, 139264
    s_add_u32 s56, s95, 516096
    buffer_load_dwordx4 v116, s[8:11], s56 offen lds
    global_load_dword v98, v85, s[100:101]
    s_lshl_b32 s56, s92, 12
    v_add_u32 v72, s56, v68
    v_add_u32 v73, s56, v69
    v_add_u32 v74, s56, v70
    v_add_u32_e64 v75, s56, v71
    s_add_u32 s92, s92, 1
    s_cmp_eq_u32 s92, 7
    s_cselect_b32 s92, 0, s92
    s_waitcnt lgkmcnt(0)
    v_dot2_f32_bf16 v76, v48, s79, v76
    v_dot2_f32_bf16 v80, v48, v48, v80
    v_dot2_f32_bf16 v77, v49, s79, v77
    v_dot2_f32_bf16 v81, v49, v49, v81
    v_dot2_f32_bf16 v78, v50, s79, v78
    v_dot2_f32_bf16 v82, v50, v50, v82
    v_dot2_f32_bf16 v79, v51, s79, v79
    v_dot2_f32_bf16 v83, v51, v51, v83
    v_dot2_f32_bf16 v76, v52, s79, v76
    v_dot2_f32_bf16 v80, v52, v52, v80
    v_dot2_f32_bf16 v77, v53, s79, v77
    v_dot2_f32_bf16 v81, v53, v53, v81
    v_dot2_f32_bf16 v78, v54, s79, v78
    v_dot2_f32_bf16 v82, v54, v54, v82
    v_dot2_f32_bf16 v79, v55, s79, v79
    v_dot2_f32_bf16 v83, v55, v55, v83
    v_dot2_f32_bf16 v76, v56, s79, v76
    v_dot2_f32_bf16 v80, v56, v56, v80
    v_dot2_f32_bf16 v77, v57, s79, v77
    v_dot2_f32_bf16 v81, v57, v57, v81
    v_dot2_f32_bf16 v78, v58, s79, v78
    v_dot2_f32_bf16 v82, v58, v58, v82
    v_dot2_f32_bf16 v79, v59, s79, v79
    v_dot2_f32_bf16 v83, v59, v59, v83
    v_dot2_f32_bf16 v76, v60, s79, v76
    v_dot2_f32_bf16 v80, v60, v60, v80
    v_dot2_f32_bf16 v77, v61, s79, v77
    v_dot2_f32_bf16 v81, v61, v61, v81
    v_dot2_f32_bf16 v78, v62, s79, v78
    v_dot2_f32_bf16 v82, v62, v62, v82
    v_dot2_f32_bf16 v79, v63, s79, v79
    v_dot2_f32_bf16 v83, v63, v63, v83
    s_waitcnt vmcnt(8)
    s_nop 0
    ds_read_b128 v[32:35], v72
    ds_read_b128 v[36:39], v73
    ds_read_b128 v[40:43], v74
    ds_read_b128 v[44:47], v75
    s_mul_i32 s56, s76, 12288
    s_mul_i32 s57, s76, 16384
    s_lshl_b32 s58, s76, 6
    v_xor_b32 v20, s58, v68
    v_add_u32 v20, s56, v20
    v_xor_b32 v21, s58, v69
    v_add_u32 v21, s56, v21
    v_xor_b32 v22, s58, v70
    v_add_u32 v22, s57, v22
    v_xor_b32 v23, s58, v71
    v_add_u32_e64 v23, s57, v23
    s_mul_i32 s56, s76, 28672
    ds_read_b128 v[128:131], v20 offset:0
    ds_read_b128 v[132:135], v21 offset:0
    ds_read_b128 v[136:139], v22 offset:0
    ds_read_b128 v[140:143], v23 offset:0
    ds_read_b128 v[144:147], v20 offset:4096
    v_subrev_u32 v24, s56, v20
    v_subrev_u32 v25, s56, v21
    v_subrev_u32_e64 v26, s56, v22
    v_subrev_u32 v27, s56, v23
    ds_read_b128 v[148:151], v21 offset:4096
    s_waitcnt lgkmcnt(6)
    v_dot2_f32_bf16 v76, v32, s79, v76
    v_dot2_f32_bf16 v80, v32, v32, v80
    v_dot2_f32_bf16 v77, v33, s79, v77
    v_dot2_f32_bf16 v81, v33, v33, v81
    v_dot2_f32_bf16 v78, v34, s79, v78
    v_dot2_f32_bf16 v82, v34, v34, v82
    v_dot2_f32_bf16 v79, v35, s79, v79
    v_dot2_f32_bf16 v83, v35, v35, v83
    v_dot2_f32_bf16 v76, v36, s79, v76
    v_dot2_f32_bf16 v80, v36, v36, v80
    v_dot2_f32_bf16 v77, v37, s79, v77
    v_dot2_f32_bf16 v81, v37, v37, v81
    v_dot2_f32_bf16 v78, v38, s79, v78
    v_dot2_f32_bf16 v82, v38, v38, v82
    v_dot2_f32_bf16 v79, v39, s79, v79
    v_dot2_f32_bf16 v83, v39, v39, v83
    v_dot2_f32_bf16 v76, v40, s79, v76
    v_dot2_f32_bf16 v80, v40, v40, v80
    v_dot2_f32_bf16 v77, v41, s79, v77
    v_dot2_f32_bf16 v81, v41, v41, v81
    v_dot2_f32_bf16 v78, v42, s79, v78
    v_dot2_f32_bf16 v82, v42, v42, v82
    v_dot2_f32_bf16 v79, v43, s79, v79
    v_dot2_f32_bf16 v83, v43, v43, v83
    v_dot2_f32_bf16 v76, v44, s79, v76
    v_dot2_f32_bf16 v80, v44, v44, v80
    v_dot2_f32_bf16 v77, v45, s79, v77
    v_dot2_f32_bf16 v81, v45, v45, v81
    v_dot2_f32_bf16 v78, v46, s79, v78
    v_dot2_f32_bf16 v82, v46, v46, v82
    v_dot2_f32_bf16 v79, v47, s79, v79
    v_dot2_f32_bf16 v83, v47, v47, v83
    ds_read_b128 v[152:155], v22 offset:4096
    ds_read_b128 v[156:159], v23 offset:4096
    v_add_f32 v76, v76, v77
    v_add_f32 v78, v78, v79
    v_add_f32 v80, v80, v81
    v_add_f32 v76, v76, v78
    v_add_f32 v82, v82, v83
    v_mov_b32 v77, v76
    v_add_f32 v80, v80, v82
    s_nop 0
    v_permlane32_swap_b32 v76, v77
    v_mov_b32 v81, v80
    v_add_f32 v76, v76, v77
    v_mul_f32 v76, 991054117, v76
    v_permlane32_swap_b32 v80, v81
    v_cvt_pk_bf16_f32 v77, v76, v76
    s_brev_b32 s79, 1
    v_add_f32 v80, v80, v81
    v_lshlrev_b32_e64 v77, 16, v77
    v_mul_f32 v80, 991054117, v80
    v_xor_b32 v48, s79, v77
    v_xor_b32 v49, s79, v77
    v_xor_b32 v50, s79, v77
    v_xor_b32 v51, s79, v77
    v_xor_b32 v52, s79, v77
    v_xor_b32 v53, s79, v77
    v_xor_b32 v54, s79, v77
    v_xor_b32 v55, s79, v77
    v_xor_b32 v56, s79, v77
    v_xor_b32 v57, s79, v77
    v_xor_b32 v58, s79, v77
    v_xor_b32 v59, s79, v77
    v_xor_b32 v60, s79, v77
    v_xor_b32 v61, s79, v77
    v_xor_b32 v62, s79, v77
    v_xor_b32 v63, s79, v77
    v_fma_f32 v80, -v76, v76, v80
    s_cmp_lt_u32 s44, 5
    s_cbranch_scc1 P_A
    s_cmp_eq_u32 s44, 12
    s_cbranch_scc1 P_C1
    s_cmp_gt_u32 s44, 12
    s_cbranch_scc1 P_C2
P_B:
    s_nop 0
    s_waitcnt lgkmcnt(6)
    v_mfma_f32_32x32x16_bf16 v[32:47], v[8:11], v[128:131], v[48:63]
    ds_read_b128 v[160:163], v20 offset:8192
    ds_read_b128 v[164:167], v21 offset:8192
    ds_read_b128 v[168:171], v22 offset:8192
    ds_read_b128 v[172:175], v23 offset:8192
    v_max_f32 v80, 0, v80
    v_cvt_pk_bf16_f32 v80, v80, v80
    v_mfma_f32_32x32x16_bf16 v[32:47], v[12:15], v[132:135], v[32:47]
    s_waitcnt lgkmcnt(8)
    v_mfma_f32_32x32x16_bf16 v[64:79], v[8:11], v[136:139], v[48:63]
    ds_read_b128 v[176:179], v20 offset:12288
    ds_read_b128 v[180:183], v21 offset:12288
    ds_read_b128 v[184:187], v26 offset:12288
    ds_read_b128 v[188:191], v27 offset:12288
    v_lshlrev_b32_e64 v80, 16, v80
    v_add_f32 v80, 925353388, v80
    v_mfma_f32_32x32x16_bf16 v[64:79], v[12:15], v[140:143], v[64:79]
    v_cvt_pk_bf16_f32 v80, v80, v80
    v_lshlrev_b32 v80, 16, v80
    v_sqrt_f32 v80, v80
    v_cvt_pk_bf16_f32 v128, v32, v33
    v_cvt_pk_bf16_f32 v129, v34, v35
    v_cvt_pk_bf16_f32 v130, v36, v37
    v_cvt_pk_bf16_f32 v131, v38, v39
    v_cvt_pk_bf16_f32 v132, v40, v41
    v_cvt_pk_bf16_f32 v133, v42, v43
    v_cvt_pk_bf16_f32 v134, v44, v45
    v_cvt_pk_bf16_f32 v135, v46, v47
    s_waitcnt lgkmcnt(10)
    v_mfma_f32_32x32x16_bf16 v[32:47], v[8:11], v[144:147], v[48:63]
    ds_read_b128 v[192:195], v24 offset:16384
    ds_read_b128 v[196:199], v25 offset:16384
    ds_read_b128 v[200:203], v26 offset:16384
    ds_read_b128 v[204:207], v27 offset:16384
    s_lshl_b32 s58, s40, 7
    v_cvt_pk_bf16_f32 v80, v80, v80
    v_mfma_f32_32x32x16_bf16 v[32:47], v[12:15], v[148:151], v[32:47]
    v_cvt_pk_bf16_f32 v136, v64, v65
    v_cvt_pk_bf16_f32 v137, v66, v67
    v_cvt_pk_bf16_f32 v138, v68, v69
    v_cvt_pk_bf16_f32 v139, v70, v71
    v_cvt_pk_bf16_f32 v140, v72, v73
    v_cvt_pk_bf16_f32 v141, v74, v75
    v_cvt_pk_bf16_f32 v142, v76, v77
    v_cvt_pk_bf16_f32 v143, v78, v79
    s_waitcnt lgkmcnt(12)
    s_nop 0
    v_mfma_f32_32x32x16_bf16 v[64:79], v[8:11], v[152:155], v[48:63]
    ds_read_b128 v[208:211], v24 offset:20480
    ds_read_b128 v[212:215], v25 offset:20480
    ds_read_b128 v[216:219], v26 offset:20480
    ds_read_b128 v[220:223], v27 offset:20480
    v_lshlrev_b32 v80, 16, v80
    v_rcp_f32 v253, v80
    v_mfma_f32_32x32x16_bf16 v[64:79], v[12:15], v[156:159], v[64:79]
    v_cvt_pk_bf16_f32 v144, v32, v33
    v_cvt_pk_bf16_f32 v145, v34, v35
    v_cvt_pk_bf16_f32 v146, v36, v37
    v_cvt_pk_bf16_f32 v147, v38, v39
    v_cvt_pk_bf16_f32 v148, v40, v41
    v_cvt_pk_bf16_f32 v149, v42, v43
    v_cvt_pk_bf16_f32 v150, v44, v45
    v_cvt_pk_bf16_f32 v151, v46, v47
    s_waitcnt lgkmcnt(14)
    s_nop 0
    v_mfma_f32_32x32x16_bf16 v[32:47], v[8:11], v[160:163], v[48:63]
    ds_read_b128 v[224:227], v24 offset:24576
    ds_read_b128 v[228:231], v25 offset:24576
    ds_read_b128 v[232:235], v26 offset:24576
    ds_read_b128 v[236:239], v27 offset:24576
    s_add_u32 s58, s58, 143360
    v_mul_f32_e64 v245, v253, v253
    v_mfma_f32_32x32x16_bf16 v[32:47], v[12:15], v[164:167], v[32:47]
    v_cvt_pk_bf16_f32 v152, v64, v65
    v_cvt_pk_bf16_f32 v153, v66, v67
    v_cvt_pk_bf16_f32 v154, v68, v69
    v_cvt_pk_bf16_f32 v155, v70, v71
    v_cvt_pk_bf16_f32 v156, v72, v73
    v_cvt_pk_bf16_f32 v157, v74, v75
    v_cvt_pk_bf16_f32 v158, v76, v77
    v_cvt_pk_bf16_f32 v159, v78, v79
    s_waitcnt lgkmcnt(15)
    s_nop 0
    v_mfma_f32_32x32x16_bf16 v[64:79], v[8:11], v[168:171], v[48:63]
    v_lshl_add_u32 v84, v95, 2, s58
    v_lshl_add_u32 v85, v94, 4, s58
    v_mfma_f32_32x32x16_bf16 v[64:79], v[12:15], v[172:175], v[64:79]
    v_cvt_pk_bf16_f32 v160, v32, v33
    v_cvt_pk_bf16_f32 v161, v34, v35
    v_cvt_pk_bf16_f32 v162, v36, v37
    v_cvt_pk_bf16_f32 v163, v38, v39
    v_cvt_pk_bf16_f32 v164, v40, v41
    v_cvt_pk_bf16_f32 v165, v42, v43
    v_cvt_pk_bf16_f32 v166, v44, v45
    v_cvt_pk_bf16_f32 v167, v46, v47
    s_waitcnt lgkmcnt(14)
    v_mfma_f32_32x32x16_bf16 v[32:47], v[8:11], v[176:179], v[48:63]
    s_waitcnt lgkmcnt(0)
    s_add_u32 m0, s55, 0
    s_add_u32 s57, s46, s52
    buffer_load_dwordx4 v116, s[8:11], s57 offen offset:0 lds
    buffer_load_dwordx4 v117, s[8:11], s57 offen offset:1024 lds
    ds_write_b32 v84, v253
    ds_read_b128 v[100:103], v85 offset:0
    v_mfma_f32_32x32x16_bf16 v[32:47], v[12:15], v[180:183], v[32:47]
    v_cvt_pk_bf16_f32 v168, v64, v65
    v_cvt_pk_bf16_f32 v169, v66, v67
    v_cvt_pk_bf16_f32 v170, v68, v69
    v_cvt_pk_bf16_f32 v171, v70, v71
    v_cvt_pk_bf16_f32 v172, v72, v73
    v_cvt_pk_bf16_f32 v173, v74, v75
    v_cvt_pk_bf16_f32 v174, v76, v77
    v_cvt_pk_bf16_f32 v175, v78, v79
    v_mfma_f32_32x32x16_bf16 v[64:79], v[8:11], v[184:187], v[48:63]
    buffer_load_dwordx4 v118, s[8:11], s57 offen offset:2048 lds
    buffer_load_dwordx4 v119, s[8:11], s57 offen offset:3072 lds
    ds_read_b128 v[104:107], v85 offset:32
    ds_read_b128 v[108:111], v85 offset:64
    v_mfma_f32_32x32x16_bf16 v[64:79], v[12:15], v[188:191], v[64:79]
    v_cvt_pk_bf16_f32 v176, v32, v33
    v_cvt_pk_bf16_f32 v177, v34, v35
    v_cvt_pk_bf16_f32 v178, v36, v37
    v_cvt_pk_bf16_f32 v179, v38, v39
    v_cvt_pk_bf16_f32 v180, v40, v41
    v_cvt_pk_bf16_f32 v181, v42, v43
    v_cvt_pk_bf16_f32 v182, v44, v45
    v_cvt_pk_bf16_f32 v183, v46, v47
    v_mfma_f32_32x32x16_bf16 v[32:47], v[8:11], v[192:195], v[48:63]
    s_add_u32 m0, s55, 4096
    s_add_u32 s57, s57, 344064
    buffer_load_dwordx4 v116, s[8:11], s57 offen offset:0 lds
    buffer_load_dwordx4 v117, s[8:11], s57 offen offset:1024 lds
    ds_read_b128 v[112:115], v85 offset:96
    v_mul_u32_u24 v246, 7168, v94
    v_mfma_f32_32x32x16_bf16 v[32:47], v[12:15], v[196:199], v[32:47]
    v_cvt_pk_bf16_f32 v184, v64, v65
    v_cvt_pk_bf16_f32 v185, v66, v67
    v_cvt_pk_bf16_f32 v186, v68, v69
    v_cvt_pk_bf16_f32 v187, v70, v71
    v_cvt_pk_bf16_f32 v188, v72, v73
    v_cvt_pk_bf16_f32 v189, v74, v75
    v_cvt_pk_bf16_f32 v190, v76, v77
    v_cvt_pk_bf16_f32 v191, v78, v79
    v_mfma_f32_32x32x16_bf16 v[64:79], v[8:11], v[200:203], v[48:63]
    buffer_load_dwordx4 v118, s[8:11], s57 offen offset:2048 lds
    s_add_u32 m0, s55, 7168
    s_add_u32 s57, s49, s53
    s_nop 0
    buffer_load_dwordx4 v240, s[12:15], s57 offen offset:0 lds
    v_lshl_add_u32 v246, v95, 4, v246
    v_mfma_f32_32x32x16_bf16 v[64:79], v[12:15], v[204:207], v[64:79]
    v_cvt_pk_bf16_f32 v192, v32, v33
    v_cvt_pk_bf16_f32 v193, v34, v35
    v_cvt_pk_bf16_f32 v194, v36, v37
    v_cvt_pk_bf16_f32 v195, v38, v39
    v_cvt_pk_bf16_f32 v196, v40, v41
    v_cvt_pk_bf16_f32 v197, v42, v43
    v_cvt_pk_bf16_f32 v198, v44, v45
    v_cvt_pk_bf16_f32 v199, v46, v47
    v_mfma_f32_32x32x16_bf16 v[32:47], v[8:11], v[208:211], v[48:63]
    buffer_load_dwordx4 v241, s[12:15], s57 offen offset:1024 lds
    buffer_load_dwordx4 v242, s[12:15], s57 offen offset:2048 lds
    v_mfma_f32_32x32x16_bf16 v[32:47], v[12:15], v[212:215], v[32:47]
    v_cvt_pk_bf16_f32 v200, v64, v65
    v_cvt_pk_bf16_f32 v201, v66, v67
    v_cvt_pk_bf16_f32 v202, v68, v69
    v_cvt_pk_bf16_f32 v203, v70, v71
    v_cvt_pk_bf16_f32 v204, v72, v73
    v_cvt_pk_bf16_f32 v205, v74, v75
    v_cvt_pk_bf16_f32 v206, v76, v77
    v_cvt_pk_bf16_f32 v207, v78, v79
    v_mfma_f32_32x32x16_bf16 v[64:79], v[8:11], v[216:219], v[48:63]
    buffer_load_dwordx4 v243, s[12:15], s57 offen offset:3072 lds
    v_mfma_f32_32x32x16_bf16 v[64:79], v[12:15], v[220:223], v[64:79]
    s_nop 0
    s_nop 0
    v_cvt_pk_bf16_f32 v208, v32, v33
    v_cvt_pk_bf16_f32 v209, v34, v35
    v_cvt_pk_bf16_f32 v210, v36, v37
    v_cvt_pk_bf16_f32 v211, v38, v39
    v_cvt_pk_bf16_f32 v212, v40, v41
    v_cvt_pk_bf16_f32 v213, v42, v43
    v_cvt_pk_bf16_f32 v214, v44, v45
    v_cvt_pk_bf16_f32 v215, v46, v47
    v_mfma_f32_32x32x16_bf16 v[32:47], v[8:11], v[224:227], v[48:63]
    s_add_u32 m0, s55, 11264
    s_add_u32 s57, s57, 458752
    buffer_load_dwordx4 v240, s[12:15], s57 offen offset:0 lds
    v_mfma_f32_32x32x16_bf16 v[32:47], v[12:15], v[228:231], v[32:47]
    v_cvt_pk_bf16_f32 v216, v64, v65
    v_cvt_pk_bf16_f32 v217, v66, v67
    v_cvt_pk_bf16_f32 v218, v68, v69
    v_cvt_pk_bf16_f32 v219, v70, v71
    v_cvt_pk_bf16_f32 v220, v72, v73
    v_cvt_pk_bf16_f32 v221, v74, v75
    v_cvt_pk_bf16_f32 v222, v76, v77
    v_cvt_pk_bf16_f32 v223, v78, v79
    v_mfma_f32_32x32x16_bf16 v[64:79], v[8:11], v[232:235], v[48:63]
    buffer_load_dwordx4 v241, s[12:15], s57 offen offset:1024 lds
    v_mfma_f32_32x32x16_bf16 v[64:79], v[12:15], v[236:239], v[64:79]
    s_nop 0
    s_nop 0
    v_cvt_pk_bf16_f32 v224, v32, v33
    v_cvt_pk_bf16_f32 v225, v34, v35
    v_cvt_pk_bf16_f32 v226, v36, v37
    v_cvt_pk_bf16_f32 v227, v38, v39
    v_cvt_pk_bf16_f32 v228, v40, v41
    v_cvt_pk_bf16_f32 v229, v42, v43
    v_cvt_pk_bf16_f32 v230, v44, v45
    v_cvt_pk_bf16_f32 v231, v46, v47
    buffer_load_dwordx4 v242, s[12:15], s57 offen offset:2048 lds
    buffer_load_dword v255, off, s[36:39], 0 sc1
    s_nop 0
    v_cvt_pk_bf16_f32 v232, v64, v65
    v_cvt_pk_bf16_f32 v233, v66, v67
    v_cvt_pk_bf16_f32 v234, v68, v69
    v_cvt_pk_bf16_f32 v235, v70, v71
    v_cvt_pk_bf16_f32 v236, v72, v73
    v_cvt_pk_bf16_f32 v237, v74, v75
    v_cvt_pk_bf16_f32 v238, v76, v77
    v_cvt_pk_bf16_f32 v239, v78, v79
    s_waitcnt vmcnt(16)
    s_waitcnt lgkmcnt(0)
    s_barrier
    ds_read_b64_tr_b16 a[224:225], v96 offset:0
    ds_read_b64_tr_b16 a[226:227], v96 offset:1024
    ds_read_b64_tr_b16 a[228:229], v97 offset:0
    ds_read_b64_tr_b16 a[230:231], v97 offset:1024
    ds_read_b64_tr_b16 a[232:233], v96 offset:2048
    ds_read_b64_tr_b16 a[234:235], v96 offset:3072
    ds_read_b64_tr_b16 a[236:237], v97 offset:2048
    ds_read_b64_tr_b16 a[238:239], v97 offset:3072
    ds_read_b64_tr_b16 a[240:241], v96 offset:4096
    ds_read_b64_tr_b16 a[242:243], v96 offset:5120
    ds_read_b64_tr_b16 a[244:245], v97 offset:4096
    ds_read_b64_tr_b16 a[246:247], v97 offset:5120
    s_waitcnt lgkmcnt(4)
    v_mfma_f32_32x32x16_bf16 v[32:47], v[128:131], a[224:227], 0
    ds_read_b64_tr_b16 a[248:249], v96 offset:6144
    ds_read_b64_tr_b16 a[250:251], v96 offset:7168
    s_lshl_b32 s79, s42, 2
    s_and_b32 s76, s41, 3
    s_add_u32 s79, s79, s76
    v_mfma_f32_32x32x16_bf16 v[48:63], v[128:131], a[228:231], 0
    ds_read_b64_tr_b16 a[252:253], v97 offset:6144
    ds_read_b64_tr_b16 a[254:255], v97 offset:7168
    s_lshl_b32 s79, s79, 1
    s_mul_i32 s95, s79, 33024
    s_lshl_b32 s76, s40, 13
    v_mfma_f32_32x32x16_bf16 v[32:47], v[132:135], a[232:235], v[32:47]
    ds_read_b64_tr_b16 a[224:225], v96 offset:8192
    ds_read_b64_tr_b16 a[226:227], v96 offset:9216
    s_add_u32 s95, s95, s76
    s_add_u32 s95, s95, 5701632
    s_lshl_b32 s76, s79, 1
    v_mfma_f32_32x32x16_bf16 v[48:63], v[132:135], a[236:239], v[48:63]
    ds_read_b64_tr_b16 a[228:229], v97 offset:8192
    ds_read_b64_tr_b16 a[230:231], v97 offset:9216
    s_add_u32 s76, s76, s40
    s_mul_i32 s44, s76, 14336
    s_waitcnt lgkmcnt(4)
    v_mfma_f32_32x32x16_bf16 v[32:47], v[136:139], a[240:243], v[32:47]
    ds_read_b64_tr_b16 a[232:233], v96 offset:10240
    ds_read_b64_tr_b16 a[234:235], v96 offset:11264
    s_lshr_b32 s58, s41, 2
    s_lshl_b32 s58, s58, 7
    s_add_u32 s44, s44, s58
    v_mfma_f32_32x32x16_bf16 v[48:63], v[136:139], a[244:247], v[48:63]
    ds_read_b64_tr_b16 a[236:237], v97 offset:10240
    ds_read_b64_tr_b16 a[238:239], v97 offset:11264
    s_lshl_b32 s45, s79, 9
    s_lshl_b32 s76, s40, 4
    s_add_u32 s45, s45, s76
    v_mfma_f32_32x32x16_bf16 v[32:47], v[140:143], a[248:251], v[32:47]
    ds_read_b64_tr_b16 a[240:241], v96 offset:12288
    ds_read_b64_tr_b16 a[242:243], v96 offset:13312
    global_load_dword v99, v120, s[60:61]
    s_add_u32 s45, s45, 15401216
    v_mfma_f32_32x32x16_bf16 v[48:63], v[140:143], a[252:255], v[48:63]
    ds_read_b64_tr_b16 a[244:245], v97 offset:12288
    ds_read_b64_tr_b16 a[246:247], v97 offset:13312
    v_lshrrev_b32 v29, 4, v7
    v_mov_b32 v30, 2146435072
    s_waitcnt lgkmcnt(4)
    v_mfma_f32_32x32x16_bf16 v[32:47], v[144:147], a[224:227], v[32:47]
    ds_read_b64_tr_b16 a[248:249], v96 offset:14336
    ds_read_b64_tr_b16 a[250:251], v96 offset:15360
    s_add_u32 m0, s55, 14336
    s_add_u32 s57, s49, s54
    s_lshr_b32 s100, s41, 4
    v_mfma_f32_32x32x16_bf16 v[48:63], v[144:147], a[228:231], v[48:63]
    ds_read_b64_tr_b16 a[252:253], v97 offset:14336
    ds_read_b64_tr_b16 a[254:255], v97 offset:15360
    buffer_load_dwordx4 v240, s[12:15], s57 offen offset:0 lds
    s_lshl_b32 s86, s42, 1
    v_mfma_f32_32x32x16_bf16 v[32:47], v[148:151], a[232:235], v[32:47]
    ds_read_b64_tr_b16 a[224:225], v96 offset:16384
    ds_read_b64_tr_b16 a[226:227], v96 offset:17408
    s_add_u32 s86, s86, s100
    s_and_b32 s100, s41, 15
    s_lshl_b32 s100, s100, 2
    v_mfma_f32_32x32x16_bf16 v[48:63], v[148:151], a[236:239], v[48:63]
    ds_read_b64_tr_b16 a[228:229], v97 offset:16384
    ds_read_b64_tr_b16 a[230:231], v97 offset:17408
    s_add_u32 s87, s100, s40
    s_mul_i32 s88, s40, 3
    s_waitcnt lgkmcnt(4)
    v_mfma_f32_32x32x16_bf16 v[32:47], v[152:155], a[240:243], v[32:47]
    ds_read_b64_tr_b16 a[232:233], v96 offset:18432
    ds_read_b64_tr_b16 a[234:235], v96 offset:19456
    buffer_load_dwordx4 v241, s[12:15], s57 offen offset:1024 lds
    s_add_u32 s88, s88, s100
    v_mfma_f32_32x32x16_bf16 v[48:63], v[152:155], a[244:247], v[48:63]
    ds_read_b64_tr_b16 a[236:237], v97 offset:18432
    ds_read_b64_tr_b16 a[238:239], v97 offset:19456
    s_sub_u32 s88, s88, 8
    s_mul_i32 s100, s87, 28928
    s_mul_i32 s101, s86, 1792
    v_mfma_f32_32x32x16_bf16 v[32:47], v[156:159], a[248:251], v[32:47]
    ds_read_b64_tr_b16 a[240:241], v96 offset:20480
    ds_read_b64_tr_b16 a[242:243], v96 offset:21504
    buffer_load_dwordx4 v242, s[12:15], s57 offen offset:2048 lds
    s_add_u32 s96, s100, s101
    v_mfma_f32_32x32x16_bf16 v[48:63], v[156:159], a[252:255], v[48:63]
    ds_read_b64_tr_b16 a[244:245], v97 offset:20480
    ds_read_b64_tr_b16 a[246:247], v97 offset:21504
    s_mul_i32 s100, s87, 33024
    s_lshl_b32 s101, s86, 11
    s_waitcnt lgkmcnt(4)
    v_mfma_f32_32x32x16_bf16 v[32:47], v[160:163], a[224:227], v[32:47]
    ds_read_b64_tr_b16 a[248:249], v96 offset:22528
    ds_read_b64_tr_b16 a[250:251], v96 offset:23552
    buffer_load_dwordx4 v243, s[12:15], s57 offen offset:3072 lds
    s_add_u32 s100, s100, s101
    s_nop 0
    v_mfma_f32_32x32x16_bf16 v[48:63], v[160:163], a[228:231], v[48:63]
    ds_read_b64_tr_b16 a[252:253], v97 offset:22528
    ds_read_b64_tr_b16 a[254:255], v97 offset:23552
    s_add_u32 m0, s55, 18432
    s_add_u32 s57, s57, 458752
    s_add_u32 s43, s100, 5701632
    v_mfma_f32_32x32x16_bf16 v[32:47], v[164:167], a[232:235], v[32:47]
    ds_read_b64_tr_b16 a[224:225], v96 offset:24576
    ds_read_b64_tr_b16 a[226:227], v96 offset:25600
    buffer_load_dwordx4 v240, s[12:15], s57 offen offset:0 lds
    s_lshl_b32 s100, s87, 9
    v_mfma_f32_32x32x16_bf16 v[48:63], v[164:167], a[236:239], v[48:63]
    ds_read_b64_tr_b16 a[228:229], v97 offset:24576
    ds_read_b64_tr_b16 a[230:231], v97 offset:25600
    s_lshl_b32 s101, s86, 2
    s_add_u32 s100, s100, s101
    s_waitcnt lgkmcnt(4)
    v_mfma_f32_32x32x16_bf16 v[32:47], v[168:171], a[240:243], v[32:47]
    ds_read_b64_tr_b16 a[232:233], v96 offset:26624
    ds_read_b64_tr_b16 a[234:235], v96 offset:27648
    buffer_load_dwordx4 v241, s[12:15], s57 offen offset:1024 lds
    s_add_u32 s3, s100, 15401216
    v_mfma_f32_32x32x16_bf16 v[48:63], v[168:171], a[244:247], v[48:63]
    ds_read_b64_tr_b16 a[236:237], v97 offset:26624
    ds_read_b64_tr_b16 a[238:239], v97 offset:27648
    s_waitcnt vmcnt(15) lgkmcnt(0)
    s_barrier
    v_mfma_f32_32x32x16_bf16 v[32:47], v[172:175], a[248:251], v[32:47]
    ds_read_b64_tr_b16 a[240:241], v1 offset:0
    ds_read_b64_tr_b16 a[242:243], v1 offset:28672
    buffer_load_dwordx4 v242, s[12:15], s57 offen offset:2048 lds
    s_mul_i32 s100, s86, 28
    s_nop 0
    v_mfma_f32_32x32x16_bf16 v[48:63], v[172:175], a[252:255], v[48:63]
    ds_read_b64_tr_b16 a[244:245], v2 offset:0
    ds_read_b64_tr_b16 a[246:247], v2 offset:28672
    v_readlane_b32 s56, v31, 0
    s_add_u32 m0, s62, 32768
    v_mfma_f32_32x32x16_bf16 v[32:47], v[176:179], a[224:227], v[32:47]
    ds_read_b64_tr_b16 a[248:249], v3 offset:0
    ds_read_b64_tr_b16 a[250:251], v3 offset:28672
    s_nop 0
    buffer_load_dwordx4 v248, s[20:23], s56 offen offset:0 lds
    s_add_u32 s101, s100, 27
    v_mfma_f32_32x32x16_bf16 v[48:63], v[176:179], a[228:231], v[48:63]
    ds_read_b64_tr_b16 a[252:253], v4 offset:0
    ds_read_b64_tr_b16 a[254:255], v4 offset:28672
    s_lshr_b32 s100, s100, 6
    s_lshr_b32 s101, s101, 6
    v_lshrrev_b32_e64 v24, 2, v29
    v_mfma_f32_32x32x16_bf16 v[32:47], v[180:183], a[232:235], v[32:47]
    ds_read_b64_tr_b16 a[224:225], v1 offset:1024
    ds_read_b64_tr_b16 a[226:227], v1 offset:29696
    buffer_load_dwordx4 v249, s[20:23], s56 offen offset:1024 lds
    v_add_u32_e64 v24, s88, v24
    v_mfma_f32_32x32x16_bf16 v[48:63], v[180:183], a[236:239], v[48:63]
    ds_read_b64_tr_b16 a[228:229], v2 offset:1024
    ds_read_b64_tr_b16 a[230:231], v2 offset:29696
    v_bfe_u32 v25, v29, 1, 1
    v_mad_u32_u24 v25, v25, 7, 7
    v_cmp_gt_u32 s[90:91], 12, v29
    s_waitcnt lgkmcnt(4)
    v_mfma_f32_32x32x16_bf16 v[32:47], v[184:187], a[240:243], v[32:47]
    ds_read_b64_tr_b16 a[232:233], v3 offset:1024
    ds_read_b64_tr_b16 a[234:235], v3 offset:29696
    buffer_load_dwordx4 v250, s[20:23], s56 offen offset:2048 lds
    v_mov_b32 v26, s87
    v_mfma_f32_32x32x16_bf16 v[48:63], v[184:187], a[244:247], v[48:63]
    ds_read_b64_tr_b16 a[236:237], v4 offset:1024
    ds_read_b64_tr_b16 a[238:239], v4 offset:29696
    v_and_b32_e64 v27, 1, v29
    v_cndmask_b32 v24, v26, v24, s[90:91]
    v_cndmask_b32 v25, 0, v25, s[90:91]
    v_cmp_eq_u32 s[90:91], 1, v27
    v_mfma_f32_32x32x16_bf16 v[32:47], v[188:191], a[248:251], v[32:47]
    ds_read_b64_tr_b16 a[240:241], v1 offset:2048
    ds_read_b64_tr_b16 a[242:243], v1 offset:30720
    buffer_load_dwordx4 v251, s[20:23], s56 offen offset:3072 lds
    v_mov_b32_e64 v26, s100
    v_mfma_f32_32x32x16_bf16 v[48:63], v[188:191], a[252:255], v[48:63]
    ds_read_b64_tr_b16 a[244:245], v2 offset:2048
    ds_read_b64_tr_b16 a[246:247], v2 offset:30720
    v_readlane_b32 s56, v31, 1
    s_add_u32 m0, s62, 0
    s_waitcnt lgkmcnt(4)
    v_mfma_f32_32x32x16_bf16 v[32:47], v[192:195], a[224:227], v[32:47]
    ds_read_b64_tr_b16 a[248:249], v3 offset:2048
    ds_read_b64_tr_b16 a[250:251], v3 offset:30720
    buffer_load_dwordx4 v248, s[20:23], s56 offen offset:0 lds
    v_mov_b32_e64 v28, s101
    v_mfma_f32_32x32x16_bf16 v[48:63], v[192:195], a[228:231], v[48:63]
    ds_read_b64_tr_b16 a[252:253], v4 offset:2048
    ds_read_b64_tr_b16 a[254:255], v4 offset:30720
    v_cndmask_b32 v26, v26, v28, s[90:91]
    v_cmp_gt_u32 s[90:91], 14, v29
    v_cmp_le_i32 s[76:77], 0, v24
    v_add_u32_e64 v25, v25, v26
    v_mfma_f32_32x32x16_bf16 v[32:47], v[196:199], a[232:235], v[32:47]
    ds_read_b64_tr_b16 a[224:225], v1 offset:3072
    ds_read_b64_tr_b16 a[226:227], v1 offset:31744
    v_lshlrev_b32 v24, 9, v24
    v_lshl_add_u32 v24, v25, 2, v24
    s_and_b64 s[90:91], s[90:91], s[76:77]
    v_mfma_f32_32x32x16_bf16 v[48:63], v[196:199], a[236:239], v[48:63]
    ds_read_b64_tr_b16 a[228:229], v2 offset:3072
    ds_read_b64_tr_b16 a[230:231], v2 offset:31744
    buffer_load_dwordx4 v249, s[20:23], s56 offen offset:1024 lds
    s_waitcnt lgkmcnt(4)
    v_mfma_f32_32x32x16_bf16 v[32:47], v[200:203], a[240:243], v[32:47]
    ds_read_b64_tr_b16 a[232:233], v3 offset:3072
    ds_read_b64_tr_b16 a[234:235], v3 offset:31744
    v_add_u32 v24, 15400960, v24
    v_cndmask_b32 v244, v30, v24, s[90:91]
    s_add_u32 s100, s88, 0
    v_mfma_f32_32x32x16_bf16 v[48:63], v[200:203], a[244:247], v[48:63]
    ds_read_b64_tr_b16 a[236:237], v4 offset:3072
    ds_read_b64_tr_b16 a[238:239], v4 offset:31744
    buffer_load_dwordx4 v250, s[20:23], s56 offen offset:2048 lds
    s_mul_i32 s101, s100, 28928
    v_mfma_f32_32x32x16_bf16 v[32:47], v[204:207], a[248:251], v[32:47]
    ds_read_b64_tr_b16 a[240:241], v1 offset:4096
    ds_read_b64_tr_b16 a[242:243], v1 offset:32768
    s_mul_i32 s80, s86, 1792
    s_add_u32 s80, s80, s101
    s_add_u32 s80, s80, 1900544
    v_mfma_f32_32x32x16_bf16 v[48:63], v[204:207], a[252:255], v[48:63]
    ds_read_b64_tr_b16 a[244:245], v2 offset:4096
    ds_read_b64_tr_b16 a[246:247], v2 offset:32768
    buffer_load_dwordx4 v251, s[20:23], s56 offen offset:3072 lds
    s_waitcnt lgkmcnt(4)
    v_mfma_f32_32x32x16_bf16 v[32:47], v[208:211], a[224:227], v[32:47]
    ds_read_b64_tr_b16 a[248:249], v3 offset:4096
    ds_read_b64_tr_b16 a[250:251], v3 offset:32768
    v_readlane_b32 s56, v31, 2
    s_add_u32 m0, s62, 16384
    s_mul_i32 s81, s86, 448
    v_mfma_f32_32x32x16_bf16 v[48:63], v[208:211], a[228:231], v[48:63]
    ds_read_b64_tr_b16 a[252:253], v4 offset:4096
    ds_read_b64_tr_b16 a[254:255], v4 offset:32768
    buffer_load_dwordx4 v248, s[20:23], s56 offen offset:0 lds
    s_add_u32 s81, s81, s101
    v_mfma_f32_32x32x16_bf16 v[32:47], v[212:215], a[232:235], v[32:47]
    ds_read_b64_tr_b16 a[224:225], v1 offset:5120
    ds_read_b64_tr_b16 a[226:227], v1 offset:33792
    s_add_u32 s81, s81, 3801088
    s_cmp_lt_i32 s100, 0
    s_cselect_b32 s80, 15532032, s80
    s_cselect_b32 s81, 15532032, s81
    v_mfma_f32_32x32x16_bf16 v[48:63], v[212:215], a[236:239], v[48:63]
    ds_read_b64_tr_b16 a[228:229], v2 offset:5120
    ds_read_b64_tr_b16 a[230:231], v2 offset:33792
    buffer_load_dwordx4 v249, s[20:23], s56 offen offset:1024 lds
    s_waitcnt lgkmcnt(4)
    v_mfma_f32_32x32x16_bf16 v[32:47], v[216:219], a[240:243], v[32:47]
    ds_read_b64_tr_b16 a[232:233], v3 offset:5120
    ds_read_b64_tr_b16 a[234:235], v3 offset:33792
    s_waitcnt vmcnt(18)
    v_cmp_eq_u32 vcc, 0, v255
    s_cbranch_vccnz Lslow_1
Lback_2:
    v_mfma_f32_32x32x16_bf16 v[48:63], v[216:219], a[244:247], v[48:63]
    ds_read_b64_tr_b16 a[236:237], v4 offset:5120
    ds_read_b64_tr_b16 a[238:239], v4 offset:33792
    buffer_load_dwordx4 v250, s[20:23], s56 offen offset:2048 lds
    s_add_u32 s100, s88, 1
    v_mfma_f32_32x32x16_bf16 v[32:47], v[220:223], a[248:251], v[32:47]
    ds_read_b64_tr_b16 a[240:241], v1 offset:6144
    ds_read_b64_tr_b16 a[242:243], v1 offset:34816
    s_mul_i32 s101, s100, 28928
    s_mul_i32 s82, s86, 1792
    s_add_u32 s82, s82, s101
    v_mfma_f32_32x32x16_bf16 v[48:63], v[220:223], a[252:255], v[48:63]
    ds_read_b64_tr_b16 a[244:245], v2 offset:6144
    ds_read_b64_tr_b16 a[246:247], v2 offset:34816
    buffer_load_dwordx4 v251, s[20:23], s56 offen offset:3072 lds
    s_waitcnt lgkmcnt(4)
    v_mfma_f32_32x32x16_bf16 v[32:47], v[224:227], a[224:227], v[32:47]
    ds_read_b64_tr_b16 a[248:249], v3 offset:6144
    ds_read_b64_tr_b16 a[250:251], v3 offset:34816
    s_add_u32 s82, s82, 1900544
    s_mul_i32 s83, s86, 448
    s_add_u32 s83, s83, s101
    v_mfma_f32_32x32x16_bf16 v[48:63], v[224:227], a[228:231], v[48:63]
    ds_read_b64_tr_b16 a[252:253], v4 offset:6144
    ds_read_b64_tr_b16 a[254:255], v4 offset:34816
    s_barrier
    s_add_u32 m0, s55, 21504
    s_add_u32 s57, s49, s53
    v_mfma_f32_32x32x16_bf16 v[32:47], v[228:231], a[232:235], v[32:47]
    ds_read_b64_tr_b16 a[224:225], v1 offset:7168
    ds_read_b64_tr_b16 a[226:227], v1 offset:35840
    buffer_load_dwordx4 v240, s[16:19], s57 offen offset:0 lds
    s_add_u32 s83, s83, 3801088
    v_mfma_f32_32x32x16_bf16 v[48:63], v[228:231], a[236:239], v[48:63]
    ds_read_b64_tr_b16 a[228:229], v2 offset:7168
    ds_read_b64_tr_b16 a[230:231], v2 offset:35840
    s_cmp_lt_i32 s100, 0
    s_cselect_b32 s82, 15532032, s82
    s_cselect_b32 s83, 15532032, s83
    s_waitcnt lgkmcnt(4)
    v_mfma_f32_32x32x16_bf16 v[32:47], v[232:235], a[240:243], v[32:47]
    ds_read_b64_tr_b16 a[232:233], v3 offset:7168
    ds_read_b64_tr_b16 a[234:235], v3 offset:35840
    buffer_load_dwordx4 v241, s[16:19], s57 offen offset:1024 lds
    s_add_u32 s100, s88, 2
    v_mfma_f32_32x32x16_bf16 v[48:63], v[232:235], a[244:247], v[48:63]
    ds_read_b64_tr_b16 a[236:237], v4 offset:7168
    ds_read_b64_tr_b16 a[238:239], v4 offset:35840
    s_mul_i32 s101, s100, 28928
    s_mul_i32 s84, s86, 1792
    s_add_u32 s84, s84, s101
    v_mfma_f32_32x32x16_bf16 v[32:47], v[236:239], a[248:251], v[32:47]
    ds_read_b64_tr_b16 a[240:241], v1 offset:8192
    ds_read_b64_tr_b16 a[242:243], v1 offset:36864
    buffer_load_dwordx4 v242, s[16:19], s57 offen offset:2048 lds
    s_add_u32 s84, s84, 1900544
    v_mfma_f32_32x32x16_bf16 v[48:63], v[236:239], a[252:255], v[48:63]
    ds_read_b64_tr_b16 a[244:245], v2 offset:8192
    ds_read_b64_tr_b16 a[246:247], v2 offset:36864
    s_mul_i32 s85, s86, 448
    s_add_u32 s85, s85, s101
    s_waitcnt lgkmcnt(4)
    v_mfma_f32_32x32x16_bf16 v[64:79], a[224:227], v[128:131], 0
    ds_read_b64_tr_b16 a[248:249], v3 offset:8192
    ds_read_b64_tr_b16 a[250:251], v3 offset:36864
    buffer_load_dwordx4 v243, s[16:19], s57 offen offset:3072 lds
    s_add_u32 s85, s85, 3801088
    v_mfma_f32_32x32x16_bf16 v[80:95], a[228:231], v[128:131], 0
    ds_read_b64_tr_b16 a[252:253], v4 offset:8192
    ds_read_b64_tr_b16 a[254:255], v4 offset:36864
    s_add_u32 m0, s55, 25600
    s_add_u32 s57, s57, 458752
    v_mfma_f32_32x32x16_bf16 v[64:79], a[232:235], v[132:135], v[64:79]
    ds_read_b64_tr_b16 a[224:225], v1 offset:9216
    ds_read_b64_tr_b16 a[226:227], v1 offset:37888
    buffer_load_dwordx4 v240, s[16:19], s57 offen offset:0 lds
    v_mfma_f32_32x32x16_bf16 v[80:95], a[236:239], v[132:135], v[80:95]
    ds_read_b64_tr_b16 a[228:229], v2 offset:9216
    ds_read_b64_tr_b16 a[230:231], v2 offset:37888
    v_mul_f32 v32, v100, v32
    v_mul_f32 v33, v101, v33
    v_mul_f32 v34, v102, v34
    s_waitcnt lgkmcnt(4)
    v_mfma_f32_32x32x16_bf16 v[64:79], a[240:243], v[136:139], v[64:79]
    ds_read_b64_tr_b16 a[232:233], v3 offset:9216
    ds_read_b64_tr_b16 a[234:235], v3 offset:37888
    buffer_load_dwordx4 v241, s[16:19], s57 offen offset:1024 lds
    v_mul_f32_e64 v35, v103, v35
    v_mfma_f32_32x32x16_bf16 v[80:95], a[244:247], v[136:139], v[80:95]
    ds_read_b64_tr_b16 a[236:237], v4 offset:9216
    ds_read_b64_tr_b16 a[238:239], v4 offset:37888
    v_mul_f32 v36, v104, v36
    v_mul_f32 v37, v105, v37
    v_mul_f32 v38, v106, v38
    v_mul_f32 v39, v107, v39
    v_mfma_f32_32x32x16_bf16 v[64:79], a[248:251], v[140:143], v[64:79]
    ds_read_b64_tr_b16 a[240:241], v1 offset:10240
    ds_read_b64_tr_b16 a[242:243], v1 offset:38912
    buffer_load_dwordx4 v242, s[16:19], s57 offen offset:2048 lds
    v_cvt_pk_bf16_f32 v32, v32, v33
    v_mfma_f32_32x32x16_bf16 v[80:95], a[252:255], v[140:143], v[80:95]
    ds_read_b64_tr_b16 a[244:245], v2 offset:10240
    ds_read_b64_tr_b16 a[246:247], v2 offset:38912
    v_cvt_pk_bf16_f32 v33, v34, v35
    v_cvt_pk_bf16_f32 v34, v36, v37
    v_cvt_pk_bf16_f32 v35, v38, v39
    s_waitcnt lgkmcnt(4)
    v_mfma_f32_32x32x16_bf16 v[64:79], a[224:227], v[144:147], v[64:79]
    ds_read_b64_tr_b16 a[248:249], v3 offset:10240
    ds_read_b64_tr_b16 a[250:251], v3 offset:38912
    s_waitcnt vmcnt(15)
    ds_read_b64_tr_b16 a[0:1], v5 offset:32768
    ds_read_b64_tr_b16 a[2:3], v5 offset:33792
    ds_read_b64_tr_b16 a[4:5], v6 offset:32768
    v_mfma_f32_32x32x16_bf16 v[80:95], a[228:231], v[144:147], v[80:95]
    ds_read_b64_tr_b16 a[252:253], v4 offset:10240
    ds_read_b64_tr_b16 a[254:255], v4 offset:38912
    ds_read_b64_tr_b16 a[6:7], v6 offset:33792
    ds_read_b64_tr_b16 a[8:9], v5 offset:34816
    ds_read_b64_tr_b16 a[10:11], v5 offset:35840
    ds_read_b64_tr_b16 a[12:13], v6 offset:34816
    v_mfma_f32_32x32x16_bf16 v[64:79], a[232:235], v[148:151], v[64:79]
    ds_read_b64_tr_b16 a[224:225], v1 offset:11264
    ds_read_b64_tr_b16 a[226:227], v1 offset:39936
    buffer_store_dwordx4 v[32:35], v246, s[28:31], s63 offen offset:0 sc1
    ds_read_b64_tr_b16 a[14:15], v6 offset:35840
    v_mfma_f32_32x32x16_bf16 v[80:95], a[236:239], v[148:151], v[80:95]
    ds_read_b64_tr_b16 a[228:229], v2 offset:11264
    ds_read_b64_tr_b16 a[230:231], v2 offset:39936
    v_mul_f32 v40, v108, v40
    v_mul_f32 v41, v109, v41
    v_mul_f32 v42, v110, v42
    s_waitcnt lgkmcnt(9)
    v_mfma_f32_32x32x16_bf16 v[64:79], a[240:243], v[152:155], v[64:79]
    ds_read_b64_tr_b16 a[232:233], v3 offset:11264
    ds_read_b64_tr_b16 a[234:235], v3 offset:39936
    v_mul_f32 v43, v111, v43
    v_mul_f32 v44, v112, v44
    v_mul_f32 v45, v113, v45
    v_mul_f32 v46, v114, v46
    v_mfma_f32_32x32x16_bf16 v[80:95], a[244:247], v[152:155], v[80:95]
    ds_read_b64_tr_b16 a[236:237], v4 offset:11264
    ds_read_b64_tr_b16 a[238:239], v4 offset:39936
    v_mul_f32_e64 v47, v115, v47
    v_cvt_pk_bf16_f32 v40, v40, v41
    v_mfma_f32_32x32x16_bf16 v[64:79], a[248:251], v[156:159], v[64:79]
    ds_read_b64_tr_b16 a[240:241], v1 offset:12288
    ds_read_b64_tr_b16 a[242:243], v1 offset:40960
    v_cvt_pk_bf16_f32 v41, v42, v43
    s_cmp_lt_i32 s100, 0
    s_nop 0
    s_cselect_b32 s84, 15532032, s84
    s_cselect_b32 s85, 15532032, s85
    v_mfma_f32_32x32x16_bf16 v[80:95], a[252:255], v[156:159], v[80:95]
    ds_read_b64_tr_b16 a[244:245], v2 offset:12288
    ds_read_b64_tr_b16 a[246:247], v2 offset:40960
    v_readlane_b32 s56, v31, 3
    s_waitcnt lgkmcnt(10)
    s_add_u32 m0, s62, 32768
    s_waitcnt lgkmcnt(4)
    v_mfma_f32_32x32x16_bf16 v[64:79], a[224:227], v[160:163], v[64:79]
    ds_read_b64_tr_b16 a[248:249], v3 offset:12288
    ds_read_b64_tr_b16 a[250:251], v3 offset:40960
    buffer_load_dwordx4 v248, s[20:23], s56 offen offset:0 lds
    v_cvt_pk_bf16_f32 v42, v44, v45
    v_mfma_f32_32x32x16_bf16 v[80:95], a[228:231], v[160:163], v[80:95]
    ds_read_b64_tr_b16 a[252:253], v4 offset:12288
    ds_read_b64_tr_b16 a[254:255], v4 offset:40960
    v_cvt_pk_bf16_f32 v43, v46, v47
    v_mul_f32 v48, v100, v48
    v_mul_f32 v49, v101, v49
    v_mfma_f32_32x32x16_bf16 v[64:79], a[232:235], v[164:167], v[64:79]
    ds_read_b64_tr_b16 a[224:225], v1 offset:13312
    ds_read_b64_tr_b16 a[226:227], v1 offset:41984
    buffer_load_dwordx4 v249, s[20:23], s56 offen offset:1024 lds
    v_mul_f32_e64 v50, v102, v50
    v_mfma_f32_32x32x16_bf16 v[80:95], a[236:239], v[164:167], v[80:95]
    ds_read_b64_tr_b16 a[228:229], v2 offset:13312
    ds_read_b64_tr_b16 a[230:231], v2 offset:41984
    v_mul_f32_e64 v51, v103, v51
    v_mul_f32 v52, v104, v52
    s_waitcnt lgkmcnt(4)
    v_mfma_f32_32x32x16_bf16 v[64:79], a[240:243], v[168:171], v[64:79]
    ds_read_b64_tr_b16 a[232:233], v3 offset:13312
    ds_read_b64_tr_b16 a[234:235], v3 offset:41984
    buffer_store_dwordx4 v[40:43], v246, s[28:31], s64 offen offset:0 sc1
    v_mul_f32 v53, v105, v53
    v_mfma_f32_32x32x16_bf16 v[80:95], a[244:247], v[168:171], v[80:95]
    ds_read_b64_tr_b16 a[236:237], v4 offset:13312
    ds_read_b64_tr_b16 a[238:239], v4 offset:41984
    s_barrier
    v_mfma_f32_32x32x16_bf16 v[64:79], a[248:251], v[172:175], v[64:79]
    ds_read_b64_tr_b16 a[240:241], v1 offset:14336
    ds_read_b64_tr_b16 a[242:243], v1 offset:43008
    buffer_load_dwordx4 v250, s[20:23], s56 offen offset:2048 lds
    v_mul_f32_e64 v54, v106, v54
    v_mfma_f32_32x32x16_bf16 v[80:95], a[252:255], v[172:175], v[80:95]
    ds_read_b64_tr_b16 a[244:245], v2 offset:14336
    ds_read_b64_tr_b16 a[246:247], v2 offset:43008
    v_mul_f32 v55, v107, v55
    v_cvt_pk_bf16_f32 v48, v48, v49
    v_cvt_pk_bf16_f32 v49, v50, v51
    s_waitcnt lgkmcnt(4)
    v_mfma_f32_32x32x16_bf16 v[64:79], a[224:227], v[176:179], v[64:79]
    ds_read_b64_tr_b16 a[248:249], v3 offset:14336
    ds_read_b64_tr_b16 a[250:251], v3 offset:43008
    buffer_load_dwordx4 v251, s[20:23], s56 offen offset:3072 lds
    v_cvt_pk_bf16_f32 v50, v52, v53
    v_mfma_f32_32x32x16_bf16 v[80:95], a[228:231], v[176:179], v[80:95]
    ds_read_b64_tr_b16 a[252:253], v4 offset:14336
    ds_read_b64_tr_b16 a[254:255], v4 offset:43008
    s_add_u32 m0, s55, 0
    s_add_u32 s57, s49, s54
    v_cvt_pk_bf16_f32 v51, v54, v55
    v_mfma_f32_32x32x16_bf16 v[64:79], a[232:235], v[180:183], v[64:79]
    ds_read_b64_tr_b16 a[224:225], v1 offset:15360
    ds_read_b64_tr_b16 a[226:227], v1 offset:44032
    buffer_load_dwordx4 v240, s[16:19], s57 offen offset:0 lds
    v_mul_f32_e64 v56, v108, v56
    v_mfma_f32_32x32x16_bf16 v[80:95], a[236:239], v[180:183], v[80:95]
    ds_read_b64_tr_b16 a[228:229], v2 offset:15360
    ds_read_b64_tr_b16 a[230:231], v2 offset:44032
    v_mul_f32 v57, v109, v57
    v_mul_f32 v58, v110, v58
    v_mul_f32 v59, v111, v59
    s_waitcnt lgkmcnt(4)
    v_mfma_f32_32x32x16_bf16 v[64:79], a[240:243], v[184:187], v[64:79]
    ds_read_b64_tr_b16 a[232:233], v3 offset:15360
    ds_read_b64_tr_b16 a[234:235], v3 offset:44032
    buffer_store_dwordx4 v[48:51], v246, s[28:31], s63 offen offset:512 sc1
    v_mul_f32_e64 v60, v112, v60
    v_mfma_f32_32x32x16_bf16 v[80:95], a[244:247], v[184:187], v[80:95]
    ds_read_b64_tr_b16 a[236:237], v4 offset:15360
    ds_read_b64_tr_b16 a[238:239], v4 offset:44032
    v_mul_f32 v61, v113, v61
    s_cmp_lt_i32 s88, 0
    s_cselect_b32 s86, 0xf149, 0
    v_mfma_f32_32x32x16_bf16 v[64:79], a[248:251], v[188:191], v[64:79]
    ds_read_b64_tr_b16 a[240:241], v1 offset:16384
    ds_read_b64_tr_b16 a[242:243], v1 offset:45056
    buffer_load_dwordx4 v241, s[16:19], s57 offen offset:1024 lds
    v_mul_f32_e64 v62, v114, v62
    v_mfma_f32_32x32x16_bf16 v[80:95], a[252:255], v[188:191], v[80:95]
    ds_read_b64_tr_b16 a[244:245], v2 offset:16384
    ds_read_b64_tr_b16 a[246:247], v2 offset:45056
    v_mul_f32_e64 v63, v115, v63
    s_cmp_lt_i32 s88, -1
    s_cselect_b32 s87, 0xf149, 0
    s_waitcnt lgkmcnt(4)
    v_mfma_f32_32x32x16_bf16 v[64:79], a[224:227], v[192:195], v[64:79]
    ds_read_b64_tr_b16 a[248:249], v3 offset:16384
    ds_read_b64_tr_b16 a[250:251], v3 offset:45056
    buffer_load_dwordx4 v242, s[16:19], s57 offen offset:2048 lds
    v_cvt_pk_bf16_f32 v56, v56, v57
    v_mfma_f32_32x32x16_bf16 v[80:95], a[228:231], v[192:195], v[80:95]
    ds_read_b64_tr_b16 a[252:253], v4 offset:16384
    ds_read_b64_tr_b16 a[254:255], v4 offset:45056
    v_cvt_pk_bf16_f32 v57, v58, v59
    s_cmp_lt_i32 s88, -2
    s_nop 0
    s_cselect_b32 s88, 0xf149, 0
    v_mfma_f32_32x32x16_bf16 v[64:79], a[232:235], v[196:199], v[64:79]
    ds_read_b64_tr_b16 a[224:225], v1 offset:17408
    ds_read_b64_tr_b16 a[226:227], v1 offset:46080
    buffer_load_dwordx4 v243, s[16:19], s57 offen offset:3072 lds
    v_cvt_pk_bf16_f32 v58, v60, v61
    v_mfma_f32_32x32x16_bf16 v[80:95], a[236:239], v[196:199], v[80:95]
    ds_read_b64_tr_b16 a[228:229], v2 offset:17408
    ds_read_b64_tr_b16 a[230:231], v2 offset:46080
    s_add_u32 m0, s55, 4096
    s_add_u32 s57, s57, 458752
    s_waitcnt lgkmcnt(4)
    v_mfma_f32_32x32x16_bf16 v[64:79], a[240:243], v[200:203], v[64:79]
    ds_read_b64_tr_b16 a[232:233], v3 offset:17408
    ds_read_b64_tr_b16 a[234:235], v3 offset:46080
    buffer_load_dwordx4 v240, s[16:19], s57 offen offset:0 lds
    v_cvt_pk_bf16_f32 v59, v62, v63
    v_mfma_f32_32x32x16_bf16 v[80:95], a[244:247], v[200:203], v[80:95]
    ds_read_b64_tr_b16 a[236:237], v4 offset:17408
    ds_read_b64_tr_b16 a[238:239], v4 offset:46080
    s_waitcnt vmcnt(23)
    ds_read_b64_tr_b16 a[16:17], v5 offset:0
    ds_read_b64_tr_b16 a[18:19], v5 offset:1024
    ds_read_b64_tr_b16 a[20:21], v6 offset:0
    v_mfma_f32_32x32x16_bf16 v[64:79], a[248:251], v[204:207], v[64:79]
    ds_read_b64_tr_b16 a[240:241], v1 offset:18432
    ds_read_b64_tr_b16 a[242:243], v1 offset:47104
    ds_read_b64_tr_b16 a[22:23], v6 offset:1024
    ds_read_b64_tr_b16 a[24:25], v5 offset:2048
    ds_read_b64_tr_b16 a[26:27], v5 offset:3072
    ds_read_b64_tr_b16 a[28:29], v6 offset:2048
    v_mfma_f32_32x32x16_bf16 v[80:95], a[252:255], v[204:207], v[80:95]
    ds_read_b64_tr_b16 a[244:245], v2 offset:18432
    ds_read_b64_tr_b16 a[246:247], v2 offset:47104
    buffer_store_dwordx4 v[56:59], v246, s[28:31], s64 offen offset:512 sc1
    s_waitcnt lgkmcnt(11)
    v_mfma_f32_32x32x16_bf16 v[64:79], a[224:227], v[208:211], v[64:79]
    ds_read_b64_tr_b16 a[248:249], v3 offset:18432
    ds_read_b64_tr_b16 a[250:251], v3 offset:47104
    ds_read_b64_tr_b16 a[30:31], v6 offset:3072
    v_lshrrev_b32 v28, 4, v7
    v_lshrrev_b32 v29, 9, v7
    v_and_b32 v30, 31, v28
    v_mfma_f32_32x32x16_bf16 v[80:95], a[228:231], v[208:211], v[80:95]
    ds_read_b64_tr_b16 a[252:253], v4 offset:18432
    ds_read_b64_tr_b16 a[254:255], v4 offset:47104
    buffer_load_dwordx4 v241, s[16:19], s57 offen offset:1024 lds
    v_lshlrev_b32_e64 v24, 2, v29
    v_mfma_f32_32x32x16_bf16 v[64:79], a[232:235], v[212:215], v[64:79]
    ds_read_b64_tr_b16 a[224:225], v1 offset:19456
    ds_read_b64_tr_b16 a[226:227], v1 offset:48128
    v_sub_u32_e64 v24, v30, v24
    v_mov_b32 v25, 0x0000ffff
    v_mov_b32 v26, 0xffff0000
    v_cmp_le_i32 s[100:101], 0, v24
    v_mfma_f32_32x32x16_bf16 v[80:95], a[236:239], v[212:215], v[80:95]
    ds_read_b64_tr_b16 a[228:229], v2 offset:19456
    ds_read_b64_tr_b16 a[230:231], v2 offset:48128
    buffer_load_dwordx4 v242, s[16:19], s57 offen offset:2048 lds
    s_waitcnt lgkmcnt(4)
    v_mfma_f32_32x32x16_bf16 v[64:79], a[240:243], v[216:219], v[64:79]
    ds_read_b64_tr_b16 a[232:233], v3 offset:19456
    ds_read_b64_tr_b16 a[234:235], v3 offset:48128
    v_readlane_b32 s56, v31, 4
    s_add_u32 m0, s62, 0
    v_cmp_le_i32 s[76:77], 1, v24
    v_mfma_f32_32x32x16_bf16 v[80:95], a[244:247], v[216:219], v[80:95]
    ds_read_b64_tr_b16 a[236:237], v4 offset:19456
    ds_read_b64_tr_b16 a[238:239], v4 offset:48128
    buffer_load_dwordx4 v248, s[20:23], s56 offen offset:0 lds
    v_cndmask_b32 v8, 0, v25, s[100:101]
    v_mfma_f32_32x32x16_bf16 v[64:79], a[248:251], v[220:223], v[64:79]
    ds_read_b64_tr_b16 a[240:241], v1 offset:20480
    ds_read_b64_tr_b16 a[242:243], v1 offset:49152
    v_cndmask_b32 v27, 0, v26, s[76:77]
    v_cmp_le_i32 s[100:101], 2, v24
    v_cmp_le_i32 s[76:77], 3, v24
    v_or_b32 v8, v8, v27
    v_mfma_f32_32x32x16_bf16 v[80:95], a[252:255], v[220:223], v[80:95]
    ds_read_b64_tr_b16 a[244:245], v2 offset:20480
    ds_read_b64_tr_b16 a[246:247], v2 offset:49152
    buffer_load_dwordx4 v249, s[20:23], s56 offen offset:1024 lds
    s_waitcnt lgkmcnt(4)
    v_mfma_f32_32x32x16_bf16 v[64:79], a[224:227], v[224:227], v[64:79]
    ds_read_b64_tr_b16 a[248:249], v3 offset:20480
    ds_read_b64_tr_b16 a[250:251], v3 offset:49152
    v_cndmask_b32 v9, 0, v25, s[100:101]
    v_cndmask_b32 v27, 0, v26, s[76:77]
    v_cmp_le_i32 s[100:101], 8, v24
    v_cmp_le_i32 s[76:77], 9, v24
    v_mfma_f32_32x32x16_bf16 v[80:95], a[228:231], v[224:227], v[80:95]
    ds_read_b64_tr_b16 a[252:253], v4 offset:20480
    ds_read_b64_tr_b16 a[254:255], v4 offset:49152
    s_waitcnt vmcnt(17)
    s_barrier
    v_mfma_f32_32x32x16_bf16 v[64:79], a[232:235], v[228:231], v[64:79]
    ds_read_b64_tr_b16 a[224:225], v1 offset:21504
    ds_read_b64_tr_b16 a[226:227], v1 offset:50176
    buffer_load_dwordx4 v250, s[20:23], s56 offen offset:2048 lds
    v_or_b32_e64 v9, v9, v27
    v_mfma_f32_32x32x16_bf16 v[80:95], a[236:239], v[228:231], v[80:95]
    ds_read_b64_tr_b16 a[228:229], v2 offset:21504
    ds_read_b64_tr_b16 a[230:231], v2 offset:50176
    v_cndmask_b32 v10, 0, v25, s[100:101]
    v_cndmask_b32 v27, 0, v26, s[76:77]
    v_cmp_le_i32 s[100:101], 10, v24
    s_waitcnt lgkmcnt(4)
    s_nop 0
    v_mfma_f32_32x32x16_bf16 v[64:79], a[240:243], v[232:235], v[64:79]
    ds_read_b64_tr_b16 a[232:233], v3 offset:21504
    ds_read_b64_tr_b16 a[234:235], v3 offset:50176
    buffer_load_dwordx4 v251, s[20:23], s56 offen offset:3072 lds
    v_cmp_le_i32 s[76:77], 11, v24
    v_mfma_f32_32x32x16_bf16 v[80:95], a[244:247], v[232:235], v[80:95]
    ds_read_b64_tr_b16 a[236:237], v4 offset:21504
    ds_read_b64_tr_b16 a[238:239], v4 offset:50176
    s_add_u32 m0, s55, 7168
    s_add_u32 s57, s50, s53
    v_or_b32 v10, v10, v27
    v_mfma_f32_32x32x16_bf16 v[64:79], a[248:251], v[236:239], v[64:79]
    ds_read_b64_tr_b16 a[240:241], v1 offset:22528
    ds_read_b64_tr_b16 a[242:243], v1 offset:51200
    buffer_load_dwordx4 v240, s[12:15], s57 offen offset:0 lds
    v_cndmask_b32 v11, 0, v25, s[100:101]
    v_mfma_f32_32x32x16_bf16 v[80:95], a[252:255], v[236:239], v[80:95]
    ds_read_b64_tr_b16 a[244:245], v2 offset:22528
    ds_read_b64_tr_b16 a[246:247], v2 offset:51200
    v_cndmask_b32 v27, 0, v26, s[76:77]
    v_cmp_le_i32 s[100:101], 16, v24
    v_cmp_le_i32 s[76:77], 17, v24
    s_waitcnt lgkmcnt(4)
    v_mfma_f32_32x32x16_bf16 v[96:111], a[224:227], v[128:131], 0
    ds_read_b64_tr_b16 a[248:249], v3 offset:22528
    ds_read_b64_tr_b16 a[250:251], v3 offset:51200
    buffer_load_dwordx4 v241, s[12:15], s57 offen offset:1024 lds
    v_or_b32 v11, v11, v27
    v_mfma_f32_32x32x16_bf16 v[112:127], a[228:231], v[128:131], 0
    ds_read_b64_tr_b16 a[252:253], v4 offset:22528
    ds_read_b64_tr_b16 a[254:255], v4 offset:51200
    v_cndmask_b32 v12, 0, v25, s[100:101]
    v_cndmask_b32 v27, 0, v26, s[76:77]
    v_cmp_le_i32 s[100:101], 18, v24
    v_cmp_le_i32 s[76:77], 19, v24
    v_mfma_f32_32x32x16_bf16 v[96:111], a[232:235], v[132:135], v[96:111]
    ds_read_b64_tr_b16 a[224:225], v1 offset:23552
    ds_read_b64_tr_b16 a[226:227], v1 offset:52224
    buffer_load_dwordx4 v242, s[12:15], s57 offen offset:2048 lds
    v_or_b32_e64 v12, v12, v27
    v_mfma_f32_32x32x16_bf16 v[112:127], a[236:239], v[132:135], v[112:127]
    ds_read_b64_tr_b16 a[228:229], v2 offset:23552
    ds_read_b64_tr_b16 a[230:231], v2 offset:52224
    v_cndmask_b32 v13, 0, v25, s[100:101]
    v_cndmask_b32 v27, 0, v26, s[76:77]
    v_cmp_le_i32 s[100:101], 24, v24
    s_waitcnt lgkmcnt(4)
    s_nop 0
    v_mfma_f32_32x32x16_bf16 v[96:111], a[240:243], v[136:139], v[96:111]
    ds_read_b64_tr_b16 a[232:233], v3 offset:23552
    ds_read_b64_tr_b16 a[234:235], v3 offset:52224
    buffer_load_dwordx4 v243, s[12:15], s57 offen offset:3072 lds
    v_cmp_le_i32 s[76:77], 25, v24
    v_mfma_f32_32x32x16_bf16 v[112:127], a[244:247], v[136:139], v[112:127]
    ds_read_b64_tr_b16 a[236:237], v4 offset:23552
    ds_read_b64_tr_b16 a[238:239], v4 offset:52224
    s_add_u32 m0, s55, 11264
    s_add_u32 s57, s57, 458752
    v_mfma_f32_32x32x16_bf16 v[96:111], a[248:251], v[140:143], v[96:111]
    ds_read_b64_tr_b16 a[240:241], v1 offset:24576
    ds_read_b64_tr_b16 a[242:243], v1 offset:53248
    buffer_load_dwordx4 v240, s[12:15], s57 offen offset:0 lds
    ds_read_b64_tr_b16 a[32:33], v5 offset:16384
    v_mfma_f32_32x32x16_bf16 v[112:127], a[252:255], v[140:143], v[112:127]
    ds_read_b64_tr_b16 a[244:245], v2 offset:24576
    ds_read_b64_tr_b16 a[246:247], v2 offset:53248
    ds_read_b64_tr_b16 a[34:35], v5 offset:17408
    ds_read_b64_tr_b16 a[36:37], v6 offset:16384
    ds_read_b64_tr_b16 a[38:39], v6 offset:17408
    s_waitcnt lgkmcnt(8)
    v_mfma_f32_32x32x16_bf16 v[96:111], a[224:227], v[144:147], v[96:111]
    ds_read_b64_tr_b16 a[248:249], v3 offset:24576
    ds_read_b64_tr_b16 a[250:251], v3 offset:53248
    buffer_load_dwordx4 v241, s[12:15], s57 offen offset:1024 lds
    ds_read_b64_tr_b16 a[40:41], v5 offset:18432
    v_mfma_f32_32x32x16_bf16 v[112:127], a[228:231], v[144:147], v[112:127]
    ds_read_b64_tr_b16 a[252:253], v4 offset:24576
    ds_read_b64_tr_b16 a[254:255], v4 offset:53248
    s_waitcnt vmcnt(12)
    buffer_store_dword v255, v0, s[28:31], s69 offen sc1
    v_mfma_f32_32x32x16_bf16 v[96:111], a[232:235], v[148:151], v[96:111]
    ds_read_b64_tr_b16 a[224:225], v1 offset:25600
    ds_read_b64_tr_b16 a[226:227], v1 offset:54272
    ds_read_b64_tr_b16 a[42:43], v5 offset:19456
    ds_read_b64_tr_b16 a[44:45], v6 offset:18432
    ds_read_b64_tr_b16 a[46:47], v6 offset:19456
    v_or_b32_e64 v13, v13, v27
    v_mfma_f32_32x32x16_bf16 v[112:127], a[236:239], v[148:151], v[112:127]
    ds_read_b64_tr_b16 a[228:229], v2 offset:25600
    ds_read_b64_tr_b16 a[230:231], v2 offset:54272
    buffer_load_dwordx4 v242, s[12:15], s57 offen offset:2048 lds
    s_waitcnt lgkmcnt(7)
    v_mfma_f32_32x32x16_bf16 v[96:111], a[240:243], v[152:155], v[96:111]
    ds_read_b64_tr_b16 a[232:233], v3 offset:25600
    ds_read_b64_tr_b16 a[234:235], v3 offset:54272
    v_readlane_b32 s56, v31, 5
    s_waitcnt lgkmcnt(4)
    s_add_u32 m0, s62, 16384
    v_cndmask_b32 v14, 0, v25, s[100:101]
    v_mfma_f32_32x32x16_bf16 v[112:127], a[244:247], v[152:155], v[112:127]
    ds_read_b64_tr_b16 a[236:237], v4 offset:25600
    ds_read_b64_tr_b16 a[238:239], v4 offset:54272
    buffer_load_dwordx4 v248, s[20:23], s56 offen offset:0 lds
    v_cndmask_b32 v27, 0, v26, s[76:77]
    v_mfma_f32_32x32x16_bf16 v[96:111], a[248:251], v[156:159], v[96:111]
    ds_read_b64_tr_b16 a[240:241], v1 offset:26624
    ds_read_b64_tr_b16 a[242:243], v1 offset:55296
    ds_read_b64_tr_b16 a[48:49], v5 offset:32768
    ds_read_b64_tr_b16 a[50:51], v5 offset:33792
    ds_read_b64_tr_b16 a[52:53], v6 offset:32768
    v_mfma_f32_32x32x16_bf16 v[112:127], a[252:255], v[156:159], v[112:127]
    ds_read_b64_tr_b16 a[244:245], v2 offset:26624
    ds_read_b64_tr_b16 a[246:247], v2 offset:55296
    buffer_load_dwordx4 v249, s[20:23], s56 offen offset:1024 lds
    s_waitcnt lgkmcnt(7)
    s_nop 0
    v_mfma_f32_32x32x16_bf16 v[96:111], a[224:227], v[160:163], v[96:111]
    ds_read_b64_tr_b16 a[248:249], v3 offset:26624
    ds_read_b64_tr_b16 a[250:251], v3 offset:55296
    ds_read_b64_tr_b16 a[54:55], v6 offset:33792
    ds_read_b64_tr_b16 a[56:57], v5 offset:34816
    ds_read_b64_tr_b16 a[58:59], v5 offset:35840
    ds_read_b64_tr_b16 a[60:61], v6 offset:34816
    v_mfma_f32_32x32x16_bf16 v[112:127], a[228:231], v[160:163], v[112:127]
    ds_read_b64_tr_b16 a[252:253], v4 offset:26624
    ds_read_b64_tr_b16 a[254:255], v4 offset:55296
    buffer_load_dwordx4 v250, s[20:23], s56 offen offset:2048 lds
    ds_read_b64_tr_b16 a[62:63], v6 offset:35840
    v_mfma_f32_32x32x16_bf16 v[96:111], a[232:235], v[164:167], v[96:111]
    ds_read_b64_tr_b16 a[224:225], v1 offset:27648
    ds_read_b64_tr_b16 a[226:227], v1 offset:56320
    v_cmp_le_i32 s[100:101], 26, v24
    v_cmp_le_i32 s[76:77], 27, v24
    v_or_b32_e64 v14, v14, v27
    v_cndmask_b32 v15, 0, v25, s[100:101]
    v_mfma_f32_32x32x16_bf16 v[112:127], a[236:239], v[164:167], v[112:127]
    ds_read_b64_tr_b16 a[228:229], v2 offset:27648
    ds_read_b64_tr_b16 a[230:231], v2 offset:56320
    buffer_load_dwordx4 v251, s[20:23], s56 offen offset:3072 lds
    s_waitcnt lgkmcnt(5)
    s_nop 0
    v_mfma_f32_32x32x16_bf16 v[96:111], a[240:243], v[168:171], v[96:111]
    ds_read_b64_tr_b16 a[232:233], v3 offset:27648
    ds_read_b64_tr_b16 a[234:235], v3 offset:56320
    v_cndmask_b32 v27, 0, v26, s[76:77]
    v_cmp_gt_u32 s[100:101], 48, v28
    v_cmp_gt_u32 s[76:77], 28, v30
    v_or_b32 v15, v15, v27
    v_mfma_f32_32x32x16_bf16 v[112:127], a[244:247], v[168:171], v[112:127]
    ds_read_b64_tr_b16 a[236:237], v4 offset:27648
    ds_read_b64_tr_b16 a[238:239], v4 offset:56320
    s_waitcnt vmcnt(16)
    s_barrier
    v_readlane_b32 s56, v31, 6
    s_waitcnt lgkmcnt(8)
    s_add_u32 m0, s62, 32768
    v_mfma_f32_32x32x16_bf16 v[96:111], a[248:251], v[172:175], v[96:111]
    ds_read_b64_tr_b16 a[240:241], v1 offset:0
    ds_read_b64_tr_b16 a[242:243], v1 offset:28672
    buffer_load_dwordx4 v248, s[20:23], s56 offen offset:0 lds
    v_mov_b32 v27, 2146435072
    v_mfma_f32_32x32x16_bf16 v[112:127], a[252:255], v[172:175], v[112:127]
    ds_read_b64_tr_b16 a[244:245], v2 offset:0
    ds_read_b64_tr_b16 a[246:247], v2 offset:28672
    v_mul_u32_u24 v23, 7168, v29
    v_cndmask_b32 v22, v27, v7, s[100:101]
    v_cmp_gt_u32 s[100:101], 32, v28
    s_waitcnt lgkmcnt(4)
    s_nop 0
    v_mfma_f32_32x32x16_bf16 v[96:111], a[224:227], v[176:179], v[96:111]
    ds_read_b64_tr_b16 a[248:249], v3 offset:0
    ds_read_b64_tr_b16 a[250:251], v3 offset:28672
    buffer_load_dwordx4 v249, s[20:23], s56 offen offset:1024 lds
    v_lshl_add_u32 v23, v30, 4, v23
    v_mfma_f32_32x32x16_bf16 v[112:127], a[228:231], v[176:179], v[112:127]
    ds_read_b64_tr_b16 a[252:253], v4 offset:0
    ds_read_b64_tr_b16 a[254:255], v4 offset:28672
    v_cndmask_b32 v23, v27, v23, s[76:77]
    v_cndmask_b32 v25, v27, v252, s[100:101]
    v_and_b32 v26, 62, v28
    v_mfma_f32_32x32x16_bf16 v[96:111], a[232:235], v[180:183], v[96:111]
    ds_read_b64_tr_b16 a[224:225], v1 offset:1024
    ds_read_b64_tr_b16 a[226:227], v1 offset:29696
    buffer_load_dwordx4 v250, s[20:23], s56 offen offset:2048 lds
    s_mul_i32 s76, s40, 6
    v_mfma_f32_32x32x16_bf16 v[112:127], a[236:239], v[180:183], v[112:127]
    ds_read_b64_tr_b16 a[228:229], v2 offset:1024
    ds_read_b64_tr_b16 a[230:231], v2 offset:29696
    s_bfe_u32 s77, s42, 65537
    s_add_u32 s76, s76, s77
    s_waitcnt lgkmcnt(4)
    v_mfma_f32_32x32x16_bf16 v[96:111], a[240:243], v[184:187], v[96:111]
    ds_read_b64_tr_b16 a[232:233], v3 offset:1024
    ds_read_b64_tr_b16 a[234:235], v3 offset:29696
    buffer_load_dwordx4 v251, s[20:23], s56 offen offset:3072 lds
    s_xor_b32 s77, s76, 1
    s_nop 0
    v_mfma_f32_32x32x16_bf16 v[112:127], a[244:247], v[184:187], v[112:127]
    ds_read_b64_tr_b16 a[236:237], v4 offset:1024
    ds_read_b64_tr_b16 a[238:239], v4 offset:29696
    s_add_u32 m0, s55, 14336
    s_add_u32 s57, s50, s54
    s_sub_u32 s77, s77, 6
    v_mfma_f32_32x32x16_bf16 v[96:111], a[248:251], v[188:191], v[96:111]
    ds_read_b64_tr_b16 a[240:241], v1 offset:2048
    ds_read_b64_tr_b16 a[242:243], v1 offset:30720
    buffer_load_dwordx4 v240, s[12:15], s57 offen offset:0 lds
    v_cmp_gt_u32 s[100:101], 6, v28
    v_mfma_f32_32x32x16_bf16 v[112:127], a[252:255], v[188:191], v[112:127]
    ds_read_b64_tr_b16 a[244:245], v2 offset:2048
    ds_read_b64_tr_b16 a[246:247], v2 offset:30720
    v_add_u32_e64 v24, s77, v26
    v_add_u32 v26, s76, v26
    v_cndmask_b32 v26, v24, v26, s[100:101]
    s_waitcnt lgkmcnt(4)
    v_mfma_f32_32x32x16_bf16 v[96:111], a[224:227], v[192:195], v[96:111]
    ds_read_b64_tr_b16 a[248:249], v3 offset:2048
    ds_read_b64_tr_b16 a[250:251], v3 offset:30720
    buffer_load_dwordx4 v241, s[12:15], s57 offen offset:1024 lds
    v_cmp_gt_u32 s[100:101], 12, v28
    v_mfma_f32_32x32x16_bf16 v[112:127], a[228:231], v[192:195], v[112:127]
    ds_read_b64_tr_b16 a[252:253], v4 offset:2048
    ds_read_b64_tr_b16 a[254:255], v4 offset:30720
    s_add_u32 s76, s40, 24
    v_mov_b32 v24, s76
    v_cndmask_b32 v26, v24, v26, s[100:101]
    v_mfma_f32_32x32x16_bf16 v[96:111], a[232:235], v[196:199], v[96:111]
    ds_read_b64_tr_b16 a[224:225], v1 offset:3072
    ds_read_b64_tr_b16 a[226:227], v1 offset:31744
    buffer_load_dwordx4 v242, s[12:15], s57 offen offset:2048 lds
    v_cmp_gt_u32 s[100:101], 14, v28
    v_mfma_f32_32x32x16_bf16 v[112:127], a[236:239], v[196:199], v[112:127]
    ds_read_b64_tr_b16 a[228:229], v2 offset:3072
    ds_read_b64_tr_b16 a[230:231], v2 offset:31744
    v_and_b32 v24, 1, v28
    v_add_u32 v24, s79, v24
    v_lshlrev_b32 v24, 9, v24
    s_waitcnt lgkmcnt(4)
    v_mfma_f32_32x32x16_bf16 v[96:111], a[240:243], v[200:203], v[96:111]
    ds_read_b64_tr_b16 a[232:233], v3 offset:3072
    ds_read_b64_tr_b16 a[234:235], v3 offset:31744
    buffer_load_dwordx4 v243, s[12:15], s57 offen offset:3072 lds
    v_lshl_add_u32 v26, v26, 2, v24
    v_mfma_f32_32x32x16_bf16 v[112:127], a[244:247], v[200:203], v[112:127]
    ds_read_b64_tr_b16 a[236:237], v4 offset:3072
    ds_read_b64_tr_b16 a[238:239], v4 offset:31744
    s_add_u32 m0, s55, 18432
    s_add_u32 s57, s57, 458752
    s_waitcnt vmcnt(20)
    s_nop 0
    v_mfma_f32_32x32x16_bf16 v[96:111], a[248:251], v[204:207], v[96:111]
    ds_read_b64_tr_b16 a[240:241], v1 offset:4096
    ds_read_b64_tr_b16 a[242:243], v1 offset:32768
    buffer_load_dwordx4 v240, s[12:15], s57 offen offset:0 lds
    ds_read_b64_tr_b16 a[64:65], v5 offset:0
    v_mfma_f32_32x32x16_bf16 v[112:127], a[252:255], v[204:207], v[112:127]
    ds_read_b64_tr_b16 a[244:245], v2 offset:4096
    ds_read_b64_tr_b16 a[246:247], v2 offset:32768
    ds_read_b64_tr_b16 a[66:67], v5 offset:1024
    ds_read_b64_tr_b16 a[68:69], v6 offset:0
    ds_read_b64_tr_b16 a[70:71], v6 offset:1024
    s_waitcnt lgkmcnt(8)
    s_nop 0
    v_mfma_f32_32x32x16_bf16 v[96:111], a[224:227], v[208:211], v[96:111]
    ds_read_b64_tr_b16 a[248:249], v3 offset:4096
    ds_read_b64_tr_b16 a[250:251], v3 offset:32768
    buffer_load_dwordx4 v241, s[12:15], s57 offen offset:1024 lds
    ds_read_b64_tr_b16 a[72:73], v5 offset:2048
    v_mfma_f32_32x32x16_bf16 v[112:127], a[228:231], v[208:211], v[112:127]
    ds_read_b64_tr_b16 a[252:253], v4 offset:4096
    ds_read_b64_tr_b16 a[254:255], v4 offset:32768
    ds_read_b64_tr_b16 a[74:75], v5 offset:3072
    ds_read_b64_tr_b16 a[76:77], v6 offset:2048
    ds_read_b64_tr_b16 a[78:79], v6 offset:3072
    v_add_u32 v26, 15401088, v26
    v_mfma_f32_32x32x16_bf16 v[96:111], a[232:235], v[212:215], v[96:111]
    ds_read_b64_tr_b16 a[224:225], v1 offset:5120
    ds_read_b64_tr_b16 a[226:227], v1 offset:33792
    buffer_load_dwordx4 v242, s[12:15], s57 offen offset:2048 lds
    v_add_u32 v24, 13312, v23
    v_mfma_f32_32x32x16_bf16 v[112:127], a[236:239], v[212:215], v[112:127]
    ds_read_b64_tr_b16 a[228:229], v2 offset:5120
    ds_read_b64_tr_b16 a[230:231], v2 offset:33792
    v_cndmask_b32 v26, v27, v26, s[100:101]
    s_add_u32 s76, s40, 0
    s_waitcnt lgkmcnt(7)
    v_mfma_f32_32x32x16_bf16 v[96:111], a[240:243], v[216:219], v[96:111]
    ds_read_b64_tr_b16 a[232:233], v3 offset:5120
    ds_read_b64_tr_b16 a[234:235], v3 offset:33792
    v_readlane_b32 s56, v31, 7
    s_waitcnt lgkmcnt(6)
    s_add_u32 m0, s62, 0
    v_mfma_f32_32x32x16_bf16 v[112:127], a[244:247], v[216:219], v[112:127]
    ds_read_b64_tr_b16 a[236:237], v4 offset:5120
    ds_read_b64_tr_b16 a[238:239], v4 offset:33792
    buffer_load_dwordx4 v248, s[20:23], s56 offen offset:0 lds
    s_cmp_ge_u32 s76, 3
    s_nop 0
    s_cselect_b32 s77, 16384, 0
    v_mfma_f32_32x32x16_bf16 v[96:111], a[248:251], v[220:223], v[96:111]
    ds_read_b64_tr_b16 a[240:241], v1 offset:6144
    ds_read_b64_tr_b16 a[242:243], v1 offset:34816
    s_lshl_b32 s76, s76, 12
    s_add_u32 s76, s76, s77
    s_add_u32 s76, s76, 7168
    v_mfma_f32_32x32x16_bf16 v[112:127], a[252:255], v[220:223], v[112:127]
    ds_read_b64_tr_b16 a[244:245], v2 offset:6144
    ds_read_b64_tr_b16 a[246:247], v2 offset:34816
    buffer_load_dwordx4 v249, s[20:23], s56 offen offset:1024 lds
    s_waitcnt lgkmcnt(4)
    v_mfma_f32_32x32x16_bf16 v[96:111], a[224:227], v[224:227], v[96:111]
    ds_read_b64_tr_b16 a[248:249], v3 offset:6144
    ds_read_b64_tr_b16 a[250:251], v3 offset:34816
    v_add_u32 v16, s76, v252
    v_add_u32 v19, s76, v7
    s_add_u32 s76, s40, 1
    v_mfma_f32_32x32x16_bf16 v[112:127], a[228:231], v[224:227], v[112:127]
    ds_read_b64_tr_b16 a[252:253], v4 offset:6144
    ds_read_b64_tr_b16 a[254:255], v4 offset:34816
    s_waitcnt vmcnt(17)
    s_barrier
    v_mfma_f32_32x32x16_bf16 v[96:111], a[232:235], v[228:231], v[96:111]
    ds_read_b64_tr_b16 a[224:225], v1 offset:7168
    ds_read_b64_tr_b16 a[226:227], v1 offset:35840
    buffer_load_dwordx4 v250, s[20:23], s56 offen offset:2048 lds
    s_cmp_ge_u32 s76, 3
    s_cselect_b32 s77, 16384, 0
    v_mfma_f32_32x32x16_bf16 v[112:127], a[236:239], v[228:231], v[112:127]
    ds_read_b64_tr_b16 a[228:229], v2 offset:7168
    ds_read_b64_tr_b16 a[230:231], v2 offset:35840
    s_lshl_b32 s76, s76, 12
    s_add_u32 s76, s76, s77
    s_waitcnt lgkmcnt(4)
    v_mfma_f32_32x32x16_bf16 v[96:111], a[240:243], v[232:235], v[96:111]
    ds_read_b64_tr_b16 a[232:233], v3 offset:7168
    ds_read_b64_tr_b16 a[234:235], v3 offset:35840
    buffer_load_dwordx4 v251, s[20:23], s56 offen offset:3072 lds
    s_add_u32 s76, s76, 7168
    v_mfma_f32_32x32x16_bf16 v[112:127], a[244:247], v[232:235], v[112:127]
    ds_read_b64_tr_b16 a[236:237], v4 offset:7168
    ds_read_b64_tr_b16 a[238:239], v4 offset:35840
    s_add_u32 m0, s55, 21504
    s_add_u32 s57, s50, s53
    v_add_u32 v17, s76, v252
    v_mfma_f32_32x32x16_bf16 v[96:111], a[248:251], v[236:239], v[96:111]
    ds_read_b64_tr_b16 a[240:241], v1 offset:8192
    ds_read_b64_tr_b16 a[242:243], v1 offset:36864
    buffer_load_dwordx4 v240, s[16:19], s57 offen offset:0 lds
    v_add_u32_e64 v20, s76, v7
    v_mfma_f32_32x32x16_bf16 v[112:127], a[252:255], v[236:239], v[112:127]
    ds_read_b64_tr_b16 a[244:245], v2 offset:8192
    ds_read_b64_tr_b16 a[246:247], v2 offset:36864
    s_add_u32 s76, s40, 2
    s_cmp_ge_u32 s76, 3
    s_cselect_b32 s77, 16384, 0
    s_waitcnt lgkmcnt(4)
    v_mfma_f32_32x32x16_bf16 v[32:47], a[224:227], v[128:131], 0
    ds_read_b64_tr_b16 a[248:249], v3 offset:8192
    ds_read_b64_tr_b16 a[250:251], v3 offset:36864
    buffer_load_dwordx4 v241, s[16:19], s57 offen offset:1024 lds
    s_lshl_b32 s76, s76, 12
    v_mfma_f32_32x32x16_bf16 v[48:63], a[228:231], v[128:131], 0
    ds_read_b64_tr_b16 a[252:253], v4 offset:8192
    ds_read_b64_tr_b16 a[254:255], v4 offset:36864
    s_add_u32 s76, s76, s77
    s_add_u32 s76, s76, 7168
    v_add_u32 v18, s76, v252
    v_mfma_f32_32x32x16_bf16 v[32:47], a[232:235], v[132:135], v[32:47]
    ds_read_b64_tr_b16 a[224:225], v1 offset:9216
    ds_read_b64_tr_b16 a[226:227], v1 offset:37888
    buffer_load_dwordx4 v242, s[16:19], s57 offen offset:2048 lds
    v_add_u32_e64 v21, s76, v7
    v_mfma_f32_32x32x16_bf16 v[48:63], a[236:239], v[132:135], v[48:63]
    ds_read_b64_tr_b16 a[228:229], v2 offset:9216
    ds_read_b64_tr_b16 a[230:231], v2 offset:37888
    v_mul_f32 v64, v245, v64
    v_mul_f32 v65, v245, v65
    v_mul_f32_e64 v66, v245, v66
    v_mul_f32 v67, v245, v67
    s_waitcnt lgkmcnt(4)
    v_mfma_f32_32x32x16_bf16 v[32:47], a[240:243], v[136:139], v[32:47]
    ds_read_b64_tr_b16 a[232:233], v3 offset:9216
    ds_read_b64_tr_b16 a[234:235], v3 offset:37888
    buffer_load_dwordx4 v243, s[16:19], s57 offen offset:3072 lds
    v_mul_f32 v68, v245, v68
    v_mul_f32 v69, v245, v69
    v_mul_f32_e64 v70, v245, v70
    v_mfma_f32_32x32x16_bf16 v[48:63], a[244:247], v[136:139], v[48:63]
    ds_read_b64_tr_b16 a[236:237], v4 offset:9216
    ds_read_b64_tr_b16 a[238:239], v4 offset:37888
    s_add_u32 m0, s55, 25600
    s_add_u32 s57, s57, 458752
    v_mul_f32 v71, v245, v71
    v_mul_f32 v64, v96, v64
    v_mul_f32_e64 v65, v97, v65
    v_mfma_f32_32x32x16_bf16 v[32:47], a[248:251], v[140:143], v[32:47]
    ds_read_b64_tr_b16 a[240:241], v1 offset:10240
    ds_read_b64_tr_b16 a[242:243], v1 offset:38912
    buffer_load_dwordx4 v240, s[16:19], s57 offen offset:0 lds
    s_waitcnt vmcnt(20)
    v_mul_f32 v66, v98, v66
    v_mul_f32_e64 v67, v99, v67
    v_mfma_f32_32x32x16_bf16 v[48:63], a[252:255], v[140:143], v[48:63]
    ds_read_b64_tr_b16 a[244:245], v2 offset:10240
    ds_read_b64_tr_b16 a[246:247], v2 offset:38912
    ds_read_b64_tr_b16 a[80:81], v5 offset:16384
    ds_read_b64_tr_b16 a[82:83], v5 offset:17408
    ds_read_b64_tr_b16 a[84:85], v6 offset:16384
    v_mul_f32 v68, v100, v68
    s_waitcnt lgkmcnt(7)
    v_mfma_f32_32x32x16_bf16 v[32:47], a[224:227], v[144:147], v[32:47]
    ds_read_b64_tr_b16 a[248:249], v3 offset:10240
    ds_read_b64_tr_b16 a[250:251], v3 offset:38912
    buffer_load_dwordx4 v241, s[16:19], s57 offen offset:1024 lds
    ds_read_b64_tr_b16 a[86:87], v6 offset:17408
    v_mul_f32 v69, v101, v69
    v_mul_f32 v70, v102, v70
    v_mfma_f32_32x32x16_bf16 v[48:63], a[228:231], v[144:147], v[48:63]
    ds_read_b64_tr_b16 a[252:253], v4 offset:10240
    ds_read_b64_tr_b16 a[254:255], v4 offset:38912
    ds_read_b64_tr_b16 a[88:89], v5 offset:18432
    ds_read_b64_tr_b16 a[90:91], v5 offset:19456
    ds_read_b64_tr_b16 a[92:93], v6 offset:18432
    ds_read_b64_tr_b16 a[94:95], v6 offset:19456
    v_mul_f32_e64 v71, v103, v71
    v_mfma_f32_32x32x16_bf16 v[32:47], a[232:235], v[148:151], v[32:47]
    ds_read_b64_tr_b16 a[224:225], v1 offset:11264
    ds_read_b64_tr_b16 a[226:227], v1 offset:39936
    buffer_load_dwordx4 v242, s[16:19], s57 offen offset:2048 lds
    v_cvt_pk_bf16_f32 v64, v64, v65
    v_cvt_pk_bf16_f32 v65, v66, v67
    v_cvt_pk_bf16_f32 v66, v68, v69
    v_mfma_f32_32x32x16_bf16 v[48:63], a[236:239], v[148:151], v[48:63]
    ds_read_b64_tr_b16 a[228:229], v2 offset:11264
    ds_read_b64_tr_b16 a[230:231], v2 offset:39936
    v_cvt_pk_bf16_f32 v67, v70, v71
    v_mul_f32_e64 v72, v245, v72
    v_mul_f32 v73, v245, v73
    s_waitcnt lgkmcnt(8)
    v_mfma_f32_32x32x16_bf16 v[32:47], a[240:243], v[152:155], v[32:47]
    ds_read_b64_tr_b16 a[232:233], v3 offset:11264
    ds_read_b64_tr_b16 a[234:235], v3 offset:39936
    buffer_store_dwordx4 v[64:67], v7, s[28:31], s72 offen offset:0 sc1
    v_mul_f32_e64 v74, v245, v74
    v_mfma_f32_32x32x16_bf16 v[48:63], a[244:247], v[152:155], v[48:63]
    ds_read_b64_tr_b16 a[236:237], v4 offset:11264
    ds_read_b64_tr_b16 a[238:239], v4 offset:39936
    v_readlane_b32 s56, v31, 8
    s_waitcnt lgkmcnt(8)
    s_add_u32 m0, s62, 16384
    v_mul_f32 v75, v245, v75
    v_mfma_f32_32x32x16_bf16 v[32:47], a[248:251], v[156:159], v[32:47]
    ds_read_b64_tr_b16 a[240:241], v1 offset:12288
    ds_read_b64_tr_b16 a[242:243], v1 offset:40960
    buffer_load_dwordx4 v248, s[20:23], s56 offen offset:0 lds
    v_mul_f32_e64 v76, v245, v76
    v_mfma_f32_32x32x16_bf16 v[48:63], a[252:255], v[156:159], v[48:63]
    ds_read_b64_tr_b16 a[244:245], v2 offset:12288
    ds_read_b64_tr_b16 a[246:247], v2 offset:40960
    v_mul_f32 v77, v245, v77
    v_mul_f32 v78, v245, v78
    v_mul_f32 v79, v245, v79
    s_waitcnt lgkmcnt(4)
    v_mfma_f32_32x32x16_bf16 v[32:47], a[224:227], v[160:163], v[32:47]
    ds_read_b64_tr_b16 a[248:249], v3 offset:12288
    ds_read_b64_tr_b16 a[250:251], v3 offset:40960
    v_mul_f32 v72, v104, v72
    v_mul_f32 v73, v105, v73
    v_mul_f32 v74, v106, v74
    v_mul_f32 v75, v107, v75
    v_mfma_f32_32x32x16_bf16 v[48:63], a[228:231], v[160:163], v[48:63]
    ds_read_b64_tr_b16 a[252:253], v4 offset:12288
    ds_read_b64_tr_b16 a[254:255], v4 offset:40960
    buffer_load_dwordx4 v249, s[20:23], s56 offen offset:1024 lds
    v_mul_f32_e64 v76, v108, v76
    v_mfma_f32_32x32x16_bf16 v[32:47], a[232:235], v[164:167], v[32:47]
    ds_read_b64_tr_b16 a[224:225], v1 offset:13312
    ds_read_b64_tr_b16 a[226:227], v1 offset:41984
    v_mul_f32 v77, v109, v77
    v_mul_f32 v78, v110, v78
    v_mul_f32_e64 v79, v111, v79
    v_cvt_pk_bf16_f32 v72, v72, v73
    v_mfma_f32_32x32x16_bf16 v[48:63], a[236:239], v[164:167], v[48:63]
    ds_read_b64_tr_b16 a[228:229], v2 offset:13312
    ds_read_b64_tr_b16 a[230:231], v2 offset:41984
    buffer_load_dwordx4 v250, s[20:23], s56 offen offset:2048 lds
    s_waitcnt lgkmcnt(4)
    s_nop 0
    v_mfma_f32_32x32x16_bf16 v[32:47], a[240:243], v[168:171], v[32:47]
    ds_read_b64_tr_b16 a[232:233], v3 offset:13312
    ds_read_b64_tr_b16 a[234:235], v3 offset:41984
    v_cvt_pk_bf16_f32 v73, v74, v75
    v_cvt_pk_bf16_f32 v74, v76, v77
    v_cvt_pk_bf16_f32 v75, v78, v79
    v_mul_f32_e64 v80, v245, v80
    v_mfma_f32_32x32x16_bf16 v[48:63], a[244:247], v[168:171], v[48:63]
    ds_read_b64_tr_b16 a[236:237], v4 offset:13312
    ds_read_b64_tr_b16 a[238:239], v4 offset:41984
    s_waitcnt vmcnt(15)
    s_barrier
    v_mfma_f32_32x32x16_bf16 v[32:47], a[248:251], v[172:175], v[32:47]
    ds_read_b64_tr_b16 a[240:241], v1 offset:14336
    ds_read_b64_tr_b16 a[242:243], v1 offset:43008
    buffer_store_dwordx4 v[72:75], v7, s[28:31], s72 offen offset:1024 sc1
    v_mul_f32_e64 v81, v245, v81
    v_mfma_f32_32x32x16_bf16 v[48:63], a[252:255], v[172:175], v[48:63]
    ds_read_b64_tr_b16 a[244:245], v2 offset:14336
    ds_read_b64_tr_b16 a[246:247], v2 offset:43008
    v_mul_f32 v82, v245, v82
    v_mul_f32 v83, v245, v83
    v_mul_f32 v84, v245, v84
    s_waitcnt lgkmcnt(4)
    v_mfma_f32_32x32x16_bf16 v[32:47], a[224:227], v[176:179], v[32:47]
    ds_read_b64_tr_b16 a[248:249], v3 offset:14336
    ds_read_b64_tr_b16 a[250:251], v3 offset:43008
    buffer_load_dwordx4 v251, s[20:23], s56 offen offset:3072 lds
    v_mul_f32_e64 v85, v245, v85
    v_mfma_f32_32x32x16_bf16 v[48:63], a[228:231], v[176:179], v[48:63]
    ds_read_b64_tr_b16 a[252:253], v4 offset:14336
    ds_read_b64_tr_b16 a[254:255], v4 offset:43008
    s_add_u32 m0, s55, 0
    s_add_u32 s57, s50, s54
    v_mul_f32_e64 v86, v245, v86
    v_mfma_f32_32x32x16_bf16 v[32:47], a[232:235], v[180:183], v[32:47]
    ds_read_b64_tr_b16 a[224:225], v1 offset:15360
    ds_read_b64_tr_b16 a[226:227], v1 offset:44032
    buffer_load_dwordx4 v240, s[16:19], s57 offen offset:0 lds
    v_mul_f32_e64 v87, v245, v87
    v_mfma_f32_32x32x16_bf16 v[48:63], a[236:239], v[180:183], v[48:63]
    ds_read_b64_tr_b16 a[228:229], v2 offset:15360
    ds_read_b64_tr_b16 a[230:231], v2 offset:44032
    v_mul_f32 v80, v112, v80
    v_mul_f32 v81, v113, v81
    v_mul_f32 v82, v114, v82
    s_waitcnt lgkmcnt(4)
    v_mfma_f32_32x32x16_bf16 v[32:47], a[240:243], v[184:187], v[32:47]
    ds_read_b64_tr_b16 a[232:233], v3 offset:15360
    ds_read_b64_tr_b16 a[234:235], v3 offset:44032
    buffer_load_dwordx4 v241, s[16:19], s57 offen offset:1024 lds
    v_mul_f32_e64 v83, v115, v83
    v_mfma_f32_32x32x16_bf16 v[48:63], a[244:247], v[184:187], v[48:63]
    ds_read_b64_tr_b16 a[236:237], v4 offset:15360
    ds_read_b64_tr_b16 a[238:239], v4 offset:44032
    v_mul_f32 v84, v116, v84
    v_mul_f32 v85, v117, v85
    v_mul_f32 v86, v118, v86
    v_mul_f32 v87, v119, v87
    v_mfma_f32_32x32x16_bf16 v[32:47], a[248:251], v[188:191], v[32:47]
    ds_read_b64_tr_b16 a[240:241], v1 offset:16384
    ds_read_b64_tr_b16 a[242:243], v1 offset:45056
    buffer_load_dwordx4 v242, s[16:19], s57 offen offset:2048 lds
    v_cvt_pk_bf16_f32 v80, v80, v81
    v_mfma_f32_32x32x16_bf16 v[48:63], a[252:255], v[188:191], v[48:63]
    ds_read_b64_tr_b16 a[244:245], v2 offset:16384
    ds_read_b64_tr_b16 a[246:247], v2 offset:45056
    v_cvt_pk_bf16_f32 v81, v82, v83
    v_cvt_pk_bf16_f32 v82, v84, v85
    v_cvt_pk_bf16_f32 v83, v86, v87
    v_mul_f32 v88, v245, v88
    s_waitcnt lgkmcnt(4)
    v_mfma_f32_32x32x16_bf16 v[32:47], a[224:227], v[192:195], v[32:47]
    ds_read_b64_tr_b16 a[248:249], v3 offset:16384
    ds_read_b64_tr_b16 a[250:251], v3 offset:45056
    buffer_store_dwordx4 v[80:83], v7, s[28:31], s72 offen offset:2048 sc1
    v_mul_f32 v89, v245, v89
    v_mul_f32 v90, v245, v90
    v_mfma_f32_32x32x16_bf16 v[48:63], a[228:231], v[192:195], v[48:63]
    ds_read_b64_tr_b16 a[252:253], v4 offset:16384
    ds_read_b64_tr_b16 a[254:255], v4 offset:45056
    v_mul_f32 v91, v245, v91
    v_mul_f32 v92, v245, v92
    v_mul_f32 v93, v245, v93
    v_mul_f32 v94, v245, v94
    v_mul_f32_e64 v95, v245, v95
    v_mfma_f32_32x32x16_bf16 v[32:47], a[232:235], v[196:199], v[32:47]
    ds_read_b64_tr_b16 a[224:225], v1 offset:17408
    ds_read_b64_tr_b16 a[226:227], v1 offset:46080
    buffer_load_dwordx4 v243, s[16:19], s57 offen offset:3072 lds
    v_mul_f32 v88, v120, v88
    v_mul_f32 v89, v121, v89
    v_mfma_f32_32x32x16_bf16 v[48:63], a[236:239], v[196:199], v[48:63]
    ds_read_b64_tr_b16 a[228:229], v2 offset:17408
    ds_read_b64_tr_b16 a[230:231], v2 offset:46080
    s_add_u32 m0, s55, 4096
    s_add_u32 s57, s57, 458752
    v_mul_f32 v90, v122, v90
    s_waitcnt lgkmcnt(4)
    v_mfma_f32_32x32x16_bf16 v[32:47], a[240:243], v[200:203], v[32:47]
    ds_read_b64_tr_b16 a[232:233], v3 offset:17408
    ds_read_b64_tr_b16 a[234:235], v3 offset:46080
    buffer_load_dwordx4 v240, s[16:19], s57 offen offset:0 lds
    v_mul_f32 v91, v123, v91
    v_mul_f32 v92, v124, v92
    v_mfma_f32_32x32x16_bf16 v[48:63], a[244:247], v[200:203], v[48:63]
    ds_read_b64_tr_b16 a[236:237], v4 offset:17408
    ds_read_b64_tr_b16 a[238:239], v4 offset:46080
    ds_read_b64_tr_b16 a[96:97], v5 offset:32768
    ds_read_b64_tr_b16 a[98:99], v5 offset:33792
    ds_read_b64_tr_b16 a[100:101], v6 offset:32768
    v_mul_f32_e64 v93, v125, v93
    v_mfma_f32_32x32x16_bf16 v[32:47], a[248:251], v[204:207], v[32:47]
    ds_read_b64_tr_b16 a[240:241], v1 offset:18432
    ds_read_b64_tr_b16 a[242:243], v1 offset:47104
    buffer_load_dwordx4 v241, s[16:19], s57 offen offset:1024 lds
    ds_read_b64_tr_b16 a[102:103], v6 offset:33792
    v_mul_f32_e64 v94, v126, v94
    v_mfma_f32_32x32x16_bf16 v[48:63], a[252:255], v[204:207], v[48:63]
    ds_read_b64_tr_b16 a[244:245], v2 offset:18432
    ds_read_b64_tr_b16 a[246:247], v2 offset:47104
    ds_read_b64_tr_b16 a[104:105], v5 offset:34816
    ds_read_b64_tr_b16 a[106:107], v5 offset:35840
    ds_read_b64_tr_b16 a[108:109], v6 offset:34816
    v_mul_f32 v95, v127, v95
    s_waitcnt lgkmcnt(11)
    v_mfma_f32_32x32x16_bf16 v[32:47], a[224:227], v[208:211], v[32:47]
    ds_read_b64_tr_b16 a[248:249], v3 offset:18432
    ds_read_b64_tr_b16 a[250:251], v3 offset:47104
    buffer_load_dwordx4 v242, s[16:19], s57 offen offset:2048 lds
    ds_read_b64_tr_b16 a[110:111], v6 offset:35840
    v_cvt_pk_bf16_f32 v88, v88, v89
    v_mfma_f32_32x32x16_bf16 v[48:63], a[228:231], v[208:211], v[48:63]
    ds_read_b64_tr_b16 a[252:253], v4 offset:18432
    ds_read_b64_tr_b16 a[254:255], v4 offset:47104
    v_cvt_pk_bf16_f32 v89, v90, v91
    v_cvt_pk_bf16_f32 v90, v92, v93
    v_cvt_pk_bf16_f32 v91, v94, v95
    v_lshrrev_b32_e64 v27, 3, v28
    v_mfma_f32_32x32x16_bf16 v[32:47], a[232:235], v[212:215], v[32:47]
    ds_read_b64_tr_b16 a[224:225], v1 offset:19456
    ds_read_b64_tr_b16 a[226:227], v1 offset:48128
    buffer_store_dwordx4 v[88:91], v7, s[28:31], s72 offen offset:3072 sc1
    v_mul_u32_u24 v27, 896, v27
    v_mfma_f32_32x32x16_bf16 v[48:63], a[236:239], v[212:215], v[48:63]
    ds_read_b64_tr_b16 a[228:229], v2 offset:19456
    ds_read_b64_tr_b16 a[230:231], v2 offset:48128
    v_and_b32_e64 v29, 7, v28
    v_lshl_add_u32 v27, v29, 4, v27
    v_and_b32 v30, 3, v28
    s_waitcnt lgkmcnt(4)
    v_mfma_f32_32x32x16_bf16 v[32:47], a[240:243], v[216:219], v[32:47]
    ds_read_b64_tr_b16 a[232:233], v3 offset:19456
    ds_read_b64_tr_b16 a[234:235], v3 offset:48128
    v_readlane_b32 s56, v31, 9
    s_add_u32 m0, s62, 32768
    v_lshrrev_b32_e64 v28, 2, v28
    v_mfma_f32_32x32x16_bf16 v[48:63], a[244:247], v[216:219], v[48:63]
    ds_read_b64_tr_b16 a[236:237], v4 offset:19456
    ds_read_b64_tr_b16 a[238:239], v4 offset:48128
    buffer_load_dwordx4 v248, s[20:23], s56 offen offset:0 lds
    v_lshlrev_b32 v28, 12, v28
    v_mfma_f32_32x32x16_bf16 v[32:47], a[248:251], v[220:223], v[32:47]
    ds_read_b64_tr_b16 a[240:241], v1 offset:20480
    ds_read_b64_tr_b16 a[242:243], v1 offset:49152
    s_waitcnt vmcnt(23)
    ds_read_b64_tr_b16 a[112:113], v5 offset:0
    ds_read_b64_tr_b16 a[114:115], v5 offset:1024
    ds_read_b64_tr_b16 a[116:117], v6 offset:0
    v_mfma_f32_32x32x16_bf16 v[48:63], a[252:255], v[220:223], v[48:63]
    ds_read_b64_tr_b16 a[244:245], v2 offset:20480
    ds_read_b64_tr_b16 a[246:247], v2 offset:49152
    buffer_load_dwordx4 v249, s[20:23], s56 offen offset:1024 lds
    s_waitcnt lgkmcnt(7)
    s_nop 0
    v_mfma_f32_32x32x16_bf16 v[32:47], a[224:227], v[224:227], v[32:47]
    ds_read_b64_tr_b16 a[248:249], v3 offset:20480
    ds_read_b64_tr_b16 a[250:251], v3 offset:49152
    ds_read_b64_tr_b16 a[118:119], v6 offset:1024
    ds_read_b64_tr_b16 a[120:121], v5 offset:2048
    ds_read_b64_tr_b16 a[122:123], v5 offset:3072
    ds_read_b64_tr_b16 a[124:125], v6 offset:2048
    v_mfma_f32_32x32x16_bf16 v[48:63], a[228:231], v[224:227], v[48:63]
    ds_read_b64_tr_b16 a[252:253], v4 offset:20480
    ds_read_b64_tr_b16 a[254:255], v4 offset:49152
    s_waitcnt vmcnt(17)
    s_barrier
    v_mfma_f32_32x32x16_bf16 v[32:47], a[232:235], v[228:231], v[32:47]
    ds_read_b64_tr_b16 a[224:225], v1 offset:21504
    ds_read_b64_tr_b16 a[226:227], v1 offset:50176
    buffer_load_dwordx4 v250, s[20:23], s56 offen offset:2048 lds
    ds_read_b64_tr_b16 a[126:127], v6 offset:3072
    v_mfma_f32_32x32x16_bf16 v[48:63], a[236:239], v[228:231], v[48:63]
    ds_read_b64_tr_b16 a[228:229], v2 offset:21504
    ds_read_b64_tr_b16 a[230:231], v2 offset:50176
    v_lshl_add_u32 v28, v30, 9, v28
    v_add_u32 v28, s55, v28
    v_add_u32 v28, 9664, v28
    s_waitcnt lgkmcnt(5)
    v_mfma_f32_32x32x16_bf16 v[32:47], a[240:243], v[232:235], v[32:47]
    ds_read_b64_tr_b16 a[232:233], v3 offset:21504
    ds_read_b64_tr_b16 a[234:235], v3 offset:50176
    buffer_load_dwordx4 v251, s[20:23], s56 offen offset:3072 lds
    v_and_b32 v29, 0xff, v252
    v_mfma_f32_32x32x16_bf16 v[48:63], a[244:247], v[232:235], v[48:63]
    ds_read_b64_tr_b16 a[236:237], v4 offset:21504
    ds_read_b64_tr_b16 a[238:239], v4 offset:50176
    v_readlane_b32 s56, v31, 10
    s_waitcnt lgkmcnt(6)
    s_add_u32 m0, s62, 0
    v_add_u32_e64 v29, s55, v29
    v_mfma_f32_32x32x16_bf16 v[32:47], a[248:251], v[236:239], v[32:47]
    ds_read_b64_tr_b16 a[240:241], v1 offset:22528
    ds_read_b64_tr_b16 a[242:243], v1 offset:51200
    buffer_load_dwordx4 v248, s[20:23], s56 offen offset:0 lds
    v_add_u32 v30, 114944, v7
    v_mfma_f32_32x32x16_bf16 v[48:63], a[252:255], v[236:239], v[48:63]
    ds_read_b64_tr_b16 a[244:245], v2 offset:22528
    ds_read_b64_tr_b16 a[246:247], v2 offset:51200
    s_waitcnt lgkmcnt(4)
    s_nop 0
    v_mfma_f32_32x32x16_bf16 v[96:111], a[224:227], v[128:131], 0
    ds_read_b64_tr_b16 a[248:249], v3 offset:22528
    ds_read_b64_tr_b16 a[250:251], v3 offset:51200
    buffer_load_dword v247, v244, s[28:31], 0 offen sc1
    v_mfma_f32_32x32x16_bf16 v[112:127], a[228:231], v[128:131], 0
    ds_read_b64_tr_b16 a[252:253], v4 offset:22528
    ds_read_b64_tr_b16 a[254:255], v4 offset:51200
    buffer_load_dwordx4 v249, s[20:23], s56 offen offset:1024 lds
    v_lshrrev_b32 v72, 9, v7
    v_mfma_f32_32x32x16_bf16 v[96:111], a[232:235], v[132:135], v[96:111]
    ds_read_b64_tr_b16 a[224:225], v1 offset:23552
    ds_read_b64_tr_b16 a[226:227], v1 offset:52224
    s_waitcnt vmcnt(16)
    ds_read_b64_tr_b16 a[128:129], v5 offset:16384
    ds_read_b64_tr_b16 a[130:131], v5 offset:17408
    ds_read_b64_tr_b16 a[132:133], v6 offset:16384
    v_mfma_f32_32x32x16_bf16 v[112:127], a[236:239], v[132:135], v[112:127]
    ds_read_b64_tr_b16 a[228:229], v2 offset:23552
    ds_read_b64_tr_b16 a[230:231], v2 offset:52224
    buffer_load_dwordx4 v250, s[20:23], s56 offen offset:2048 lds
    s_waitcnt lgkmcnt(7)
    s_nop 0
    v_mfma_f32_32x32x16_bf16 v[96:111], a[240:243], v[136:139], v[96:111]
    ds_read_b64_tr_b16 a[232:233], v3 offset:23552
    ds_read_b64_tr_b16 a[234:235], v3 offset:52224
    ds_read_b64_tr_b16 a[134:135], v6 offset:17408
    ds_read_b64_tr_b16 a[136:137], v5 offset:18432
    ds_read_b64_tr_b16 a[138:139], v5 offset:19456
    ds_read_b64_tr_b16 a[140:141], v6 offset:18432
    v_mfma_f32_32x32x16_bf16 v[112:127], a[244:247], v[136:139], v[112:127]
    ds_read_b64_tr_b16 a[236:237], v4 offset:23552
    ds_read_b64_tr_b16 a[238:239], v4 offset:52224
    buffer_load_dwordx4 v251, s[20:23], s56 offen offset:3072 lds
    ds_read_b64_tr_b16 a[142:143], v6 offset:19456
    v_mfma_f32_32x32x16_bf16 v[96:111], a[248:251], v[140:143], v[96:111]
    ds_read_b64_tr_b16 a[240:241], v1 offset:24576
    ds_read_b64_tr_b16 a[242:243], v1 offset:53248
    v_lshlrev_b32_e64 v72, 2, v72
    v_bfe_u32 v73, v7, 4, 5
    v_sub_u32_e64 v72, v73, v72
    v_cmp_le_i32 s[8:9], 0, v72
    v_mfma_f32_32x32x16_bf16 v[112:127], a[252:255], v[140:143], v[112:127]
    ds_read_b64_tr_b16 a[244:245], v2 offset:24576
    ds_read_b64_tr_b16 a[246:247], v2 offset:53248
    v_cmp_le_i32 s[10:11], 1, v72
    v_cmp_le_i32 s[12:13], 2, v72
    v_cmp_le_i32 s[14:15], 3, v72
    s_waitcnt lgkmcnt(5)
    s_nop 0
    v_mfma_f32_32x32x16_bf16 v[96:111], a[224:227], v[144:147], v[96:111]
    ds_read_b64_tr_b16 a[248:249], v3 offset:24576
    ds_read_b64_tr_b16 a[250:251], v3 offset:53248
    v_cmp_le_i32 s[16:17], 8, v72
    v_cmp_le_i32 s[18:19], 9, v72
    v_cmp_le_i32 s[36:37], 10, v72
    v_cmp_le_i32 s[38:39], 11, v72
    v_mfma_f32_32x32x16_bf16 v[112:127], a[228:231], v[144:147], v[112:127]
    ds_read_b64_tr_b16 a[252:253], v4 offset:24576
    ds_read_b64_tr_b16 a[254:255], v4 offset:53248
    v_readlane_b32 s56, v31, 11
    s_waitcnt lgkmcnt(8)
    s_nop 0
    s_add_u32 m0, s62, 16384
    v_cmp_le_i32 s[46:47], 16, v72
    v_mfma_f32_32x32x16_bf16 v[96:111], a[232:235], v[148:151], v[96:111]
    ds_read_b64_tr_b16 a[224:225], v1 offset:25600
    ds_read_b64_tr_b16 a[226:227], v1 offset:54272
    buffer_load_dwordx4 v248, s[20:23], s56 offen offset:0 lds
    v_cmp_le_i32 s[48:49], 17, v72
    v_mfma_f32_32x32x16_bf16 v[112:127], a[236:239], v[148:151], v[112:127]
    ds_read_b64_tr_b16 a[228:229], v2 offset:25600
    ds_read_b64_tr_b16 a[230:231], v2 offset:54272
    v_cmp_le_i32 s[50:51], 18, v72
    v_cmp_le_i32 s[52:53], 19, v72
    v_cmp_le_i32 s[64:65], 24, v72
    s_waitcnt lgkmcnt(4)
    v_mfma_f32_32x32x16_bf16 v[96:111], a[240:243], v[152:155], v[96:111]
    ds_read_b64_tr_b16 a[232:233], v3 offset:25600
    ds_read_b64_tr_b16 a[234:235], v3 offset:54272
    s_waitcnt vmcnt(10)
    buffer_store_dword v255, v0, s[28:31], s74 offen sc1
    v_mfma_f32_32x32x16_bf16 v[112:127], a[244:247], v[152:155], v[112:127]
    ds_read_b64_tr_b16 a[236:237], v4 offset:25600
    ds_read_b64_tr_b16 a[238:239], v4 offset:54272
    buffer_load_dwordx4 v249, s[20:23], s56 offen offset:1024 lds
    v_cmp_le_i32 s[66:67], 25, v72
    v_mfma_f32_32x32x16_bf16 v[96:111], a[248:251], v[156:159], v[96:111]
    ds_read_b64_tr_b16 a[240:241], v1 offset:26624
    ds_read_b64_tr_b16 a[242:243], v1 offset:55296
    v_cmp_le_i32 s[68:69], 26, v72
    v_cmp_le_i32 s[76:77], 27, v72
    v_mov_b32 v240, 0x3f803f80
    v_mov_b32 v241, 0x3f803f80
    v_mfma_f32_32x32x16_bf16 v[112:127], a[252:255], v[156:159], v[112:127]
    ds_read_b64_tr_b16 a[244:245], v2 offset:26624
    ds_read_b64_tr_b16 a[246:247], v2 offset:55296
    buffer_load_dwordx4 v250, s[20:23], s56 offen offset:2048 lds
    s_waitcnt lgkmcnt(4)
    s_nop 0
    v_mfma_f32_32x32x16_bf16 v[96:111], a[224:227], v[160:163], v[96:111]
    ds_read_b64_tr_b16 a[248:249], v3 offset:26624
    ds_read_b64_tr_b16 a[250:251], v3 offset:55296
    v_mov_b32 v242, 0x3f803f80
    v_mov_b32 v243, 0x3f803f80
    v_mov_b32 v74, s86
    v_mov_b32 v75, s87
    v_mfma_f32_32x32x16_bf16 v[112:127], a[228:231], v[160:163], v[112:127]
    ds_read_b64_tr_b16 a[252:253], v4 offset:26624
    ds_read_b64_tr_b16 a[254:255], v4 offset:55296
    buffer_load_dwordx4 v251, s[20:23], s56 offen offset:3072 lds
    v_mov_b32 v76, s88
    v_mfma_f32_32x32x16_bf16 v[96:111], a[232:235], v[164:167], v[96:111]
    ds_read_b64_tr_b16 a[224:225], v1 offset:27648
    ds_read_b64_tr_b16 a[226:227], v1 offset:56320
    v_mov_b32 v77, 0x3f80
    v_readfirstlane_b32 s100, v255
    v_mfma_f32_32x32x16_bf16 v[112:127], a[236:239], v[164:167], v[112:127]
    ds_read_b64_tr_b16 a[228:229], v2 offset:27648
    ds_read_b64_tr_b16 a[230:231], v2 offset:56320
    s_cmp_lt_u32 s41, 28
    s_cselect_b32 s78, 0x3f, 0
    s_mov_b32 s79, 0
    s_waitcnt lgkmcnt(4)
    v_mfma_f32_32x32x16_bf16 v[96:111], a[240:243], v[168:171], v[96:111]
    ds_read_b64_tr_b16 a[232:233], v3 offset:27648
    ds_read_b64_tr_b16 a[234:235], v3 offset:56320
    v_mfma_f32_32x32x16_bf16 v[112:127], a[244:247], v[168:171], v[112:127]
    ds_read_b64_tr_b16 a[236:237], v4 offset:27648
    ds_read_b64_tr_b16 a[238:239], v4 offset:56320
    s_barrier
    v_mfma_f32_32x32x16_bf16 v[96:111], a[248:251], v[172:175], v[96:111]
    ds_read_b64_tr_b16 a[240:241], v1 offset:0
    ds_read_b64_tr_b16 a[242:243], v1 offset:28672
    v_mfma_f32_32x32x16_bf16 v[112:127], a[252:255], v[172:175], v[112:127]
    ds_read_b64_tr_b16 a[244:245], v2 offset:0
    ds_read_b64_tr_b16 a[246:247], v2 offset:28672
    s_waitcnt lgkmcnt(4)
    v_mfma_f32_32x32x16_bf16 v[96:111], a[224:227], v[176:179], v[96:111]
    ds_read_b64_tr_b16 a[248:249], v3 offset:0
    ds_read_b64_tr_b16 a[250:251], v3 offset:28672
    s_waitcnt vmcnt(8)
    v_cmp_ne_u32 vcc, v247, v255
    s_and_b64 vcc, vcc, s[90:91]
    s_cbranch_vccnz Lslow_3
Lback_4:
    v_mfma_f32_32x32x16_bf16 v[112:127], a[228:231], v[176:179], v[112:127]
    ds_read_b64_tr_b16 a[252:253], v4 offset:0
    ds_read_b64_tr_b16 a[254:255], v4 offset:28672
    s_add_u32 m0, s55, 7168
    v_mfma_f32_32x32x16_bf16 v[96:111], a[232:235], v[180:183], v[96:111]
    ds_read_b64_tr_b16 a[224:225], v1 offset:1024
    ds_read_b64_tr_b16 a[226:227], v1 offset:29696
    buffer_load_dwordx4 v7, s[28:31], s80 offen sc1 lds
    v_mfma_f32_32x32x16_bf16 v[112:127], a[236:239], v[180:183], v[112:127]
    ds_read_b64_tr_b16 a[228:229], v2 offset:1024
    ds_read_b64_tr_b16 a[230:231], v2 offset:29696
    buffer_load_dwordx4 v22, s[28:31], s80 offen offset:1024 sc1 lds
    s_waitcnt lgkmcnt(4)
    s_nop 0
    v_mfma_f32_32x32x16_bf16 v[96:111], a[240:243], v[184:187], v[96:111]
    ds_read_b64_tr_b16 a[232:233], v3 offset:1024
    ds_read_b64_tr_b16 a[234:235], v3 offset:29696
    s_add_u32 m0, s55, 11264
    v_mfma_f32_32x32x16_bf16 v[112:127], a[244:247], v[184:187], v[112:127]
    ds_read_b64_tr_b16 a[236:237], v4 offset:1024
    ds_read_b64_tr_b16 a[238:239], v4 offset:29696
    buffer_load_dwordx4 v7, s[28:31], s82 offen sc1 lds
    v_mfma_f32_32x32x16_bf16 v[96:111], a[248:251], v[188:191], v[96:111]
    ds_read_b64_tr_b16 a[240:241], v1 offset:2048
    ds_read_b64_tr_b16 a[242:243], v1 offset:30720
    ds_read_b64_tr_b16 a[144:145], v5 offset:32768
    ds_read_b64_tr_b16 a[146:147], v5 offset:33792
    ds_read_b64_tr_b16 a[148:149], v6 offset:32768
    v_mfma_f32_32x32x16_bf16 v[112:127], a[252:255], v[188:191], v[112:127]
    ds_read_b64_tr_b16 a[244:245], v2 offset:2048
    ds_read_b64_tr_b16 a[246:247], v2 offset:30720
    buffer_load_dwordx4 v22, s[28:31], s82 offen offset:1024 sc1 lds
    s_waitcnt lgkmcnt(7)
    s_nop 0
    v_mfma_f32_32x32x16_bf16 v[96:111], a[224:227], v[192:195], v[96:111]
    ds_read_b64_tr_b16 a[248:249], v3 offset:2048
    ds_read_b64_tr_b16 a[250:251], v3 offset:30720
    s_add_u32 m0, s55, 15360
    ds_read_b64_tr_b16 a[150:151], v6 offset:33792
    ds_read_b64_tr_b16 a[152:153], v5 offset:34816
    v_mfma_f32_32x32x16_bf16 v[112:127], a[228:231], v[192:195], v[112:127]
    ds_read_b64_tr_b16 a[252:253], v4 offset:2048
    ds_read_b64_tr_b16 a[254:255], v4 offset:30720
    buffer_load_dwordx4 v7, s[28:31], s84 offen sc1 lds
    ds_read_b64_tr_b16 a[154:155], v5 offset:35840
    v_mfma_f32_32x32x16_bf16 v[96:111], a[232:235], v[196:199], v[96:111]
    ds_read_b64_tr_b16 a[224:225], v1 offset:3072
    ds_read_b64_tr_b16 a[226:227], v1 offset:31744
    ds_read_b64_tr_b16 a[156:157], v6 offset:34816
    ds_read_b64_tr_b16 a[158:159], v6 offset:35840
    v_mfma_f32_32x32x16_bf16 v[112:127], a[236:239], v[196:199], v[112:127]
    ds_read_b64_tr_b16 a[228:229], v2 offset:3072
    ds_read_b64_tr_b16 a[230:231], v2 offset:31744
    buffer_load_dwordx4 v22, s[28:31], s84 offen offset:1024 sc1 lds
    s_waitcnt lgkmcnt(7)
    s_nop 0
    v_mfma_f32_32x32x16_bf16 v[96:111], a[240:243], v[200:203], v[96:111]
    ds_read_b64_tr_b16 a[232:233], v3 offset:3072
    ds_read_b64_tr_b16 a[234:235], v3 offset:31744
    buffer_load_dwordx2 v[64:65], v252, s[28:31], s96 offen offset:0 sc1
    v_mfma_f32_32x32x16_bf16 v[112:127], a[244:247], v[200:203], v[112:127]
    ds_read_b64_tr_b16 a[236:237], v4 offset:3072
    ds_read_b64_tr_b16 a[238:239], v4 offset:31744
    buffer_load_dwordx2 v[66:67], v252, s[28:31], s96 offen offset:512 sc1
    v_mfma_f32_32x32x16_bf16 v[96:111], a[248:251], v[204:207], v[96:111]
    ds_read_b64_tr_b16 a[240:241], v1 offset:4096
    ds_read_b64_tr_b16 a[242:243], v1 offset:32768
    buffer_load_dwordx2 v[68:69], v252, s[28:31], s96 offen offset:1024 sc1
    v_mfma_f32_32x32x16_bf16 v[112:127], a[252:255], v[204:207], v[112:127]
    ds_read_b64_tr_b16 a[244:245], v2 offset:4096
    ds_read_b64_tr_b16 a[246:247], v2 offset:32768
    buffer_load_dwordx2 v[70:71], v25, s[28:31], s96 offen offset:1536 sc1
    s_add_u32 m0, s55, 9216
    s_waitcnt lgkmcnt(4)
    v_mfma_f32_32x32x16_bf16 v[96:111], a[224:227], v[208:211], v[96:111]
    ds_read_b64_tr_b16 a[248:249], v3 offset:4096
    ds_read_b64_tr_b16 a[250:251], v3 offset:32768
    buffer_load_dwordx4 v23, s[28:31], s81 offen sc1 lds
    s_waitcnt vmcnt(16)
    v_mfma_f32_32x32x16_bf16 v[112:127], a[228:231], v[208:211], v[112:127]
    ds_read_b64_tr_b16 a[252:253], v4 offset:4096
    ds_read_b64_tr_b16 a[254:255], v4 offset:32768
    ds_read_b64_tr_b16 a[160:161], v5 offset:0
    ds_read_b64_tr_b16 a[162:163], v5 offset:1024
    ds_read_b64_tr_b16 a[164:165], v6 offset:0
    ds_read_b64_tr_b16 a[166:167], v6 offset:1024
    v_mfma_f32_32x32x16_bf16 v[96:111], a[232:235], v[212:215], v[96:111]
    ds_read_b64_tr_b16 a[224:225], v1 offset:5120
    ds_read_b64_tr_b16 a[226:227], v1 offset:33792
    buffer_load_dwordx4 v24, s[28:31], s81 offen offset:1024 sc1 lds
    ds_read_b64_tr_b16 a[168:169], v5 offset:2048
    v_mfma_f32_32x32x16_bf16 v[112:127], a[236:239], v[212:215], v[112:127]
    ds_read_b64_tr_b16 a[228:229], v2 offset:5120
    ds_read_b64_tr_b16 a[230:231], v2 offset:33792
    s_add_u32 m0, s55, 13312
    ds_read_b64_tr_b16 a[170:171], v5 offset:3072
    s_waitcnt lgkmcnt(10)
    s_nop 0
    v_mfma_f32_32x32x16_bf16 v[96:111], a[240:243], v[216:219], v[96:111]
    ds_read_b64_tr_b16 a[232:233], v3 offset:5120
    ds_read_b64_tr_b16 a[234:235], v3 offset:33792
    buffer_load_dwordx4 v23, s[28:31], s83 offen sc1 lds
    ds_read_b64_tr_b16 a[172:173], v6 offset:2048
    v_mfma_f32_32x32x16_bf16 v[112:127], a[244:247], v[216:219], v[112:127]
    ds_read_b64_tr_b16 a[236:237], v4 offset:5120
    ds_read_b64_tr_b16 a[238:239], v4 offset:33792
    buffer_load_dwordx4 v24, s[28:31], s83 offen offset:1024 sc1 lds
    ds_read_b64_tr_b16 a[174:175], v6 offset:3072
    v_mfma_f32_32x32x16_bf16 v[96:111], a[248:251], v[220:223], v[96:111]
    ds_read_b64_tr_b16 a[240:241], v1 offset:6144
    ds_read_b64_tr_b16 a[242:243], v1 offset:34816
    s_add_u32 m0, s55, 17408
    v_mfma_f32_32x32x16_bf16 v[112:127], a[252:255], v[220:223], v[112:127]
    ds_read_b64_tr_b16 a[244:245], v2 offset:6144
    ds_read_b64_tr_b16 a[246:247], v2 offset:34816
    buffer_load_dwordx4 v23, s[28:31], s85 offen sc1 lds
    s_waitcnt lgkmcnt(5)
    v_mfma_f32_32x32x16_bf16 v[96:111], a[224:227], v[224:227], v[96:111]
    ds_read_b64_tr_b16 a[248:249], v3 offset:6144
    ds_read_b64_tr_b16 a[250:251], v3 offset:34816
    buffer_load_dwordx4 v24, s[28:31], s85 offen offset:1024 sc1 lds
    s_waitcnt vmcnt(16)
    v_mfma_f32_32x32x16_bf16 v[112:127], a[228:231], v[224:227], v[112:127]
    ds_read_b64_tr_b16 a[252:253], v4 offset:6144
    ds_read_b64_tr_b16 a[254:255], v4 offset:34816
    ds_read_b64_tr_b16 a[176:177], v5 offset:16384
    ds_read_b64_tr_b16 a[178:179], v5 offset:17408
    ds_read_b64_tr_b16 a[180:181], v6 offset:16384
    ds_read_b64_tr_b16 a[182:183], v6 offset:17408
    v_mfma_f32_32x32x16_bf16 v[96:111], a[232:235], v[228:231], v[96:111]
    ds_read_b64_tr_b16 a[184:185], v5 offset:18432
    ds_read_b64_tr_b16 a[186:187], v5 offset:19456
    ds_read_b64_tr_b16 a[188:189], v6 offset:18432
    ds_read_b64_tr_b16 a[190:191], v6 offset:19456
    v_mfma_f32_32x32x16_bf16 v[112:127], a[236:239], v[228:231], v[112:127]
    s_waitcnt lgkmcnt(8)
    v_mfma_f32_32x32x16_bf16 v[96:111], a[240:243], v[232:235], v[96:111]
    v_mfma_f32_32x32x16_bf16 v[112:127], a[244:247], v[232:235], v[112:127]
    v_mfma_f32_32x32x16_bf16 v[96:111], a[248:251], v[236:239], v[96:111]
    v_mfma_f32_32x32x16_bf16 v[112:127], a[252:255], v[236:239], v[112:127]
    s_branch L_att
P_C2:
    s_nop 0
    s_waitcnt lgkmcnt(6)
    v_mfma_f32_32x32x16_bf16 v[32:47], v[8:11], v[128:131], v[48:63]
    ds_read_b128 v[160:163], v20 offset:8192
    ds_read_b128 v[164:167], v21 offset:8192
    ds_read_b128 v[168:171], v22 offset:8192
    ds_read_b128 v[172:175], v23 offset:8192
    v_max_f32 v80, 0, v80
    v_cvt_pk_bf16_f32 v80, v80, v80
    v_mfma_f32_32x32x16_bf16 v[32:47], v[12:15], v[132:135], v[32:47]
    s_waitcnt lgkmcnt(8)
    v_mfma_f32_32x32x16_bf16 v[64:79], v[8:11], v[136:139], v[48:63]
    ds_read_b128 v[176:179], v20 offset:12288
    ds_read_b128 v[180:183], v21 offset:12288
    ds_read_b128 v[184:187], v26 offset:12288
    ds_read_b128 v[188:191], v27 offset:12288
    v_lshlrev_b32_e64 v80, 16, v80
    v_add_f32 v80, 925353388, v80
    v_mfma_f32_32x32x16_bf16 v[64:79], v[12:15], v[140:143], v[64:79]
    v_cvt_pk_bf16_f32 v80, v80, v80
    v_lshlrev_b32 v80, 16, v80
    v_sqrt_f32 v80, v80
    v_cvt_pk_bf16_f32 v128, v32, v33
    v_cvt_pk_bf16_f32 v129, v34, v35
    v_cvt_pk_bf16_f32 v130, v36, v37
    v_cvt_pk_bf16_f32 v131, v38, v39
    v_cvt_pk_bf16_f32 v132, v40, v41
    v_cvt_pk_bf16_f32 v133, v42, v43
    v_cvt_pk_bf16_f32 v134, v44, v45
    v_cvt_pk_bf16_f32 v135, v46, v47
    s_waitcnt lgkmcnt(10)
    v_mfma_f32_32x32x16_bf16 v[32:47], v[8:11], v[144:147], v[48:63]
    ds_read_b128 v[192:195], v24 offset:16384
    ds_read_b128 v[196:199], v25 offset:16384
    ds_read_b128 v[200:203], v26 offset:16384
    ds_read_b128 v[204:207], v27 offset:16384
    s_lshl_b32 s58, s40, 7
    v_cvt_pk_bf16_f32 v80, v80, v80
    v_mfma_f32_32x32x16_bf16 v[32:47], v[12:15], v[148:151], v[32:47]
    v_cvt_pk_bf16_f32 v136, v64, v65
    v_cvt_pk_bf16_f32 v137, v66, v67
    v_cvt_pk_bf16_f32 v138, v68, v69
    v_cvt_pk_bf16_f32 v139, v70, v71
    v_cvt_pk_bf16_f32 v140, v72, v73
    v_cvt_pk_bf16_f32 v141, v74, v75
    v_cvt_pk_bf16_f32 v142, v76, v77
    v_cvt_pk_bf16_f32 v143, v78, v79
    s_waitcnt lgkmcnt(12)
    s_nop 0
    v_mfma_f32_32x32x16_bf16 v[64:79], v[8:11], v[152:155], v[48:63]
    ds_read_b128 v[208:211], v24 offset:20480
    ds_read_b128 v[212:215], v25 offset:20480
    ds_read_b128 v[216:219], v26 offset:20480
    ds_read_b128 v[220:223], v27 offset:20480
    v_lshlrev_b32 v80, 16, v80
    v_rcp_f32 v253, v80
    v_mfma_f32_32x32x16_bf16 v[64:79], v[12:15], v[156:159], v[64:79]
    v_cvt_pk_bf16_f32 v144, v32, v33
    v_cvt_pk_bf16_f32 v145, v34, v35
    v_cvt_pk_bf16_f32 v146, v36, v37
    v_cvt_pk_bf16_f32 v147, v38, v39
    v_cvt_pk_bf16_f32 v148, v40, v41
    v_cvt_pk_bf16_f32 v149, v42, v43
    v_cvt_pk_bf16_f32 v150, v44, v45
    v_cvt_pk_bf16_f32 v151, v46, v47
    s_waitcnt lgkmcnt(14)
    s_nop 0
    v_mfma_f32_32x32x16_bf16 v[32:47], v[8:11], v[160:163], v[48:63]
    ds_read_b128 v[224:227], v24 offset:24576
    ds_read_b128 v[228:231], v25 offset:24576
    ds_read_b128 v[232:235], v26 offset:24576
    ds_read_b128 v[236:239], v27 offset:24576
    s_add_u32 s58, s58, 143360
    v_mul_f32_e64 v245, v253, v253
    v_mfma_f32_32x32x16_bf16 v[32:47], v[12:15], v[164:167], v[32:47]
    v_cvt_pk_bf16_f32 v152, v64, v65
    v_cvt_pk_bf16_f32 v153, v66, v67
    v_cvt_pk_bf16_f32 v154, v68, v69
    v_cvt_pk_bf16_f32 v155, v70, v71
    v_cvt_pk_bf16_f32 v156, v72, v73
    v_cvt_pk_bf16_f32 v157, v74, v75
    v_cvt_pk_bf16_f32 v158, v76, v77
    v_cvt_pk_bf16_f32 v159, v78, v79
    s_waitcnt lgkmcnt(15)
    v_mfma_f32_32x32x16_bf16 v[64:79], v[8:11], v[168:171], v[48:63]
    v_mfma_f32_32x32x16_bf16 v[64:79], v[12:15], v[172:175], v[64:79]
    s_nop 0
    v_cvt_pk_bf16_f32 v160, v32, v33
    v_cvt_pk_bf16_f32 v161, v34, v35
    v_cvt_pk_bf16_f32 v162, v36, v37
    v_cvt_pk_bf16_f32 v163, v38, v39
    v_cvt_pk_bf16_f32 v164, v40, v41
    v_cvt_pk_bf16_f32 v165, v42, v43
    v_cvt_pk_bf16_f32 v166, v44, v45
    v_cvt_pk_bf16_f32 v167, v46, v47
    s_waitcnt lgkmcnt(14)
    v_mfma_f32_32x32x16_bf16 v[32:47], v[8:11], v[176:179], v[48:63]
    s_waitcnt lgkmcnt(0)
    s_add_u32 m0, s55, 0
    s_add_u32 s57, s46, s52
    buffer_load_dwordx4 v116, s[8:11], s57 offen offset:0 lds
    buffer_load_dwordx4 v117, s[8:11], s57 offen offset:1024 lds
    v_mfma_f32_32x32x16_bf16 v[32:47], v[12:15], v[180:183], v[32:47]
    v_cvt_pk_bf16_f32 v168, v64, v65
    v_cvt_pk_bf16_f32 v169, v66, v67
    v_cvt_pk_bf16_f32 v170, v68, v69
    v_cvt_pk_bf16_f32 v171, v70, v71
    v_cvt_pk_bf16_f32 v172, v72, v73
    v_cvt_pk_bf16_f32 v173, v74, v75
    v_cvt_pk_bf16_f32 v174, v76, v77
    v_cvt_pk_bf16_f32 v175, v78, v79
    v_mfma_f32_32x32x16_bf16 v[64:79], v[8:11], v[184:187], v[48:63]
    buffer_load_dwordx4 v118, s[8:11], s57 offen offset:2048 lds
    buffer_load_dwordx4 v119, s[8:11], s57 offen offset:3072 lds
    v_mfma_f32_32x32x16_bf16 v[64:79], v[12:15], v[188:191], v[64:79]
    v_cvt_pk_bf16_f32 v176, v32, v33
    v_cvt_pk_bf16_f32 v177, v34, v35
    v_cvt_pk_bf16_f32 v178, v36, v37
    v_cvt_pk_bf16_f32 v179, v38, v39
    v_cvt_pk_bf16_f32 v180, v40, v41
    v_cvt_pk_bf16_f32 v181, v42, v43
    v_cvt_pk_bf16_f32 v182, v44, v45
    v_cvt_pk_bf16_f32 v183, v46, v47
    v_mfma_f32_32x32x16_bf16 v[32:47], v[8:11], v[192:195], v[48:63]
    s_add_u32 m0, s55, 4096
    s_add_u32 s57, s57, 344064
    buffer_load_dwordx4 v116, s[8:11], s57 offen offset:0 lds
    buffer_load_dwordx4 v117, s[8:11], s57 offen offset:1024 lds
    v_mfma_f32_32x32x16_bf16 v[32:47], v[12:15], v[196:199], v[32:47]
    v_cvt_pk_bf16_f32 v184, v64, v65
    v_cvt_pk_bf16_f32 v185, v66, v67
    v_cvt_pk_bf16_f32 v186, v68, v69
    v_cvt_pk_bf16_f32 v187, v70, v71
    v_cvt_pk_bf16_f32 v188, v72, v73
    v_cvt_pk_bf16_f32 v189, v74, v75
    v_cvt_pk_bf16_f32 v190, v76, v77
    v_cvt_pk_bf16_f32 v191, v78, v79
    v_mfma_f32_32x32x16_bf16 v[64:79], v[8:11], v[200:203], v[48:63]
    buffer_load_dwordx4 v118, s[8:11], s57 offen offset:2048 lds
    s_add_u32 m0, s55, 7168
    s_add_u32 s57, s47, s51
    s_nop 0
    buffer_load_dwordx4 v116, s[8:11], s57 offen offset:0 lds
    v_mfma_f32_32x32x16_bf16 v[64:79], v[12:15], v[204:207], v[64:79]
    v_cvt_pk_bf16_f32 v192, v32, v33
    v_cvt_pk_bf16_f32 v193, v34, v35
    v_cvt_pk_bf16_f32 v194, v36, v37
    v_cvt_pk_bf16_f32 v195, v38, v39
    v_cvt_pk_bf16_f32 v196, v40, v41
    v_cvt_pk_bf16_f32 v197, v42, v43
    v_cvt_pk_bf16_f32 v198, v44, v45
    v_cvt_pk_bf16_f32 v199, v46, v47
    v_mfma_f32_32x32x16_bf16 v[32:47], v[8:11], v[208:211], v[48:63]
    buffer_load_dwordx4 v117, s[8:11], s57 offen offset:1024 lds
    buffer_load_dwordx4 v118, s[8:11], s57 offen offset:2048 lds
    v_mfma_f32_32x32x16_bf16 v[32:47], v[12:15], v[212:215], v[32:47]
    v_cvt_pk_bf16_f32 v200, v64, v65
    v_cvt_pk_bf16_f32 v201, v66, v67
    v_cvt_pk_bf16_f32 v202, v68, v69
    v_cvt_pk_bf16_f32 v203, v70, v71
    v_cvt_pk_bf16_f32 v204, v72, v73
    v_cvt_pk_bf16_f32 v205, v74, v75
    v_cvt_pk_bf16_f32 v206, v76, v77
    v_cvt_pk_bf16_f32 v207, v78, v79
    v_mfma_f32_32x32x16_bf16 v[64:79], v[8:11], v[216:219], v[48:63]
    buffer_load_dwordx4 v119, s[8:11], s57 offen offset:3072 lds
    v_mfma_f32_32x32x16_bf16 v[64:79], v[12:15], v[220:223], v[64:79]
    s_nop 0
    s_nop 0
    v_cvt_pk_bf16_f32 v208, v32, v33
    v_cvt_pk_bf16_f32 v209, v34, v35
    v_cvt_pk_bf16_f32 v210, v36, v37
    v_cvt_pk_bf16_f32 v211, v38, v39
    v_cvt_pk_bf16_f32 v212, v40, v41
    v_cvt_pk_bf16_f32 v213, v42, v43
    v_cvt_pk_bf16_f32 v214, v44, v45
    v_cvt_pk_bf16_f32 v215, v46, v47
    v_mfma_f32_32x32x16_bf16 v[32:47], v[8:11], v[224:227], v[48:63]
    s_add_u32 m0, s55, 11264
    s_add_u32 s57, s57, 344064
    buffer_load_dwordx4 v116, s[8:11], s57 offen offset:0 lds
    v_mfma_f32_32x32x16_bf16 v[32:47], v[12:15], v[228:231], v[32:47]
    v_cvt_pk_bf16_f32 v216, v64, v65
    v_cvt_pk_bf16_f32 v217, v66, v67
    v_cvt_pk_bf16_f32 v218, v68, v69
    v_cvt_pk_bf16_f32 v219, v70, v71
    v_cvt_pk_bf16_f32 v220, v72, v73
    v_cvt_pk_bf16_f32 v221, v74, v75
    v_cvt_pk_bf16_f32 v222, v76, v77
    v_cvt_pk_bf16_f32 v223, v78, v79
    v_mfma_f32_32x32x16_bf16 v[64:79], v[8:11], v[232:235], v[48:63]
    buffer_load_dwordx4 v117, s[8:11], s57 offen offset:1024 lds
    v_mfma_f32_32x32x16_bf16 v[64:79], v[12:15], v[236:239], v[64:79]
    s_nop 0
    s_nop 0
    v_cvt_pk_bf16_f32 v224, v32, v33
    v_cvt_pk_bf16_f32 v225, v34, v35
    v_cvt_pk_bf16_f32 v226, v36, v37
    v_cvt_pk_bf16_f32 v227, v38, v39
    v_cvt_pk_bf16_f32 v228, v40, v41
    v_cvt_pk_bf16_f32 v229, v42, v43
    v_cvt_pk_bf16_f32 v230, v44, v45
    v_cvt_pk_bf16_f32 v231, v46, v47
    buffer_load_dwordx4 v118, s[8:11], s57 offen offset:2048 lds
    buffer_load_dword v255, off, s[36:39], 0 sc1
    s_nop 0
    v_cvt_pk_bf16_f32 v232, v64, v65
    v_cvt_pk_bf16_f32 v233, v66, v67
    v_cvt_pk_bf16_f32 v234, v68, v69
    v_cvt_pk_bf16_f32 v235, v70, v71
    v_cvt_pk_bf16_f32 v236, v72, v73
    v_cvt_pk_bf16_f32 v237, v74, v75
    v_cvt_pk_bf16_f32 v238, v76, v77
    v_cvt_pk_bf16_f32 v239, v78, v79
    s_waitcnt vmcnt(16)
    s_waitcnt lgkmcnt(0)
    s_barrier
    ds_read_b64_tr_b16 a[224:225], v96 offset:0
    ds_read_b64_tr_b16 a[226:227], v96 offset:1024
    ds_read_b64_tr_b16 a[228:229], v97 offset:0
    ds_read_b64_tr_b16 a[230:231], v97 offset:1024
    ds_read_b64_tr_b16 a[232:233], v96 offset:2048
    ds_read_b64_tr_b16 a[234:235], v96 offset:3072
    ds_read_b64_tr_b16 a[236:237], v97 offset:2048
    ds_read_b64_tr_b16 a[238:239], v97 offset:3072
    ds_read_b64_tr_b16 a[240:241], v96 offset:4096
    ds_read_b64_tr_b16 a[242:243], v96 offset:5120
    ds_read_b64_tr_b16 a[244:245], v97 offset:4096
    ds_read_b64_tr_b16 a[246:247], v97 offset:5120
    s_waitcnt lgkmcnt(4)
    v_mfma_f32_32x32x16_bf16 v[32:47], a[224:227], v[128:131], 0
    ds_read_b64_tr_b16 a[248:249], v96 offset:6144
    ds_read_b64_tr_b16 a[250:251], v96 offset:7168
    s_lshl_b32 s79, s42, 2
    s_and_b32 s76, s41, 3
    s_add_u32 s79, s79, s76
    v_mfma_f32_32x32x16_bf16 v[48:63], a[228:231], v[128:131], 0
    ds_read_b64_tr_b16 a[252:253], v97 offset:6144
    ds_read_b64_tr_b16 a[254:255], v97 offset:7168
    s_lshl_b32 s79, s79, 1
    s_mul_i32 s95, s79, 33024
    s_lshl_b32 s76, s40, 13
    v_mfma_f32_32x32x16_bf16 v[32:47], a[232:235], v[132:135], v[32:47]
    ds_read_b64_tr_b16 a[224:225], v96 offset:8192
    ds_read_b64_tr_b16 a[226:227], v96 offset:9216
    s_add_u32 s95, s95, s76
    s_add_u32 s95, s95, 5701632
    s_lshl_b32 s76, s79, 1
    v_mfma_f32_32x32x16_bf16 v[48:63], a[236:239], v[132:135], v[48:63]
    ds_read_b64_tr_b16 a[228:229], v97 offset:8192
    ds_read_b64_tr_b16 a[230:231], v97 offset:9216
    s_add_u32 s76, s76, s40
    s_mul_i32 s44, s76, 14336
    s_waitcnt lgkmcnt(4)
    v_mfma_f32_32x32x16_bf16 v[32:47], a[240:243], v[136:139], v[32:47]
    ds_read_b64_tr_b16 a[232:233], v96 offset:10240
    ds_read_b64_tr_b16 a[234:235], v96 offset:11264
    s_lshr_b32 s58, s41, 2
    s_lshl_b32 s58, s58, 7
    s_add_u32 s44, s44, s58
    v_mfma_f32_32x32x16_bf16 v[48:63], a[244:247], v[136:139], v[48:63]
    ds_read_b64_tr_b16 a[236:237], v97 offset:10240
    ds_read_b64_tr_b16 a[238:239], v97 offset:11264
    s_lshl_b32 s45, s79, 9
    s_lshl_b32 s76, s40, 4
    s_add_u32 s45, s45, s76
    v_mfma_f32_32x32x16_bf16 v[32:47], a[248:251], v[140:143], v[32:47]
    ds_read_b64_tr_b16 a[240:241], v96 offset:12288
    ds_read_b64_tr_b16 a[242:243], v96 offset:13312
    global_load_dword v99, v120, s[60:61]
    s_add_u32 s45, s45, 15401216
    v_mfma_f32_32x32x16_bf16 v[48:63], a[252:255], v[140:143], v[48:63]
    ds_read_b64_tr_b16 a[244:245], v97 offset:12288
    ds_read_b64_tr_b16 a[246:247], v97 offset:13312
    v_lshrrev_b32 v29, 4, v7
    v_mov_b32 v30, 2146435072
    s_waitcnt lgkmcnt(4)
    v_mfma_f32_32x32x16_bf16 v[32:47], a[224:227], v[144:147], v[32:47]
    ds_read_b64_tr_b16 a[248:249], v96 offset:14336
    ds_read_b64_tr_b16 a[250:251], v96 offset:15360
    s_add_u32 m0, s55, 14336
    s_add_u32 s57, s47, s52
    s_lshr_b32 s100, s41, 4
    v_mfma_f32_32x32x16_bf16 v[48:63], a[228:231], v[144:147], v[48:63]
    ds_read_b64_tr_b16 a[252:253], v97 offset:14336
    ds_read_b64_tr_b16 a[254:255], v97 offset:15360
    buffer_load_dwordx4 v116, s[8:11], s57 offen offset:0 lds
    s_lshl_b32 s86, s42, 1
    v_mfma_f32_32x32x16_bf16 v[32:47], a[232:235], v[148:151], v[32:47]
    ds_read_b64_tr_b16 a[224:225], v96 offset:16384
    ds_read_b64_tr_b16 a[226:227], v96 offset:17408
    s_add_u32 s86, s86, s100
    s_and_b32 s100, s41, 15
    s_lshl_b32 s100, s100, 2
    v_mfma_f32_32x32x16_bf16 v[48:63], a[236:239], v[148:151], v[48:63]
    ds_read_b64_tr_b16 a[228:229], v97 offset:16384
    ds_read_b64_tr_b16 a[230:231], v97 offset:17408
    s_add_u32 s87, s100, s40
    s_mul_i32 s88, s40, 3
    s_waitcnt lgkmcnt(4)
    v_mfma_f32_32x32x16_bf16 v[32:47], a[240:243], v[152:155], v[32:47]
    ds_read_b64_tr_b16 a[232:233], v96 offset:18432
    ds_read_b64_tr_b16 a[234:235], v96 offset:19456
    buffer_load_dwordx4 v117, s[8:11], s57 offen offset:1024 lds
    s_add_u32 s88, s88, s100
    v_mfma_f32_32x32x16_bf16 v[48:63], a[244:247], v[152:155], v[48:63]
    ds_read_b64_tr_b16 a[236:237], v97 offset:18432
    ds_read_b64_tr_b16 a[238:239], v97 offset:19456
    s_sub_u32 s88, s88, 8
    s_mul_i32 s100, s87, 28928
    s_mul_i32 s101, s86, 1792
    v_mfma_f32_32x32x16_bf16 v[32:47], a[248:251], v[156:159], v[32:47]
    ds_read_b64_tr_b16 a[240:241], v96 offset:20480
    ds_read_b64_tr_b16 a[242:243], v96 offset:21504
    buffer_load_dwordx4 v118, s[8:11], s57 offen offset:2048 lds
    s_add_u32 s96, s100, s101
    v_mfma_f32_32x32x16_bf16 v[48:63], a[252:255], v[156:159], v[48:63]
    ds_read_b64_tr_b16 a[244:245], v97 offset:20480
    ds_read_b64_tr_b16 a[246:247], v97 offset:21504
    s_mul_i32 s100, s87, 33024
    s_lshl_b32 s101, s86, 11
    s_waitcnt lgkmcnt(4)
    v_mfma_f32_32x32x16_bf16 v[32:47], a[224:227], v[160:163], v[32:47]
    ds_read_b64_tr_b16 a[248:249], v96 offset:22528
    ds_read_b64_tr_b16 a[250:251], v96 offset:23552
    buffer_load_dwordx4 v119, s[8:11], s57 offen offset:3072 lds
    s_add_u32 s100, s100, s101
    s_nop 0
    v_mfma_f32_32x32x16_bf16 v[48:63], a[228:231], v[160:163], v[48:63]
    ds_read_b64_tr_b16 a[252:253], v97 offset:22528
    ds_read_b64_tr_b16 a[254:255], v97 offset:23552
    s_add_u32 m0, s55, 18432
    s_add_u32 s57, s57, 344064
    s_add_u32 s43, s100, 5701632
    v_mfma_f32_32x32x16_bf16 v[32:47], a[232:235], v[164:167], v[32:47]
    ds_read_b64_tr_b16 a[224:225], v96 offset:24576
    ds_read_b64_tr_b16 a[226:227], v96 offset:25600
    buffer_load_dwordx4 v116, s[8:11], s57 offen offset:0 lds
    s_lshl_b32 s100, s87, 9
    v_mfma_f32_32x32x16_bf16 v[48:63], a[236:239], v[164:167], v[48:63]
    ds_read_b64_tr_b16 a[228:229], v97 offset:24576
    ds_read_b64_tr_b16 a[230:231], v97 offset:25600
    s_lshl_b32 s101, s86, 2
    s_add_u32 s100, s100, s101
    s_waitcnt lgkmcnt(4)
    v_mfma_f32_32x32x16_bf16 v[32:47], a[240:243], v[168:171], v[32:47]
    ds_read_b64_tr_b16 a[232:233], v96 offset:26624
    ds_read_b64_tr_b16 a[234:235], v96 offset:27648
    buffer_load_dwordx4 v117, s[8:11], s57 offen offset:1024 lds
    s_add_u32 s3, s100, 15401216
    v_mfma_f32_32x32x16_bf16 v[48:63], a[244:247], v[168:171], v[48:63]
    ds_read_b64_tr_b16 a[236:237], v97 offset:26624
    ds_read_b64_tr_b16 a[238:239], v97 offset:27648
    s_waitcnt vmcnt(15) lgkmcnt(0)
    s_barrier
    v_mfma_f32_32x32x16_bf16 v[32:47], a[248:251], v[172:175], v[32:47]
    ds_read_b64_tr_b16 a[240:241], v1 offset:0
    ds_read_b64_tr_b16 a[242:243], v1 offset:28672
    buffer_load_dwordx4 v118, s[8:11], s57 offen offset:2048 lds
    s_mul_i32 s100, s86, 28
    s_nop 0
    v_mfma_f32_32x32x16_bf16 v[48:63], a[252:255], v[172:175], v[48:63]
    ds_read_b64_tr_b16 a[244:245], v2 offset:0
    ds_read_b64_tr_b16 a[246:247], v2 offset:28672
    v_readlane_b32 s56, v31, 0
    s_add_u32 m0, s62, 32768
    v_mfma_f32_32x32x16_bf16 v[32:47], a[224:227], v[176:179], v[32:47]
    ds_read_b64_tr_b16 a[248:249], v3 offset:0
    ds_read_b64_tr_b16 a[250:251], v3 offset:28672
    s_nop 0
    buffer_load_dwordx4 v248, s[20:23], s56 offen offset:0 lds
    s_add_u32 s101, s100, 27
    v_mfma_f32_32x32x16_bf16 v[48:63], a[228:231], v[176:179], v[48:63]
    ds_read_b64_tr_b16 a[252:253], v4 offset:0
    ds_read_b64_tr_b16 a[254:255], v4 offset:28672
    s_lshr_b32 s100, s100, 6
    s_lshr_b32 s101, s101, 6
    v_lshrrev_b32_e64 v24, 2, v29
    v_mfma_f32_32x32x16_bf16 v[32:47], a[232:235], v[180:183], v[32:47]
    ds_read_b64_tr_b16 a[224:225], v1 offset:1024
    ds_read_b64_tr_b16 a[226:227], v1 offset:29696
    buffer_load_dwordx4 v249, s[20:23], s56 offen offset:1024 lds
    v_add_u32_e64 v24, s88, v24
    v_mfma_f32_32x32x16_bf16 v[48:63], a[236:239], v[180:183], v[48:63]
    ds_read_b64_tr_b16 a[228:229], v2 offset:1024
    ds_read_b64_tr_b16 a[230:231], v2 offset:29696
    v_bfe_u32 v25, v29, 1, 1
    v_mad_u32_u24 v25, v25, 7, 7
    v_cmp_gt_u32 s[90:91], 12, v29
    s_waitcnt lgkmcnt(4)
    v_mfma_f32_32x32x16_bf16 v[32:47], a[240:243], v[184:187], v[32:47]
    ds_read_b64_tr_b16 a[232:233], v3 offset:1024
    ds_read_b64_tr_b16 a[234:235], v3 offset:29696
    buffer_load_dwordx4 v250, s[20:23], s56 offen offset:2048 lds
    v_mov_b32 v26, s87
    v_mfma_f32_32x32x16_bf16 v[48:63], a[244:247], v[184:187], v[48:63]
    ds_read_b64_tr_b16 a[236:237], v4 offset:1024
    ds_read_b64_tr_b16 a[238:239], v4 offset:29696
    v_and_b32_e64 v27, 1, v29
    v_cndmask_b32 v24, v26, v24, s[90:91]
    v_cndmask_b32 v25, 0, v25, s[90:91]
    v_cmp_eq_u32 s[90:91], 1, v27
    v_mfma_f32_32x32x16_bf16 v[32:47], a[248:251], v[188:191], v[32:47]
    ds_read_b64_tr_b16 a[240:241], v1 offset:2048
    ds_read_b64_tr_b16 a[242:243], v1 offset:30720
    buffer_load_dwordx4 v251, s[20:23], s56 offen offset:3072 lds
    v_mov_b32_e64 v26, s100
    v_mfma_f32_32x32x16_bf16 v[48:63], a[252:255], v[188:191], v[48:63]
    ds_read_b64_tr_b16 a[244:245], v2 offset:2048
    ds_read_b64_tr_b16 a[246:247], v2 offset:30720
    v_readlane_b32 s56, v31, 1
    s_add_u32 m0, s62, 0
    s_waitcnt lgkmcnt(4)
    v_mfma_f32_32x32x16_bf16 v[32:47], a[224:227], v[192:195], v[32:47]
    ds_read_b64_tr_b16 a[248:249], v3 offset:2048
    ds_read_b64_tr_b16 a[250:251], v3 offset:30720
    buffer_load_dwordx4 v248, s[20:23], s56 offen offset:0 lds
    v_mov_b32_e64 v28, s101
    v_mfma_f32_32x32x16_bf16 v[48:63], a[228:231], v[192:195], v[48:63]
    ds_read_b64_tr_b16 a[252:253], v4 offset:2048
    ds_read_b64_tr_b16 a[254:255], v4 offset:30720
    v_cndmask_b32 v26, v26, v28, s[90:91]
    v_cmp_gt_u32 s[90:91], 14, v29
    v_cmp_le_i32 s[76:77], 0, v24
    v_add_u32_e64 v25, v25, v26
    v_mfma_f32_32x32x16_bf16 v[32:47], a[232:235], v[196:199], v[32:47]
    ds_read_b64_tr_b16 a[224:225], v1 offset:3072
    ds_read_b64_tr_b16 a[226:227], v1 offset:31744
    v_lshlrev_b32 v24, 9, v24
    v_lshl_add_u32 v24, v25, 2, v24
    s_and_b64 s[90:91], s[90:91], s[76:77]
    v_mfma_f32_32x32x16_bf16 v[48:63], a[236:239], v[196:199], v[48:63]
    ds_read_b64_tr_b16 a[228:229], v2 offset:3072
    ds_read_b64_tr_b16 a[230:231], v2 offset:31744
    buffer_load_dwordx4 v249, s[20:23], s56 offen offset:1024 lds
    s_waitcnt lgkmcnt(4)
    v_mfma_f32_32x32x16_bf16 v[32:47], a[240:243], v[200:203], v[32:47]
    ds_read_b64_tr_b16 a[232:233], v3 offset:3072
    ds_read_b64_tr_b16 a[234:235], v3 offset:31744
    v_add_u32 v24, 15400960, v24
    v_cndmask_b32 v244, v30, v24, s[90:91]
    s_add_u32 s100, s88, 0
    v_mfma_f32_32x32x16_bf16 v[48:63], a[244:247], v[200:203], v[48:63]
    ds_read_b64_tr_b16 a[236:237], v4 offset:3072
    ds_read_b64_tr_b16 a[238:239], v4 offset:31744
    buffer_load_dwordx4 v250, s[20:23], s56 offen offset:2048 lds
    s_mul_i32 s101, s100, 28928
    v_mfma_f32_32x32x16_bf16 v[32:47], a[248:251], v[204:207], v[32:47]
    ds_read_b64_tr_b16 a[240:241], v1 offset:4096
    ds_read_b64_tr_b16 a[242:243], v1 offset:32768
    s_mul_i32 s80, s86, 1792
    s_add_u32 s80, s80, s101
    s_add_u32 s80, s80, 1900544
    v_mfma_f32_32x32x16_bf16 v[48:63], a[252:255], v[204:207], v[48:63]
    ds_read_b64_tr_b16 a[244:245], v2 offset:4096
    ds_read_b64_tr_b16 a[246:247], v2 offset:32768
    buffer_load_dwordx4 v251, s[20:23], s56 offen offset:3072 lds
    s_waitcnt lgkmcnt(4)
    v_mfma_f32_32x32x16_bf16 v[32:47], a[224:227], v[208:211], v[32:47]
    ds_read_b64_tr_b16 a[248:249], v3 offset:4096
    ds_read_b64_tr_b16 a[250:251], v3 offset:32768
    v_readlane_b32 s56, v31, 2
    s_add_u32 m0, s62, 16384
    s_mul_i32 s81, s86, 448
    v_mfma_f32_32x32x16_bf16 v[48:63], a[228:231], v[208:211], v[48:63]
    ds_read_b64_tr_b16 a[252:253], v4 offset:4096
    ds_read_b64_tr_b16 a[254:255], v4 offset:32768
    buffer_load_dwordx4 v248, s[20:23], s56 offen offset:0 lds
    s_add_u32 s81, s81, s101
    v_mfma_f32_32x32x16_bf16 v[32:47], a[232:235], v[212:215], v[32:47]
    ds_read_b64_tr_b16 a[224:225], v1 offset:5120
    ds_read_b64_tr_b16 a[226:227], v1 offset:33792
    s_add_u32 s81, s81, 3801088
    s_cmp_lt_i32 s100, 0
    s_cselect_b32 s80, 15532032, s80
    s_cselect_b32 s81, 15532032, s81
    v_mfma_f32_32x32x16_bf16 v[48:63], a[236:239], v[212:215], v[48:63]
    ds_read_b64_tr_b16 a[228:229], v2 offset:5120
    ds_read_b64_tr_b16 a[230:231], v2 offset:33792
    buffer_load_dwordx4 v249, s[20:23], s56 offen offset:1024 lds
    s_waitcnt lgkmcnt(4)
    v_mfma_f32_32x32x16_bf16 v[32:47], a[240:243], v[216:219], v[32:47]
    ds_read_b64_tr_b16 a[232:233], v3 offset:5120
    ds_read_b64_tr_b16 a[234:235], v3 offset:33792
    s_waitcnt vmcnt(18)
    v_cmp_eq_u32 vcc, 0, v255
    s_cbranch_vccnz Lslow_5
Lback_6:
    v_mfma_f32_32x32x16_bf16 v[48:63], a[244:247], v[216:219], v[48:63]
    ds_read_b64_tr_b16 a[236:237], v4 offset:5120
    ds_read_b64_tr_b16 a[238:239], v4 offset:33792
    buffer_load_dwordx4 v250, s[20:23], s56 offen offset:2048 lds
    s_add_u32 s100, s88, 1
    v_mfma_f32_32x32x16_bf16 v[32:47], a[248:251], v[220:223], v[32:47]
    ds_read_b64_tr_b16 a[240:241], v1 offset:6144
    ds_read_b64_tr_b16 a[242:243], v1 offset:34816
    s_mul_i32 s101, s100, 28928
    s_mul_i32 s82, s86, 1792
    s_add_u32 s82, s82, s101
    v_mfma_f32_32x32x16_bf16 v[48:63], a[252:255], v[220:223], v[48:63]
    ds_read_b64_tr_b16 a[244:245], v2 offset:6144
    ds_read_b64_tr_b16 a[246:247], v2 offset:34816
    buffer_load_dwordx4 v251, s[20:23], s56 offen offset:3072 lds
    s_waitcnt lgkmcnt(4)
    v_mfma_f32_32x32x16_bf16 v[32:47], a[224:227], v[224:227], v[32:47]
    ds_read_b64_tr_b16 a[248:249], v3 offset:6144
    ds_read_b64_tr_b16 a[250:251], v3 offset:34816
    s_add_u32 s82, s82, 1900544
    s_mul_i32 s83, s86, 448
    s_add_u32 s83, s83, s101
    v_mfma_f32_32x32x16_bf16 v[48:63], a[228:231], v[224:227], v[48:63]
    ds_read_b64_tr_b16 a[252:253], v4 offset:6144
    ds_read_b64_tr_b16 a[254:255], v4 offset:34816
    s_barrier
    v_mfma_f32_32x32x16_bf16 v[32:47], a[232:235], v[228:231], v[32:47]
    ds_read_b64_tr_b16 a[224:225], v1 offset:7168
    ds_read_b64_tr_b16 a[226:227], v1 offset:35840
    s_add_u32 s83, s83, 3801088
    s_cmp_lt_i32 s100, 0
    s_cselect_b32 s82, 15532032, s82
    s_cselect_b32 s83, 15532032, s83
    v_mfma_f32_32x32x16_bf16 v[48:63], a[236:239], v[228:231], v[48:63]
    ds_read_b64_tr_b16 a[228:229], v2 offset:7168
    ds_read_b64_tr_b16 a[230:231], v2 offset:35840
    s_add_u32 s100, s88, 2
    s_mul_i32 s101, s100, 28928
    s_waitcnt lgkmcnt(4)
    v_mfma_f32_32x32x16_bf16 v[32:47], a[240:243], v[232:235], v[32:47]
    ds_read_b64_tr_b16 a[232:233], v3 offset:7168
    ds_read_b64_tr_b16 a[234:235], v3 offset:35840
    s_mul_i32 s84, s86, 1792
    s_add_u32 s84, s84, s101
    s_nop 0
    s_add_u32 s84, s84, 1900544
    v_mfma_f32_32x32x16_bf16 v[48:63], a[244:247], v[232:235], v[48:63]
    ds_read_b64_tr_b16 a[236:237], v4 offset:7168
    ds_read_b64_tr_b16 a[238:239], v4 offset:35840
    s_mul_i32 s85, s86, 448
    s_add_u32 s85, s85, s101
    s_add_u32 s85, s85, 3801088
    v_mfma_f32_32x32x16_bf16 v[32:47], a[248:251], v[236:239], v[32:47]
    ds_read_b64_tr_b16 a[240:241], v1 offset:8192
    ds_read_b64_tr_b16 a[242:243], v1 offset:36864
    s_cmp_lt_i32 s100, 0
    s_cselect_b32 s84, 15532032, s84
    s_cselect_b32 s85, 15532032, s85
    v_mfma_f32_32x32x16_bf16 v[48:63], a[252:255], v[236:239], v[48:63]
    ds_read_b64_tr_b16 a[244:245], v2 offset:8192
    ds_read_b64_tr_b16 a[246:247], v2 offset:36864
    s_cmp_lt_i32 s88, 0
    s_cselect_b32 s86, 0xf149, 0
    s_waitcnt lgkmcnt(4)
    v_mfma_f32_32x32x16_bf16 v[64:79], a[224:227], v[128:131], 0
    ds_read_b64_tr_b16 a[248:249], v3 offset:8192
    ds_read_b64_tr_b16 a[250:251], v3 offset:36864
    s_cmp_lt_i32 s88, -1
    s_cselect_b32 s87, 0xf149, 0
    s_cmp_lt_i32 s88, -2
    s_cselect_b32 s88, 0xf149, 0
    v_mfma_f32_32x32x16_bf16 v[80:95], a[228:231], v[128:131], 0
    ds_read_b64_tr_b16 a[252:253], v4 offset:8192
    ds_read_b64_tr_b16 a[254:255], v4 offset:36864
    v_lshrrev_b32 v28, 4, v7
    v_lshrrev_b32 v29, 9, v7
    v_and_b32 v30, 31, v28
    v_lshlrev_b32 v24, 2, v29
    v_mfma_f32_32x32x16_bf16 v[64:79], a[232:235], v[132:135], v[64:79]
    ds_read_b64_tr_b16 a[224:225], v1 offset:9216
    ds_read_b64_tr_b16 a[226:227], v1 offset:37888
    v_sub_u32_e64 v24, v30, v24
    v_mov_b32 v25, 0x0000ffff
    v_mov_b32 v26, 0xffff0000
    v_cmp_le_i32 s[100:101], 0, v24
    v_mfma_f32_32x32x16_bf16 v[80:95], a[236:239], v[132:135], v[80:95]
    ds_read_b64_tr_b16 a[228:229], v2 offset:9216
    ds_read_b64_tr_b16 a[230:231], v2 offset:37888
    v_mul_f32 v246, s66, v253
    v_mul_f32 v32, v246, v32
    v_mul_f32 v33, v246, v33
    s_waitcnt lgkmcnt(4)
    v_mfma_f32_32x32x16_bf16 v[64:79], a[240:243], v[136:139], v[64:79]
    ds_read_b64_tr_b16 a[232:233], v3 offset:9216
    ds_read_b64_tr_b16 a[234:235], v3 offset:37888
    v_mul_f32 v34, v246, v34
    v_mul_f32 v35, v246, v35
    v_cvt_pk_bf16_f32 v32, v32, v33
    v_cvt_pk_bf16_f32 v33, v34, v35
    v_mfma_f32_32x32x16_bf16 v[80:95], a[244:247], v[136:139], v[80:95]
    ds_read_b64_tr_b16 a[236:237], v4 offset:9216
    ds_read_b64_tr_b16 a[238:239], v4 offset:37888
    buffer_store_dwordx2 v[32:33], v252, s[28:31], s63 offen offset:0 sc1
    v_mul_f32_e64 v36, v246, v36
    v_mfma_f32_32x32x16_bf16 v[64:79], a[248:251], v[140:143], v[64:79]
    ds_read_b64_tr_b16 a[240:241], v1 offset:10240
    ds_read_b64_tr_b16 a[242:243], v1 offset:38912
    v_mul_f32 v37, v246, v37
    v_mul_f32 v38, v246, v38
    v_mul_f32_e64 v39, v246, v39
    v_cvt_pk_bf16_f32 v36, v36, v37
    v_mfma_f32_32x32x16_bf16 v[80:95], a[252:255], v[140:143], v[80:95]
    ds_read_b64_tr_b16 a[244:245], v2 offset:10240
    ds_read_b64_tr_b16 a[246:247], v2 offset:38912
    v_cvt_pk_bf16_f32 v37, v38, v39
    v_mul_f32 v40, v246, v40
    v_mul_f32 v41, v246, v41
    s_waitcnt lgkmcnt(4)
    v_mfma_f32_32x32x16_bf16 v[64:79], a[224:227], v[144:147], v[64:79]
    ds_read_b64_tr_b16 a[248:249], v3 offset:10240
    ds_read_b64_tr_b16 a[250:251], v3 offset:38912
    s_waitcnt vmcnt(9)
    ds_read_b64_tr_b16 a[0:1], v5 offset:32768
    ds_read_b64_tr_b16 a[2:3], v5 offset:33792
    ds_read_b64_tr_b16 a[4:5], v6 offset:32768
    v_mfma_f32_32x32x16_bf16 v[80:95], a[228:231], v[144:147], v[80:95]
    ds_read_b64_tr_b16 a[252:253], v4 offset:10240
    ds_read_b64_tr_b16 a[254:255], v4 offset:38912
    ds_read_b64_tr_b16 a[6:7], v6 offset:33792
    ds_read_b64_tr_b16 a[8:9], v5 offset:34816
    ds_read_b64_tr_b16 a[10:11], v5 offset:35840
    ds_read_b64_tr_b16 a[12:13], v6 offset:34816
    v_mfma_f32_32x32x16_bf16 v[64:79], a[232:235], v[148:151], v[64:79]
    ds_read_b64_tr_b16 a[224:225], v1 offset:11264
    ds_read_b64_tr_b16 a[226:227], v1 offset:39936
    buffer_store_dwordx2 v[36:37], v252, s[28:31], s63 offen offset:512 sc1
    ds_read_b64_tr_b16 a[14:15], v6 offset:35840
    v_mfma_f32_32x32x16_bf16 v[80:95], a[236:239], v[148:151], v[80:95]
    ds_read_b64_tr_b16 a[228:229], v2 offset:11264
    ds_read_b64_tr_b16 a[230:231], v2 offset:39936
    v_mul_f32_e64 v42, v246, v42
    v_mul_f32 v43, v246, v43
    v_cvt_pk_bf16_f32 v40, v40, v41
    s_waitcnt lgkmcnt(9)
    v_mfma_f32_32x32x16_bf16 v[64:79], a[240:243], v[152:155], v[64:79]
    ds_read_b64_tr_b16 a[232:233], v3 offset:11264
    ds_read_b64_tr_b16 a[234:235], v3 offset:39936
    v_cvt_pk_bf16_f32 v41, v42, v43
    v_mul_f32 v44, v246, v44
    v_mul_f32 v45, v246, v45
    v_cmp_le_i32 s[76:77], 1, v24
    v_mfma_f32_32x32x16_bf16 v[80:95], a[244:247], v[152:155], v[80:95]
    ds_read_b64_tr_b16 a[236:237], v4 offset:11264
    ds_read_b64_tr_b16 a[238:239], v4 offset:39936
    v_mul_f32_e64 v46, v246, v46
    v_cndmask_b32 v8, 0, v25, s[100:101]
    v_cndmask_b32 v27, 0, v26, s[76:77]
    v_cmp_le_i32 s[100:101], 2, v24
    v_mfma_f32_32x32x16_bf16 v[64:79], a[248:251], v[156:159], v[64:79]
    ds_read_b64_tr_b16 a[240:241], v1 offset:12288
    ds_read_b64_tr_b16 a[242:243], v1 offset:40960
    buffer_store_dwordx2 v[40:41], v252, s[28:31], s63 offen offset:1024 sc1
    v_mul_f32_e64 v47, v246, v47
    v_mfma_f32_32x32x16_bf16 v[80:95], a[252:255], v[156:159], v[80:95]
    ds_read_b64_tr_b16 a[244:245], v2 offset:12288
    ds_read_b64_tr_b16 a[246:247], v2 offset:40960
    v_readlane_b32 s56, v31, 3
    s_waitcnt lgkmcnt(10)
    s_add_u32 m0, s62, 32768
    s_waitcnt lgkmcnt(4)
    v_mfma_f32_32x32x16_bf16 v[64:79], a[224:227], v[160:163], v[64:79]
    ds_read_b64_tr_b16 a[248:249], v3 offset:12288
    ds_read_b64_tr_b16 a[250:251], v3 offset:40960
    buffer_load_dwordx4 v248, s[20:23], s56 offen offset:0 lds
    v_cvt_pk_bf16_f32 v44, v44, v45
    v_mfma_f32_32x32x16_bf16 v[80:95], a[228:231], v[160:163], v[80:95]
    ds_read_b64_tr_b16 a[252:253], v4 offset:12288
    ds_read_b64_tr_b16 a[254:255], v4 offset:40960
    v_cvt_pk_bf16_f32 v45, v46, v47
    v_mul_f32 v48, v246, v48
    v_mul_f32 v49, v246, v49
    v_mul_f32_e64 v50, v246, v50
    v_mfma_f32_32x32x16_bf16 v[64:79], a[232:235], v[164:167], v[64:79]
    ds_read_b64_tr_b16 a[224:225], v1 offset:13312
    ds_read_b64_tr_b16 a[226:227], v1 offset:41984
    buffer_load_dwordx4 v249, s[20:23], s56 offen offset:1024 lds
    v_mul_f32_e64 v51, v246, v51
    v_cvt_pk_bf16_f32 v48, v48, v49
    v_mfma_f32_32x32x16_bf16 v[80:95], a[236:239], v[164:167], v[80:95]
    ds_read_b64_tr_b16 a[228:229], v2 offset:13312
    ds_read_b64_tr_b16 a[230:231], v2 offset:41984
    s_waitcnt vmcnt(9)
    ds_read_b64_tr_b16 a[16:17], v5 offset:0
    ds_read_b64_tr_b16 a[18:19], v5 offset:1024
    s_waitcnt lgkmcnt(6)
    v_mfma_f32_32x32x16_bf16 v[64:79], a[240:243], v[168:171], v[64:79]
    ds_read_b64_tr_b16 a[232:233], v3 offset:13312
    ds_read_b64_tr_b16 a[234:235], v3 offset:41984
    buffer_store_dwordx2 v[44:45], v252, s[28:31], s63 offen offset:1536 sc1
    ds_read_b64_tr_b16 a[20:21], v6 offset:0
    v_cvt_pk_bf16_f32 v49, v50, v51
    v_mfma_f32_32x32x16_bf16 v[80:95], a[244:247], v[168:171], v[80:95]
    ds_read_b64_tr_b16 a[236:237], v4 offset:13312
    ds_read_b64_tr_b16 a[238:239], v4 offset:41984
    s_barrier
    s_nop 0
    v_mfma_f32_32x32x16_bf16 v[64:79], a[248:251], v[172:175], v[64:79]
    ds_read_b64_tr_b16 a[240:241], v1 offset:14336
    ds_read_b64_tr_b16 a[242:243], v1 offset:43008
    buffer_load_dwordx4 v250, s[20:23], s56 offen offset:2048 lds
    ds_read_b64_tr_b16 a[22:23], v6 offset:1024
    v_mfma_f32_32x32x16_bf16 v[80:95], a[252:255], v[172:175], v[80:95]
    ds_read_b64_tr_b16 a[244:245], v2 offset:14336
    ds_read_b64_tr_b16 a[246:247], v2 offset:43008
    ds_read_b64_tr_b16 a[24:25], v5 offset:2048
    ds_read_b64_tr_b16 a[26:27], v5 offset:3072
    ds_read_b64_tr_b16 a[28:29], v6 offset:2048
    s_waitcnt lgkmcnt(8)
    s_nop 0
    v_mfma_f32_32x32x16_bf16 v[64:79], a[224:227], v[176:179], v[64:79]
    ds_read_b64_tr_b16 a[248:249], v3 offset:14336
    ds_read_b64_tr_b16 a[250:251], v3 offset:43008
    buffer_store_dwordx2 v[48:49], v252, s[28:31], s63 offen offset:2048 sc1
    ds_read_b64_tr_b16 a[30:31], v6 offset:3072
    v_mfma_f32_32x32x16_bf16 v[80:95], a[228:231], v[176:179], v[80:95]
    ds_read_b64_tr_b16 a[252:253], v4 offset:14336
    ds_read_b64_tr_b16 a[254:255], v4 offset:43008
    buffer_load_dwordx4 v251, s[20:23], s56 offen offset:3072 lds
    v_mul_f32_e64 v52, v246, v52
    v_mfma_f32_32x32x16_bf16 v[64:79], a[232:235], v[180:183], v[64:79]
    ds_read_b64_tr_b16 a[224:225], v1 offset:15360
    ds_read_b64_tr_b16 a[226:227], v1 offset:44032
    v_readlane_b32 s56, v31, 4
    s_waitcnt lgkmcnt(4)
    s_add_u32 m0, s62, 0
    v_mul_f32_e64 v53, v246, v53
    v_mfma_f32_32x32x16_bf16 v[80:95], a[236:239], v[180:183], v[80:95]
    ds_read_b64_tr_b16 a[228:229], v2 offset:15360
    ds_read_b64_tr_b16 a[230:231], v2 offset:44032
    buffer_load_dwordx4 v248, s[20:23], s56 offen offset:0 lds
    s_waitcnt lgkmcnt(4)
    v_mfma_f32_32x32x16_bf16 v[64:79], a[240:243], v[184:187], v[64:79]
    ds_read_b64_tr_b16 a[232:233], v3 offset:15360
    ds_read_b64_tr_b16 a[234:235], v3 offset:44032
    v_mul_f32 v54, v246, v54
    v_mul_f32_e64 v55, v246, v55
    v_cvt_pk_bf16_f32 v52, v52, v53
    v_cvt_pk_bf16_f32 v53, v54, v55
    v_mul_f32_e64 v56, v246, v56
    v_mfma_f32_32x32x16_bf16 v[80:95], a[244:247], v[184:187], v[80:95]
    ds_read_b64_tr_b16 a[236:237], v4 offset:15360
    ds_read_b64_tr_b16 a[238:239], v4 offset:44032
    buffer_store_dwordx2 v[52:53], v252, s[28:31], s63 offen offset:2560 sc1
    s_waitcnt vmcnt(11)
    v_mul_f32 v57, v246, v57
    v_mfma_f32_32x32x16_bf16 v[64:79], a[248:251], v[188:191], v[64:79]
    ds_read_b64_tr_b16 a[240:241], v1 offset:16384
    ds_read_b64_tr_b16 a[242:243], v1 offset:45056
    buffer_load_dwordx4 v249, s[20:23], s56 offen offset:1024 lds
    ds_read_b64_tr_b16 a[32:33], v5 offset:16384
    v_mul_f32_e64 v58, v246, v58
    v_mfma_f32_32x32x16_bf16 v[80:95], a[252:255], v[188:191], v[80:95]
    ds_read_b64_tr_b16 a[244:245], v2 offset:16384
    ds_read_b64_tr_b16 a[246:247], v2 offset:45056
    ds_read_b64_tr_b16 a[34:35], v5 offset:17408
    ds_read_b64_tr_b16 a[36:37], v6 offset:16384
    ds_read_b64_tr_b16 a[38:39], v6 offset:17408
    v_mul_f32 v59, v246, v59
    s_waitcnt lgkmcnt(8)
    v_mfma_f32_32x32x16_bf16 v[64:79], a[224:227], v[192:195], v[64:79]
    ds_read_b64_tr_b16 a[248:249], v3 offset:16384
    ds_read_b64_tr_b16 a[250:251], v3 offset:45056
    buffer_load_dwordx4 v250, s[20:23], s56 offen offset:2048 lds
    ds_read_b64_tr_b16 a[40:41], v5 offset:18432
    v_cvt_pk_bf16_f32 v56, v56, v57
    v_mfma_f32_32x32x16_bf16 v[80:95], a[228:231], v[192:195], v[80:95]
    ds_read_b64_tr_b16 a[252:253], v4 offset:16384
    ds_read_b64_tr_b16 a[254:255], v4 offset:45056
    ds_read_b64_tr_b16 a[42:43], v5 offset:19456
    ds_read_b64_tr_b16 a[44:45], v6 offset:18432
    ds_read_b64_tr_b16 a[46:47], v6 offset:19456
    v_cvt_pk_bf16_f32 v57, v58, v59
    v_mfma_f32_32x32x16_bf16 v[64:79], a[232:235], v[196:199], v[64:79]
    ds_read_b64_tr_b16 a[224:225], v1 offset:17408
    ds_read_b64_tr_b16 a[226:227], v1 offset:46080
    buffer_store_dwordx2 v[56:57], v252, s[28:31], s63 offen offset:3072 sc1
    v_mul_f32_e64 v60, v246, v60
    v_mfma_f32_32x32x16_bf16 v[80:95], a[236:239], v[196:199], v[80:95]
    ds_read_b64_tr_b16 a[228:229], v2 offset:17408
    ds_read_b64_tr_b16 a[230:231], v2 offset:46080
    buffer_load_dwordx4 v251, s[20:23], s56 offen offset:3072 lds
    s_waitcnt lgkmcnt(7)
    v_mfma_f32_32x32x16_bf16 v[64:79], a[240:243], v[200:203], v[64:79]
    ds_read_b64_tr_b16 a[232:233], v3 offset:17408
    ds_read_b64_tr_b16 a[234:235], v3 offset:46080
    v_readlane_b32 s56, v31, 5
    s_waitcnt lgkmcnt(6)
    s_add_u32 m0, s62, 16384
    v_mul_f32_e64 v61, v246, v61
    v_mfma_f32_32x32x16_bf16 v[80:95], a[244:247], v[200:203], v[80:95]
    ds_read_b64_tr_b16 a[236:237], v4 offset:17408
    ds_read_b64_tr_b16 a[238:239], v4 offset:46080
    buffer_load_dwordx4 v248, s[20:23], s56 offen offset:0 lds
    v_mul_f32_e64 v62, v246, v62
    v_mfma_f32_32x32x16_bf16 v[64:79], a[248:251], v[204:207], v[64:79]
    ds_read_b64_tr_b16 a[240:241], v1 offset:18432
    ds_read_b64_tr_b16 a[242:243], v1 offset:47104
    v_mul_f32_e64 v63, v246, v63
    v_cvt_pk_bf16_f32 v60, v60, v61
    v_cvt_pk_bf16_f32 v61, v62, v63
    v_cmp_le_i32 s[76:77], 3, v24
    v_mfma_f32_32x32x16_bf16 v[80:95], a[252:255], v[204:207], v[80:95]
    ds_read_b64_tr_b16 a[244:245], v2 offset:18432
    ds_read_b64_tr_b16 a[246:247], v2 offset:47104
    buffer_store_dwordx2 v[60:61], v252, s[28:31], s63 offen offset:3584 sc1
    s_waitcnt lgkmcnt(4)
    v_mfma_f32_32x32x16_bf16 v[64:79], a[224:227], v[208:211], v[64:79]
    ds_read_b64_tr_b16 a[248:249], v3 offset:18432
    ds_read_b64_tr_b16 a[250:251], v3 offset:47104
    buffer_load_dwordx4 v249, s[20:23], s56 offen offset:1024 lds
    v_or_b32 v8, v8, v27
    v_mfma_f32_32x32x16_bf16 v[80:95], a[228:231], v[208:211], v[80:95]
    ds_read_b64_tr_b16 a[252:253], v4 offset:18432
    ds_read_b64_tr_b16 a[254:255], v4 offset:47104
    v_cndmask_b32 v9, 0, v25, s[100:101]
    v_cndmask_b32 v27, 0, v26, s[76:77]
    v_cmp_le_i32 s[100:101], 8, v24
    v_cmp_le_i32 s[76:77], 9, v24
    v_mfma_f32_32x32x16_bf16 v[64:79], a[232:235], v[212:215], v[64:79]
    ds_read_b64_tr_b16 a[224:225], v1 offset:19456
    ds_read_b64_tr_b16 a[226:227], v1 offset:48128
    buffer_load_dwordx4 v250, s[20:23], s56 offen offset:2048 lds
    v_or_b32_e64 v9, v9, v27
    v_mfma_f32_32x32x16_bf16 v[80:95], a[236:239], v[212:215], v[80:95]
    ds_read_b64_tr_b16 a[228:229], v2 offset:19456
    ds_read_b64_tr_b16 a[230:231], v2 offset:48128
    v_cndmask_b32 v10, 0, v25, s[100:101]
    v_cndmask_b32 v27, 0, v26, s[76:77]
    v_cmp_le_i32 s[100:101], 10, v24
    s_waitcnt lgkmcnt(4)
    v_mfma_f32_32x32x16_bf16 v[64:79], a[240:243], v[216:219], v[64:79]
    ds_read_b64_tr_b16 a[232:233], v3 offset:19456
    ds_read_b64_tr_b16 a[234:235], v3 offset:48128
    v_cmp_le_i32 s[76:77], 11, v24
    v_or_b32 v10, v10, v27
    v_cndmask_b32 v11, 0, v25, s[100:101]
    v_cndmask_b32 v27, 0, v26, s[76:77]
    v_mfma_f32_32x32x16_bf16 v[80:95], a[244:247], v[216:219], v[80:95]
    ds_read_b64_tr_b16 a[236:237], v4 offset:19456
    ds_read_b64_tr_b16 a[238:239], v4 offset:48128
    buffer_load_dwordx4 v251, s[20:23], s56 offen offset:3072 lds
    v_cmp_le_i32 s[100:101], 16, v24
    v_mfma_f32_32x32x16_bf16 v[64:79], a[248:251], v[220:223], v[64:79]
    ds_read_b64_tr_b16 a[240:241], v1 offset:20480
    ds_read_b64_tr_b16 a[242:243], v1 offset:49152
    v_cmp_le_i32 s[76:77], 17, v24
    v_or_b32_e64 v11, v11, v27
    v_cndmask_b32 v12, 0, v25, s[100:101]
    v_cndmask_b32 v27, 0, v26, s[76:77]
    v_mfma_f32_32x32x16_bf16 v[80:95], a[252:255], v[220:223], v[80:95]
    ds_read_b64_tr_b16 a[244:245], v2 offset:20480
    ds_read_b64_tr_b16 a[246:247], v2 offset:49152
    v_cmp_le_i32 s[100:101], 18, v24
    v_cmp_le_i32 s[76:77], 19, v24
    v_or_b32 v12, v12, v27
    s_waitcnt lgkmcnt(4)
    v_mfma_f32_32x32x16_bf16 v[64:79], a[224:227], v[224:227], v[64:79]
    ds_read_b64_tr_b16 a[248:249], v3 offset:20480
    ds_read_b64_tr_b16 a[250:251], v3 offset:49152
    v_cndmask_b32 v13, 0, v25, s[100:101]
    v_cndmask_b32 v27, 0, v26, s[76:77]
    v_cmp_le_i32 s[100:101], 24, v24
    v_cmp_le_i32 s[76:77], 25, v24
    v_mfma_f32_32x32x16_bf16 v[80:95], a[228:231], v[224:227], v[80:95]
    ds_read_b64_tr_b16 a[252:253], v4 offset:20480
    ds_read_b64_tr_b16 a[254:255], v4 offset:49152
    s_barrier
    v_mfma_f32_32x32x16_bf16 v[64:79], a[232:235], v[228:231], v[64:79]
    s_add_u32 m0, s55, 7168
    s_add_u32 s57, s50, s53
    v_or_b32_e64 v13, v13, v27
    v_cndmask_b32 v14, 0, v25, s[100:101]
    v_cndmask_b32 v27, 0, v26, s[76:77]
    v_mfma_f32_32x32x16_bf16 v[80:95], a[236:239], v[228:231], v[80:95]
    buffer_load_dwordx4 v240, s[12:15], s57 offen offset:0 lds
    v_cmp_le_i32 s[100:101], 26, v24
    v_cmp_le_i32 s[76:77], 27, v24
    s_waitcnt lgkmcnt(0)
    v_mfma_f32_32x32x16_bf16 v[64:79], a[240:243], v[232:235], v[64:79]
    v_or_b32 v14, v14, v27
    v_cndmask_b32 v15, 0, v25, s[100:101]
    v_cndmask_b32 v27, 0, v26, s[76:77]
    v_cmp_gt_u32 s[100:101], 48, v28
    v_cmp_gt_u32 s[76:77], 28, v30
    v_or_b32_e64 v15, v15, v27
    v_mfma_f32_32x32x16_bf16 v[80:95], a[244:247], v[232:235], v[80:95]
    buffer_load_dwordx4 v241, s[12:15], s57 offen offset:1024 lds
    v_mov_b32 v27, 2146435072
    v_mul_u32_u24 v23, 7168, v29
    v_cndmask_b32 v22, v27, v7, s[100:101]
    v_mfma_f32_32x32x16_bf16 v[64:79], a[248:251], v[236:239], v[64:79]
    v_cmp_gt_u32 s[100:101], 32, v28
    v_lshl_add_u32 v23, v30, 4, v23
    v_cndmask_b32 v23, v27, v23, s[76:77]
    v_cndmask_b32 v25, v27, v252, s[100:101]
    v_and_b32_e64 v26, 62, v28
    v_mfma_f32_32x32x16_bf16 v[80:95], a[252:255], v[236:239], v[80:95]
    buffer_load_dwordx4 v242, s[12:15], s57 offen offset:2048 lds
    s_mul_i32 s76, s40, 6
    s_bfe_u32 s77, s42, 65537
    s_nop 7
    s_nop 3
    s_add_u32 s76, s76, s77
    s_xor_b32 s77, s76, 1
    s_sub_u32 s77, s77, 6
    v_cmp_gt_u32 s[100:101], 6, v28
    v_add_u32 v24, s77, v26
    v_add_u32 v26, s76, v26
    v_cndmask_b32 v26, v24, v26, s[100:101]
    v_cmp_gt_u32 s[100:101], 12, v28
    s_add_u32 s76, s40, 24
    v_mov_b32 v24, s76
    v_cndmask_b32 v26, v24, v26, s[100:101]
    v_cmp_gt_u32 s[100:101], 14, v28
    v_and_b32 v24, 1, v28
    v_add_u32 v24, s79, v24
    v_lshlrev_b32_e64 v24, 9, v24
    buffer_load_dwordx4 v243, s[12:15], s57 offen offset:3072 lds
    v_lshl_add_u32 v26, v26, 2, v24
    v_add_u32 v26, 15401088, v26
    v_add_u32 v24, 13312, v23
    v_cndmask_b32 v26, v27, v26, s[100:101]
    s_add_u32 s76, s40, 0
    s_cmp_ge_u32 s76, 3
    s_cselect_b32 s77, 16384, 0
    s_lshl_b32 s76, s76, 12
    s_add_u32 s76, s76, s77
    s_add_u32 s76, s76, 7168
    v_add_u32 v16, s76, v252
    v_add_u32 v19, s76, v7
    s_add_u32 m0, s55, 11264
    s_add_u32 s57, s57, 458752
    s_add_u32 s76, s40, 1
    s_cmp_ge_u32 s76, 3
    s_cselect_b32 s77, 16384, 0
    s_lshl_b32 s76, s76, 12
    s_add_u32 s76, s76, s77
    s_add_u32 s76, s76, 7168
    v_add_u32 v17, s76, v252
    v_add_u32 v20, s76, v7
    s_add_u32 s76, s40, 2
    s_cmp_ge_u32 s76, 3
    s_cselect_b32 s77, 16384, 0
    buffer_load_dwordx4 v240, s[12:15], s57 offen offset:0 lds
    v_mul_f32 v246, s67, v253
    v_mul_f32 v64, v246, v64
    v_mul_f32 v65, v246, v65
    v_mul_f32 v66, v246, v66
    v_mul_f32_e64 v67, v246, v67
    v_cvt_pk_bf16_f32 v64, v64, v65
    v_cvt_pk_bf16_f32 v65, v66, v67
    v_mul_f32 v68, v246, v68
    v_mul_f32 v69, v246, v69
    v_mul_f32 v70, v246, v70
    v_mul_f32 v71, v246, v71
    v_cvt_pk_bf16_f32 v68, v68, v69
    v_cvt_pk_bf16_f32 v69, v70, v71
    v_mul_f32 v72, v246, v72
    v_mul_f32 v73, v246, v73
    s_lshl_b32 s76, s76, 12
    s_add_u32 s76, s76, s77
    s_add_u32 s76, s76, 7168
    v_add_u32 v18, s76, v252
    v_add_u32 v21, s76, v7
    v_lshrrev_b32_e64 v27, 3, v28
    v_mul_u32_u24 v27, 896, v27
    v_and_b32_e64 v29, 7, v28
    v_lshl_add_u32 v27, v29, 4, v27
    v_and_b32 v30, 3, v28
    v_lshrrev_b32 v28, 2, v28
    v_lshlrev_b32_e64 v28, 12, v28
    buffer_store_dwordx2 v[64:65], v252, s[28:31], s64 offen offset:0 sc1
    v_mul_f32 v74, v246, v74
    v_mul_f32 v75, v246, v75
    v_lshl_add_u32 v28, v30, 9, v28
    v_add_u32_e64 v28, s55, v28
    v_add_u32 v28, 9664, v28
    v_and_b32 v29, 0xff, v252
    v_add_u32_e64 v29, s55, v29
    v_add_u32 v30, 114944, v7
    buffer_store_dwordx2 v[68:69], v252, s[28:31], s64 offen offset:512 sc1
    v_cvt_pk_bf16_f32 v72, v72, v73
    v_cvt_pk_bf16_f32 v73, v74, v75
    v_mul_f32 v76, v246, v76
    v_mul_f32 v77, v246, v77
    v_mul_f32 v78, v246, v78
    buffer_load_dwordx4 v241, s[12:15], s57 offen offset:1024 lds
    s_waitcnt vmcnt(19)
    ds_read_b64_tr_b16 a[48:49], v5 offset:32768
    ds_read_b64_tr_b16 a[50:51], v5 offset:33792
    ds_read_b64_tr_b16 a[52:53], v6 offset:32768
    ds_read_b64_tr_b16 a[54:55], v6 offset:33792
    ds_read_b64_tr_b16 a[56:57], v5 offset:34816
    ds_read_b64_tr_b16 a[58:59], v5 offset:35840
    ds_read_b64_tr_b16 a[60:61], v6 offset:34816
    ds_read_b64_tr_b16 a[62:63], v6 offset:35840
    v_mul_f32_e64 v79, v246, v79
    v_cvt_pk_bf16_f32 v76, v76, v77
    v_cvt_pk_bf16_f32 v77, v78, v79
    v_mul_f32 v80, v246, v80
    v_mul_f32 v81, v246, v81
    v_mul_f32 v82, v246, v82
    s_waitcnt vmcnt(11)
    buffer_store_dword v255, v0, s[28:31], s69 offen sc1
    v_mul_f32_e64 v83, v246, v83
    v_cvt_pk_bf16_f32 v80, v80, v81
    buffer_store_dwordx2 v[72:73], v252, s[28:31], s64 offen offset:1024 sc1
    v_cvt_pk_bf16_f32 v81, v82, v83
    v_mul_f32 v84, v246, v84
    v_mul_f32 v85, v246, v85
    buffer_store_dwordx2 v[76:77], v252, s[28:31], s64 offen offset:1536 sc1
    v_mul_f32_e64 v86, v246, v86
    buffer_load_dwordx4 v242, s[12:15], s57 offen offset:2048 lds
    v_mul_f32_e64 v87, v246, v87
    v_cvt_pk_bf16_f32 v84, v84, v85
    v_cvt_pk_bf16_f32 v85, v86, v87
    v_mul_f32 v88, v246, v88
    v_mul_f32 v89, v246, v89
    buffer_store_dwordx2 v[80:81], v252, s[28:31], s64 offen offset:2048 sc1
    v_readlane_b32 s56, v31, 6
    s_waitcnt lgkmcnt(0)
    s_add_u32 m0, s62, 32768
    v_mul_f32 v90, v246, v90
    s_nop 1
    buffer_load_dwordx4 v248, s[20:23], s56 offen offset:0 lds
    v_mul_f32 v91, v246, v91
    v_cvt_pk_bf16_f32 v88, v88, v89
    v_cvt_pk_bf16_f32 v89, v90, v91
    v_mul_f32 v92, v246, v92
    v_mul_f32 v93, v246, v93
    buffer_store_dwordx2 v[84:85], v252, s[28:31], s64 offen offset:2560 sc1
    v_mul_f32_e64 v94, v246, v94
    buffer_load_dwordx4 v249, s[20:23], s56 offen offset:1024 lds
    v_mul_f32_e64 v95, v246, v95
    v_cvt_pk_bf16_f32 v92, v92, v93
    v_cvt_pk_bf16_f32 v93, v94, v95
    buffer_store_dwordx2 v[88:89], v252, s[28:31], s64 offen offset:3072 sc1
    s_barrier
    buffer_load_dwordx4 v250, s[20:23], s56 offen offset:2048 lds
    buffer_store_dwordx2 v[92:93], v252, s[28:31], s64 offen offset:3584 sc1
    buffer_load_dwordx4 v251, s[20:23], s56 offen offset:3072 lds
    s_add_u32 m0, s55, 14336
    s_add_u32 s57, s50, s54
    buffer_load_dwordx4 v240, s[12:15], s57 offen offset:0 lds
    buffer_load_dwordx4 v241, s[12:15], s57 offen offset:1024 lds
    buffer_load_dwordx4 v242, s[12:15], s57 offen offset:2048 lds
    buffer_load_dwordx4 v243, s[12:15], s57 offen offset:3072 lds
    ds_read_b64_tr_b16 a[64:65], v5 offset:0
    ds_read_b64_tr_b16 a[66:67], v5 offset:1024
    ds_read_b64_tr_b16 a[68:69], v6 offset:0
    ds_read_b64_tr_b16 a[70:71], v6 offset:1024
    ds_read_b64_tr_b16 a[72:73], v5 offset:2048
    ds_read_b64_tr_b16 a[74:75], v5 offset:3072
    ds_read_b64_tr_b16 a[76:77], v6 offset:2048
    ds_read_b64_tr_b16 a[78:79], v6 offset:3072
    s_add_u32 m0, s55, 18432
    s_add_u32 s57, s57, 458752
    buffer_load_dwordx4 v240, s[12:15], s57 offen offset:0 lds
    buffer_load_dwordx4 v241, s[12:15], s57 offen offset:1024 lds
    buffer_load_dwordx4 v242, s[12:15], s57 offen offset:2048 lds
    v_readlane_b32 s56, v31, 7
    s_waitcnt lgkmcnt(0)
    s_add_u32 m0, s62, 0
    s_nop 2
    buffer_load_dwordx4 v248, s[20:23], s56 offen offset:0 lds
    s_waitcnt vmcnt(28)
    ds_read_b64_tr_b16 a[80:81], v5 offset:16384
    ds_read_b64_tr_b16 a[82:83], v5 offset:17408
    ds_read_b64_tr_b16 a[84:85], v6 offset:16384
    ds_read_b64_tr_b16 a[86:87], v6 offset:17408
    ds_read_b64_tr_b16 a[88:89], v5 offset:18432
    ds_read_b64_tr_b16 a[90:91], v5 offset:19456
    ds_read_b64_tr_b16 a[92:93], v6 offset:18432
    ds_read_b64_tr_b16 a[94:95], v6 offset:19456
    buffer_load_dwordx4 v249, s[20:23], s56 offen offset:1024 lds
    buffer_load_dwordx4 v250, s[20:23], s56 offen offset:2048 lds
    buffer_load_dwordx4 v251, s[20:23], s56 offen offset:3072 lds
    s_waitcnt vmcnt(19)
    s_barrier
    s_waitcnt vmcnt(12)
    buffer_store_dword v255, v0, s[28:31], s70 offen sc1
    v_readlane_b32 s56, v31, 8
    s_waitcnt lgkmcnt(0)
    s_add_u32 m0, s62, 16384
    ds_read_b64_tr_b16 a[224:225], v1 offset:7168
    ds_read_b64_tr_b16 a[226:227], v1 offset:35840
    s_nop 0
    s_nop 0
    buffer_load_dwordx4 v248, s[20:23], s56 offen offset:0 lds
    ds_read_b64_tr_b16 a[228:229], v2 offset:7168
    ds_read_b64_tr_b16 a[230:231], v2 offset:35840
    ds_read_b64_tr_b16 a[232:233], v3 offset:7168
    ds_read_b64_tr_b16 a[234:235], v3 offset:35840
    buffer_load_dwordx4 v249, s[20:23], s56 offen offset:1024 lds
    ds_read_b64_tr_b16 a[236:237], v4 offset:7168
    ds_read_b64_tr_b16 a[238:239], v4 offset:35840
    ds_read_b64_tr_b16 a[240:241], v1 offset:8192
    ds_read_b64_tr_b16 a[242:243], v1 offset:36864
    buffer_load_dwordx4 v250, s[20:23], s56 offen offset:2048 lds
    ds_read_b64_tr_b16 a[244:245], v2 offset:8192
    ds_read_b64_tr_b16 a[246:247], v2 offset:36864
    s_waitcnt lgkmcnt(4)
    s_nop 0
    v_mfma_f32_32x32x16_bf16 v[32:47], a[224:227], v[128:131], 0
    ds_read_b64_tr_b16 a[248:249], v3 offset:8192
    ds_read_b64_tr_b16 a[250:251], v3 offset:36864
    buffer_load_dwordx4 v251, s[20:23], s56 offen offset:3072 lds
    v_mfma_f32_32x32x16_bf16 v[48:63], a[228:231], v[128:131], 0
    ds_read_b64_tr_b16 a[252:253], v4 offset:8192
    ds_read_b64_tr_b16 a[254:255], v4 offset:36864
    s_add_u32 m0, s55, 21504
    s_add_u32 s57, s50, s53
    v_mfma_f32_32x32x16_bf16 v[32:47], a[232:235], v[132:135], v[32:47]
    ds_read_b64_tr_b16 a[224:225], v1 offset:9216
    ds_read_b64_tr_b16 a[226:227], v1 offset:37888
    buffer_load_dwordx4 v240, s[16:19], s57 offen offset:0 lds
    v_mfma_f32_32x32x16_bf16 v[48:63], a[236:239], v[132:135], v[48:63]
    ds_read_b64_tr_b16 a[228:229], v2 offset:9216
    ds_read_b64_tr_b16 a[230:231], v2 offset:37888
    s_waitcnt lgkmcnt(4)
    v_mfma_f32_32x32x16_bf16 v[32:47], a[240:243], v[136:139], v[32:47]
    ds_read_b64_tr_b16 a[232:233], v3 offset:9216
    ds_read_b64_tr_b16 a[234:235], v3 offset:37888
    buffer_load_dwordx4 v241, s[16:19], s57 offen offset:1024 lds
    v_mfma_f32_32x32x16_bf16 v[48:63], a[244:247], v[136:139], v[48:63]
    ds_read_b64_tr_b16 a[236:237], v4 offset:9216
    ds_read_b64_tr_b16 a[238:239], v4 offset:37888
    v_mfma_f32_32x32x16_bf16 v[32:47], a[248:251], v[140:143], v[32:47]
    ds_read_b64_tr_b16 a[240:241], v1 offset:10240
    ds_read_b64_tr_b16 a[242:243], v1 offset:38912
    buffer_load_dwordx4 v242, s[16:19], s57 offen offset:2048 lds
    v_mfma_f32_32x32x16_bf16 v[48:63], a[252:255], v[140:143], v[48:63]
    ds_read_b64_tr_b16 a[244:245], v2 offset:10240
    ds_read_b64_tr_b16 a[246:247], v2 offset:38912
    s_waitcnt lgkmcnt(4)
    s_nop 0
    v_mfma_f32_32x32x16_bf16 v[32:47], a[224:227], v[144:147], v[32:47]
    ds_read_b64_tr_b16 a[248:249], v3 offset:10240
    ds_read_b64_tr_b16 a[250:251], v3 offset:38912
    buffer_load_dwordx4 v243, s[16:19], s57 offen offset:3072 lds
    v_mfma_f32_32x32x16_bf16 v[48:63], a[228:231], v[144:147], v[48:63]
    ds_read_b64_tr_b16 a[252:253], v4 offset:10240
    ds_read_b64_tr_b16 a[254:255], v4 offset:38912
    s_add_u32 m0, s55, 25600
    s_add_u32 s57, s57, 458752
    s_waitcnt vmcnt(20)
    s_nop 0
    v_mfma_f32_32x32x16_bf16 v[32:47], a[232:235], v[148:151], v[32:47]
    ds_read_b64_tr_b16 a[224:225], v1 offset:11264
    ds_read_b64_tr_b16 a[226:227], v1 offset:39936
    buffer_load_dwordx4 v240, s[16:19], s57 offen offset:0 lds
    ds_read_b64_tr_b16 a[96:97], v5 offset:32768
    v_mfma_f32_32x32x16_bf16 v[48:63], a[236:239], v[148:151], v[48:63]
    ds_read_b64_tr_b16 a[228:229], v2 offset:11264
    ds_read_b64_tr_b16 a[230:231], v2 offset:39936
    ds_read_b64_tr_b16 a[98:99], v5 offset:33792
    ds_read_b64_tr_b16 a[100:101], v6 offset:32768
    ds_read_b64_tr_b16 a[102:103], v6 offset:33792
    s_waitcnt lgkmcnt(8)
    s_nop 0
    v_mfma_f32_32x32x16_bf16 v[32:47], a[240:243], v[152:155], v[32:47]
    ds_read_b64_tr_b16 a[232:233], v3 offset:11264
    ds_read_b64_tr_b16 a[234:235], v3 offset:39936
    buffer_load_dwordx4 v241, s[16:19], s57 offen offset:1024 lds
    ds_read_b64_tr_b16 a[104:105], v5 offset:34816
    v_mfma_f32_32x32x16_bf16 v[48:63], a[244:247], v[152:155], v[48:63]
    ds_read_b64_tr_b16 a[236:237], v4 offset:11264
    ds_read_b64_tr_b16 a[238:239], v4 offset:39936
    ds_read_b64_tr_b16 a[106:107], v5 offset:35840
    ds_read_b64_tr_b16 a[108:109], v6 offset:34816
    ds_read_b64_tr_b16 a[110:111], v6 offset:35840
    v_mfma_f32_32x32x16_bf16 v[32:47], a[248:251], v[156:159], v[32:47]
    ds_read_b64_tr_b16 a[240:241], v1 offset:12288
    ds_read_b64_tr_b16 a[242:243], v1 offset:40960
    v_mfma_f32_32x32x16_bf16 v[48:63], a[252:255], v[156:159], v[48:63]
    ds_read_b64_tr_b16 a[244:245], v2 offset:12288
    ds_read_b64_tr_b16 a[246:247], v2 offset:40960
    buffer_load_dwordx4 v242, s[16:19], s57 offen offset:2048 lds
    s_waitcnt lgkmcnt(7)
    v_mfma_f32_32x32x16_bf16 v[32:47], a[224:227], v[160:163], v[32:47]
    ds_read_b64_tr_b16 a[248:249], v3 offset:12288
    ds_read_b64_tr_b16 a[250:251], v3 offset:40960
    v_readlane_b32 s56, v31, 9
    s_waitcnt lgkmcnt(6)
    s_add_u32 m0, s62, 32768
    v_mfma_f32_32x32x16_bf16 v[48:63], a[228:231], v[160:163], v[48:63]
    ds_read_b64_tr_b16 a[252:253], v4 offset:12288
    ds_read_b64_tr_b16 a[254:255], v4 offset:40960
    buffer_load_dwordx4 v248, s[20:23], s56 offen offset:0 lds
    v_mfma_f32_32x32x16_bf16 v[32:47], a[232:235], v[164:167], v[32:47]
    ds_read_b64_tr_b16 a[224:225], v1 offset:13312
    ds_read_b64_tr_b16 a[226:227], v1 offset:41984
    v_mfma_f32_32x32x16_bf16 v[48:63], a[236:239], v[164:167], v[48:63]
    ds_read_b64_tr_b16 a[228:229], v2 offset:13312
    ds_read_b64_tr_b16 a[230:231], v2 offset:41984
    buffer_load_dwordx4 v249, s[20:23], s56 offen offset:1024 lds
    s_waitcnt lgkmcnt(4)
    s_nop 0
    v_mfma_f32_32x32x16_bf16 v[32:47], a[240:243], v[168:171], v[32:47]
    ds_read_b64_tr_b16 a[232:233], v3 offset:13312
    ds_read_b64_tr_b16 a[234:235], v3 offset:41984
    v_mfma_f32_32x32x16_bf16 v[48:63], a[244:247], v[168:171], v[48:63]
    ds_read_b64_tr_b16 a[236:237], v4 offset:13312
    ds_read_b64_tr_b16 a[238:239], v4 offset:41984
    s_waitcnt vmcnt(18)
    s_barrier
    v_mfma_f32_32x32x16_bf16 v[32:47], a[248:251], v[172:175], v[32:47]
    ds_read_b64_tr_b16 a[240:241], v1 offset:14336
    ds_read_b64_tr_b16 a[242:243], v1 offset:43008
    buffer_load_dwordx4 v250, s[20:23], s56 offen offset:2048 lds
    v_mfma_f32_32x32x16_bf16 v[48:63], a[252:255], v[172:175], v[48:63]
    ds_read_b64_tr_b16 a[244:245], v2 offset:14336
    ds_read_b64_tr_b16 a[246:247], v2 offset:43008
    s_waitcnt lgkmcnt(4)
    s_nop 0
    v_mfma_f32_32x32x16_bf16 v[32:47], a[224:227], v[176:179], v[32:47]
    ds_read_b64_tr_b16 a[248:249], v3 offset:14336
    ds_read_b64_tr_b16 a[250:251], v3 offset:43008
    buffer_load_dwordx4 v251, s[20:23], s56 offen offset:3072 lds
    v_mfma_f32_32x32x16_bf16 v[48:63], a[228:231], v[176:179], v[48:63]
    ds_read_b64_tr_b16 a[252:253], v4 offset:14336
    ds_read_b64_tr_b16 a[254:255], v4 offset:43008
    s_add_u32 m0, s55, 0
    s_add_u32 s57, s50, s54
    v_mfma_f32_32x32x16_bf16 v[32:47], a[232:235], v[180:183], v[32:47]
    ds_read_b64_tr_b16 a[224:225], v1 offset:15360
    ds_read_b64_tr_b16 a[226:227], v1 offset:44032
    buffer_load_dwordx4 v240, s[16:19], s57 offen offset:0 lds
    v_mfma_f32_32x32x16_bf16 v[48:63], a[236:239], v[180:183], v[48:63]
    ds_read_b64_tr_b16 a[228:229], v2 offset:15360
    ds_read_b64_tr_b16 a[230:231], v2 offset:44032
    s_waitcnt lgkmcnt(4)
    s_nop 0
    v_mfma_f32_32x32x16_bf16 v[32:47], a[240:243], v[184:187], v[32:47]
    ds_read_b64_tr_b16 a[232:233], v3 offset:15360
    ds_read_b64_tr_b16 a[234:235], v3 offset:44032
    buffer_load_dwordx4 v241, s[16:19], s57 offen offset:1024 lds
    v_mfma_f32_32x32x16_bf16 v[48:63], a[244:247], v[184:187], v[48:63]
    ds_read_b64_tr_b16 a[236:237], v4 offset:15360
    ds_read_b64_tr_b16 a[238:239], v4 offset:44032
    v_mfma_f32_32x32x16_bf16 v[32:47], a[248:251], v[188:191], v[32:47]
    ds_read_b64_tr_b16 a[240:241], v1 offset:16384
    ds_read_b64_tr_b16 a[242:243], v1 offset:45056
    buffer_load_dwordx4 v242, s[16:19], s57 offen offset:2048 lds
    v_mfma_f32_32x32x16_bf16 v[48:63], a[252:255], v[188:191], v[48:63]
    ds_read_b64_tr_b16 a[244:245], v2 offset:16384
    ds_read_b64_tr_b16 a[246:247], v2 offset:45056
    s_waitcnt lgkmcnt(4)
    v_mfma_f32_32x32x16_bf16 v[32:47], a[224:227], v[192:195], v[32:47]
    ds_read_b64_tr_b16 a[248:249], v3 offset:16384
    ds_read_b64_tr_b16 a[250:251], v3 offset:45056
    buffer_load_dwordx4 v243, s[16:19], s57 offen offset:3072 lds
    s_waitcnt vmcnt(20)
    v_mfma_f32_32x32x16_bf16 v[48:63], a[228:231], v[192:195], v[48:63]
    ds_read_b64_tr_b16 a[252:253], v4 offset:16384
    ds_read_b64_tr_b16 a[254:255], v4 offset:45056
    s_add_u32 m0, s55, 4096
    s_add_u32 s57, s57, 458752
    ds_read_b64_tr_b16 a[112:113], v5 offset:0
    v_mfma_f32_32x32x16_bf16 v[32:47], a[232:235], v[196:199], v[32:47]
    ds_read_b64_tr_b16 a[224:225], v1 offset:17408
    ds_read_b64_tr_b16 a[226:227], v1 offset:46080
    buffer_load_dwordx4 v240, s[16:19], s57 offen offset:0 lds
    ds_read_b64_tr_b16 a[114:115], v5 offset:1024
    v_mfma_f32_32x32x16_bf16 v[48:63], a[236:239], v[196:199], v[48:63]
    ds_read_b64_tr_b16 a[228:229], v2 offset:17408
    ds_read_b64_tr_b16 a[230:231], v2 offset:46080
    ds_read_b64_tr_b16 a[116:117], v6 offset:0
    ds_read_b64_tr_b16 a[118:119], v6 offset:1024
    ds_read_b64_tr_b16 a[120:121], v5 offset:2048
    s_waitcnt lgkmcnt(9)
    s_nop 0
    v_mfma_f32_32x32x16_bf16 v[32:47], a[240:243], v[200:203], v[32:47]
    ds_read_b64_tr_b16 a[232:233], v3 offset:17408
    ds_read_b64_tr_b16 a[234:235], v3 offset:46080
    buffer_load_dwordx4 v241, s[16:19], s57 offen offset:1024 lds
    ds_read_b64_tr_b16 a[122:123], v5 offset:3072
    v_mfma_f32_32x32x16_bf16 v[48:63], a[244:247], v[200:203], v[48:63]
    ds_read_b64_tr_b16 a[236:237], v4 offset:17408
    ds_read_b64_tr_b16 a[238:239], v4 offset:46080
    ds_read_b64_tr_b16 a[124:125], v6 offset:2048
    ds_read_b64_tr_b16 a[126:127], v6 offset:3072
    v_mfma_f32_32x32x16_bf16 v[32:47], a[248:251], v[204:207], v[32:47]
    ds_read_b64_tr_b16 a[240:241], v1 offset:18432
    ds_read_b64_tr_b16 a[242:243], v1 offset:47104
    buffer_load_dwordx4 v242, s[16:19], s57 offen offset:2048 lds
    v_mfma_f32_32x32x16_bf16 v[48:63], a[252:255], v[204:207], v[48:63]
    ds_read_b64_tr_b16 a[244:245], v2 offset:18432
    ds_read_b64_tr_b16 a[246:247], v2 offset:47104
    v_readlane_b32 s56, v31, 10
    s_waitcnt lgkmcnt(4)
    s_add_u32 m0, s62, 0
    v_mfma_f32_32x32x16_bf16 v[32:47], a[224:227], v[208:211], v[32:47]
    ds_read_b64_tr_b16 a[248:249], v3 offset:18432
    ds_read_b64_tr_b16 a[250:251], v3 offset:47104
    buffer_load_dwordx4 v248, s[20:23], s56 offen offset:0 lds
    v_mfma_f32_32x32x16_bf16 v[48:63], a[228:231], v[208:211], v[48:63]
    ds_read_b64_tr_b16 a[252:253], v4 offset:18432
    ds_read_b64_tr_b16 a[254:255], v4 offset:47104
    v_mfma_f32_32x32x16_bf16 v[32:47], a[232:235], v[212:215], v[32:47]
    ds_read_b64_tr_b16 a[224:225], v1 offset:19456
    ds_read_b64_tr_b16 a[226:227], v1 offset:48128
    buffer_load_dwordx4 v249, s[20:23], s56 offen offset:1024 lds
    s_waitcnt vmcnt(20)
    v_mfma_f32_32x32x16_bf16 v[48:63], a[236:239], v[212:215], v[48:63]
    ds_read_b64_tr_b16 a[228:229], v2 offset:19456
    ds_read_b64_tr_b16 a[230:231], v2 offset:48128
    ds_read_b64_tr_b16 a[128:129], v5 offset:16384
    ds_read_b64_tr_b16 a[130:131], v5 offset:17408
    ds_read_b64_tr_b16 a[132:133], v6 offset:16384
    s_waitcnt lgkmcnt(7)
    v_mfma_f32_32x32x16_bf16 v[32:47], a[240:243], v[216:219], v[32:47]
    ds_read_b64_tr_b16 a[232:233], v3 offset:19456
    ds_read_b64_tr_b16 a[234:235], v3 offset:48128
    ds_read_b64_tr_b16 a[134:135], v6 offset:17408
    ds_read_b64_tr_b16 a[136:137], v5 offset:18432
    ds_read_b64_tr_b16 a[138:139], v5 offset:19456
    ds_read_b64_tr_b16 a[140:141], v6 offset:18432
    v_mfma_f32_32x32x16_bf16 v[48:63], a[244:247], v[216:219], v[48:63]
    ds_read_b64_tr_b16 a[236:237], v4 offset:19456
    ds_read_b64_tr_b16 a[238:239], v4 offset:48128
    buffer_load_dwordx4 v250, s[20:23], s56 offen offset:2048 lds
    ds_read_b64_tr_b16 a[142:143], v6 offset:19456
    v_mfma_f32_32x32x16_bf16 v[32:47], a[248:251], v[220:223], v[32:47]
    ds_read_b64_tr_b16 a[240:241], v1 offset:20480
    ds_read_b64_tr_b16 a[242:243], v1 offset:49152
    v_mfma_f32_32x32x16_bf16 v[48:63], a[252:255], v[220:223], v[48:63]
    ds_read_b64_tr_b16 a[244:245], v2 offset:20480
    ds_read_b64_tr_b16 a[246:247], v2 offset:49152
    buffer_load_dwordx4 v251, s[20:23], s56 offen offset:3072 lds
    s_waitcnt lgkmcnt(5)
    v_mfma_f32_32x32x16_bf16 v[32:47], a[224:227], v[224:227], v[32:47]
    ds_read_b64_tr_b16 a[248:249], v3 offset:20480
    ds_read_b64_tr_b16 a[250:251], v3 offset:49152
    v_mfma_f32_32x32x16_bf16 v[48:63], a[228:231], v[224:227], v[48:63]
    ds_read_b64_tr_b16 a[252:253], v4 offset:20480
    ds_read_b64_tr_b16 a[254:255], v4 offset:49152
    s_waitcnt vmcnt(15)
    s_barrier
    v_readlane_b32 s56, v31, 11
    s_waitcnt lgkmcnt(8)
    s_add_u32 m0, s62, 16384
    v_mfma_f32_32x32x16_bf16 v[32:47], a[232:235], v[228:231], v[32:47]
    ds_read_b64_tr_b16 a[224:225], v1 offset:21504
    ds_read_b64_tr_b16 a[226:227], v1 offset:50176
    buffer_load_dwordx4 v248, s[20:23], s56 offen offset:0 lds
    v_mfma_f32_32x32x16_bf16 v[48:63], a[236:239], v[228:231], v[48:63]
    ds_read_b64_tr_b16 a[228:229], v2 offset:21504
    ds_read_b64_tr_b16 a[230:231], v2 offset:50176
    s_waitcnt lgkmcnt(4)
    s_nop 0
    v_mfma_f32_32x32x16_bf16 v[32:47], a[240:243], v[232:235], v[32:47]
    ds_read_b64_tr_b16 a[232:233], v3 offset:21504
    ds_read_b64_tr_b16 a[234:235], v3 offset:50176
    buffer_load_dwordx4 v249, s[20:23], s56 offen offset:1024 lds
    v_mfma_f32_32x32x16_bf16 v[48:63], a[244:247], v[232:235], v[48:63]
    ds_read_b64_tr_b16 a[236:237], v4 offset:21504
    ds_read_b64_tr_b16 a[238:239], v4 offset:50176
    v_mfma_f32_32x32x16_bf16 v[32:47], a[248:251], v[236:239], v[32:47]
    ds_read_b64_tr_b16 a[240:241], v1 offset:22528
    ds_read_b64_tr_b16 a[242:243], v1 offset:51200
    buffer_load_dwordx4 v250, s[20:23], s56 offen offset:2048 lds
    v_mfma_f32_32x32x16_bf16 v[48:63], a[252:255], v[236:239], v[48:63]
    ds_read_b64_tr_b16 a[244:245], v2 offset:22528
    ds_read_b64_tr_b16 a[246:247], v2 offset:51200
    s_waitcnt lgkmcnt(4)
    s_nop 0
    v_mfma_f32_32x32x16_bf16 v[96:111], a[224:227], v[128:131], 0
    ds_read_b64_tr_b16 a[248:249], v3 offset:22528
    ds_read_b64_tr_b16 a[250:251], v3 offset:51200
    buffer_load_dword v247, v244, s[28:31], 0 offen sc1
    v_mfma_f32_32x32x16_bf16 v[112:127], a[228:231], v[128:131], 0
    ds_read_b64_tr_b16 a[252:253], v4 offset:22528
    ds_read_b64_tr_b16 a[254:255], v4 offset:51200
    buffer_load_dwordx4 v251, s[20:23], s56 offen offset:3072 lds
    v_lshrrev_b32_e64 v72, 9, v7
    v_mfma_f32_32x32x16_bf16 v[96:111], a[232:235], v[132:135], v[96:111]
    ds_read_b64_tr_b16 a[224:225], v1 offset:23552
    ds_read_b64_tr_b16 a[226:227], v1 offset:52224
    v_lshlrev_b32_e64 v72, 2, v72
    v_bfe_u32 v73, v7, 4, 5
    v_sub_u32_e64 v72, v73, v72
    v_cmp_le_i32 s[8:9], 0, v72
    v_mfma_f32_32x32x16_bf16 v[112:127], a[236:239], v[132:135], v[112:127]
    ds_read_b64_tr_b16 a[228:229], v2 offset:23552
    ds_read_b64_tr_b16 a[230:231], v2 offset:52224
    v_cmp_le_i32 s[10:11], 1, v72
    v_cmp_le_i32 s[12:13], 2, v72
    v_cmp_le_i32 s[14:15], 3, v72
    s_waitcnt lgkmcnt(4)
    s_nop 0
    v_mfma_f32_32x32x16_bf16 v[96:111], a[240:243], v[136:139], v[96:111]
    ds_read_b64_tr_b16 a[232:233], v3 offset:23552
    ds_read_b64_tr_b16 a[234:235], v3 offset:52224
    v_cmp_le_i32 s[16:17], 8, v72
    v_cmp_le_i32 s[18:19], 9, v72
    v_cmp_le_i32 s[36:37], 10, v72
    v_cmp_le_i32 s[38:39], 11, v72
    v_mfma_f32_32x32x16_bf16 v[112:127], a[244:247], v[136:139], v[112:127]
    ds_read_b64_tr_b16 a[236:237], v4 offset:23552
    ds_read_b64_tr_b16 a[238:239], v4 offset:52224
    v_cmp_le_i32 s[46:47], 16, v72
    v_cmp_le_i32 s[48:49], 17, v72
    v_cmp_le_i32 s[50:51], 18, v72
    v_cmp_le_i32 s[52:53], 19, v72
    v_mfma_f32_32x32x16_bf16 v[96:111], a[248:251], v[140:143], v[96:111]
    ds_read_b64_tr_b16 a[240:241], v1 offset:24576
    ds_read_b64_tr_b16 a[242:243], v1 offset:53248
    v_cmp_le_i32 s[64:65], 24, v72
    v_cmp_le_i32 s[66:67], 25, v72
    v_cmp_le_i32 s[68:69], 26, v72
    v_cmp_le_i32 s[76:77], 27, v72
    v_mfma_f32_32x32x16_bf16 v[112:127], a[252:255], v[140:143], v[112:127]
    ds_read_b64_tr_b16 a[244:245], v2 offset:24576
    ds_read_b64_tr_b16 a[246:247], v2 offset:53248
    v_mov_b32 v240, 0x3f803f80
    v_mov_b32 v241, 0x3f803f80
    v_mov_b32 v242, 0x3f803f80
    s_waitcnt lgkmcnt(4)
    s_nop 0
    v_mfma_f32_32x32x16_bf16 v[96:111], a[224:227], v[144:147], v[96:111]
    ds_read_b64_tr_b16 a[248:249], v3 offset:24576
    ds_read_b64_tr_b16 a[250:251], v3 offset:53248
    v_mov_b32 v243, 0x3f803f80
    v_mov_b32 v74, s86
    v_mov_b32 v75, s87
    v_mov_b32 v76, s88
    v_mfma_f32_32x32x16_bf16 v[112:127], a[228:231], v[144:147], v[112:127]
    ds_read_b64_tr_b16 a[252:253], v4 offset:24576
    ds_read_b64_tr_b16 a[254:255], v4 offset:53248
    v_mov_b32 v77, 0x3f80
    v_readfirstlane_b32 s100, v255
    v_mfma_f32_32x32x16_bf16 v[96:111], a[232:235], v[148:151], v[96:111]
    ds_read_b64_tr_b16 a[224:225], v1 offset:25600
    ds_read_b64_tr_b16 a[226:227], v1 offset:54272
    s_cmp_lt_u32 s41, 28
    s_cselect_b32 s78, 0x3f, 0
    s_mov_b32 s79, 0
    v_mfma_f32_32x32x16_bf16 v[112:127], a[236:239], v[148:151], v[112:127]
    ds_read_b64_tr_b16 a[228:229], v2 offset:25600
    ds_read_b64_tr_b16 a[230:231], v2 offset:54272
    s_waitcnt lgkmcnt(4)
    v_mfma_f32_32x32x16_bf16 v[96:111], a[240:243], v[152:155], v[96:111]
    ds_read_b64_tr_b16 a[232:233], v3 offset:25600
    ds_read_b64_tr_b16 a[234:235], v3 offset:54272
    v_mfma_f32_32x32x16_bf16 v[112:127], a[244:247], v[152:155], v[112:127]
    ds_read_b64_tr_b16 a[236:237], v4 offset:25600
    ds_read_b64_tr_b16 a[238:239], v4 offset:54272
    v_mfma_f32_32x32x16_bf16 v[96:111], a[248:251], v[156:159], v[96:111]
    ds_read_b64_tr_b16 a[240:241], v1 offset:26624
    ds_read_b64_tr_b16 a[242:243], v1 offset:55296
    v_mfma_f32_32x32x16_bf16 v[112:127], a[252:255], v[156:159], v[112:127]
    ds_read_b64_tr_b16 a[244:245], v2 offset:26624
    ds_read_b64_tr_b16 a[246:247], v2 offset:55296
    s_waitcnt lgkmcnt(4)
    s_nop 0
    v_mfma_f32_32x32x16_bf16 v[96:111], a[224:227], v[160:163], v[96:111]
    ds_read_b64_tr_b16 a[248:249], v3 offset:26624
    ds_read_b64_tr_b16 a[250:251], v3 offset:55296
    v_mfma_f32_32x32x16_bf16 v[112:127], a[228:231], v[160:163], v[112:127]
    ds_read_b64_tr_b16 a[252:253], v4 offset:26624
    ds_read_b64_tr_b16 a[254:255], v4 offset:55296
    v_mfma_f32_32x32x16_bf16 v[96:111], a[232:235], v[164:167], v[96:111]
    ds_read_b64_tr_b16 a[224:225], v1 offset:27648
    ds_read_b64_tr_b16 a[226:227], v1 offset:56320
    v_mfma_f32_32x32x16_bf16 v[112:127], a[236:239], v[164:167], v[112:127]
    ds_read_b64_tr_b16 a[228:229], v2 offset:27648
    ds_read_b64_tr_b16 a[230:231], v2 offset:56320
    s_waitcnt lgkmcnt(4)
    s_nop 0
    v_mfma_f32_32x32x16_bf16 v[96:111], a[240:243], v[168:171], v[96:111]
    ds_read_b64_tr_b16 a[232:233], v3 offset:27648
    ds_read_b64_tr_b16 a[234:235], v3 offset:56320
    v_mfma_f32_32x32x16_bf16 v[112:127], a[244:247], v[168:171], v[112:127]
    ds_read_b64_tr_b16 a[236:237], v4 offset:27648
    ds_read_b64_tr_b16 a[238:239], v4 offset:56320
    s_waitcnt vmcnt(9)
    s_barrier
    v_mfma_f32_32x32x16_bf16 v[96:111], a[248:251], v[172:175], v[96:111]
    ds_read_b64_tr_b16 a[240:241], v1 offset:0
    ds_read_b64_tr_b16 a[242:243], v1 offset:28672
    v_mfma_f32_32x32x16_bf16 v[112:127], a[252:255], v[172:175], v[112:127]
    ds_read_b64_tr_b16 a[244:245], v2 offset:0
    ds_read_b64_tr_b16 a[246:247], v2 offset:28672
    s_waitcnt lgkmcnt(4)
    v_mfma_f32_32x32x16_bf16 v[96:111], a[224:227], v[176:179], v[96:111]
    ds_read_b64_tr_b16 a[248:249], v3 offset:0
    ds_read_b64_tr_b16 a[250:251], v3 offset:28672
    s_waitcnt vmcnt(1)
    v_cmp_ne_u32_e64 vcc, v247, v255
    s_and_b64 vcc, vcc, s[90:91]
    s_cbranch_vccnz Lslow_7
Lback_8:
    v_mfma_f32_32x32x16_bf16 v[112:127], a[228:231], v[176:179], v[112:127]
    ds_read_b64_tr_b16 a[252:253], v4 offset:0
    ds_read_b64_tr_b16 a[254:255], v4 offset:28672
    s_add_u32 m0, s55, 7168
    v_mfma_f32_32x32x16_bf16 v[96:111], a[232:235], v[180:183], v[96:111]
    ds_read_b64_tr_b16 a[224:225], v1 offset:1024
    ds_read_b64_tr_b16 a[226:227], v1 offset:29696
    buffer_load_dwordx4 v7, s[28:31], s80 offen sc1 lds
    v_mfma_f32_32x32x16_bf16 v[112:127], a[236:239], v[180:183], v[112:127]
    ds_read_b64_tr_b16 a[228:229], v2 offset:1024
    ds_read_b64_tr_b16 a[230:231], v2 offset:29696
    buffer_load_dwordx4 v22, s[28:31], s80 offen offset:1024 sc1 lds
    s_waitcnt lgkmcnt(4)
    s_nop 0
    v_mfma_f32_32x32x16_bf16 v[96:111], a[240:243], v[184:187], v[96:111]
    ds_read_b64_tr_b16 a[232:233], v3 offset:1024
    ds_read_b64_tr_b16 a[234:235], v3 offset:29696
    s_add_u32 m0, s55, 11264
    v_mfma_f32_32x32x16_bf16 v[112:127], a[244:247], v[184:187], v[112:127]
    ds_read_b64_tr_b16 a[236:237], v4 offset:1024
    ds_read_b64_tr_b16 a[238:239], v4 offset:29696
    buffer_load_dwordx4 v7, s[28:31], s82 offen sc1 lds
    v_mfma_f32_32x32x16_bf16 v[96:111], a[248:251], v[188:191], v[96:111]
    ds_read_b64_tr_b16 a[240:241], v1 offset:2048
    ds_read_b64_tr_b16 a[242:243], v1 offset:30720
    ds_read_b64_tr_b16 a[144:145], v5 offset:32768
    ds_read_b64_tr_b16 a[146:147], v5 offset:33792
    ds_read_b64_tr_b16 a[148:149], v6 offset:32768
    v_mfma_f32_32x32x16_bf16 v[112:127], a[252:255], v[188:191], v[112:127]
    ds_read_b64_tr_b16 a[244:245], v2 offset:2048
    ds_read_b64_tr_b16 a[246:247], v2 offset:30720
    buffer_load_dwordx4 v22, s[28:31], s82 offen offset:1024 sc1 lds
    s_waitcnt lgkmcnt(7)
    s_nop 0
    v_mfma_f32_32x32x16_bf16 v[96:111], a[224:227], v[192:195], v[96:111]
    ds_read_b64_tr_b16 a[248:249], v3 offset:2048
    ds_read_b64_tr_b16 a[250:251], v3 offset:30720
    s_add_u32 m0, s55, 15360
    ds_read_b64_tr_b16 a[150:151], v6 offset:33792
    ds_read_b64_tr_b16 a[152:153], v5 offset:34816
    v_mfma_f32_32x32x16_bf16 v[112:127], a[228:231], v[192:195], v[112:127]
    ds_read_b64_tr_b16 a[252:253], v4 offset:2048
    ds_read_b64_tr_b16 a[254:255], v4 offset:30720
    buffer_load_dwordx4 v7, s[28:31], s84 offen sc1 lds
    ds_read_b64_tr_b16 a[154:155], v5 offset:35840
    v_mfma_f32_32x32x16_bf16 v[96:111], a[232:235], v[196:199], v[96:111]
    ds_read_b64_tr_b16 a[224:225], v1 offset:3072
    ds_read_b64_tr_b16 a[226:227], v1 offset:31744
    ds_read_b64_tr_b16 a[156:157], v6 offset:34816
    ds_read_b64_tr_b16 a[158:159], v6 offset:35840
    v_mfma_f32_32x32x16_bf16 v[112:127], a[236:239], v[196:199], v[112:127]
    ds_read_b64_tr_b16 a[228:229], v2 offset:3072
    ds_read_b64_tr_b16 a[230:231], v2 offset:31744
    buffer_load_dwordx4 v22, s[28:31], s84 offen offset:1024 sc1 lds
    s_waitcnt lgkmcnt(7)
    s_nop 0
    v_mfma_f32_32x32x16_bf16 v[96:111], a[240:243], v[200:203], v[96:111]
    ds_read_b64_tr_b16 a[232:233], v3 offset:3072
    ds_read_b64_tr_b16 a[234:235], v3 offset:31744
    buffer_load_dwordx2 v[64:65], v252, s[28:31], s96 offen offset:0 sc1
    v_mfma_f32_32x32x16_bf16 v[112:127], a[244:247], v[200:203], v[112:127]
    ds_read_b64_tr_b16 a[236:237], v4 offset:3072
    ds_read_b64_tr_b16 a[238:239], v4 offset:31744
    buffer_load_dwordx2 v[66:67], v252, s[28:31], s96 offen offset:512 sc1
    v_mfma_f32_32x32x16_bf16 v[96:111], a[248:251], v[204:207], v[96:111]
    ds_read_b64_tr_b16 a[240:241], v1 offset:4096
    ds_read_b64_tr_b16 a[242:243], v1 offset:32768
    buffer_load_dwordx2 v[68:69], v252, s[28:31], s96 offen offset:1024 sc1
    v_mfma_f32_32x32x16_bf16 v[112:127], a[252:255], v[204:207], v[112:127]
    ds_read_b64_tr_b16 a[244:245], v2 offset:4096
    ds_read_b64_tr_b16 a[246:247], v2 offset:32768
    buffer_load_dwordx2 v[70:71], v25, s[28:31], s96 offen offset:1536 sc1
    s_add_u32 m0, s55, 9216
    s_waitcnt lgkmcnt(4)
    s_nop 0
    v_mfma_f32_32x32x16_bf16 v[96:111], a[224:227], v[208:211], v[96:111]
    ds_read_b64_tr_b16 a[248:249], v3 offset:4096
    ds_read_b64_tr_b16 a[250:251], v3 offset:32768
    buffer_load_dwordx4 v23, s[28:31], s81 offen sc1 lds
    ds_read_b64_tr_b16 a[160:161], v5 offset:0
    v_mfma_f32_32x32x16_bf16 v[112:127], a[228:231], v[208:211], v[112:127]
    ds_read_b64_tr_b16 a[252:253], v4 offset:4096
    ds_read_b64_tr_b16 a[254:255], v4 offset:32768
    ds_read_b64_tr_b16 a[162:163], v5 offset:1024
    ds_read_b64_tr_b16 a[164:165], v6 offset:0
    ds_read_b64_tr_b16 a[166:167], v6 offset:1024
    ds_read_b64_tr_b16 a[168:169], v5 offset:2048
    v_mfma_f32_32x32x16_bf16 v[96:111], a[232:235], v[212:215], v[96:111]
    ds_read_b64_tr_b16 a[224:225], v1 offset:5120
    ds_read_b64_tr_b16 a[226:227], v1 offset:33792
    buffer_load_dwordx4 v24, s[28:31], s81 offen offset:1024 sc1 lds
    ds_read_b64_tr_b16 a[170:171], v5 offset:3072
    v_mfma_f32_32x32x16_bf16 v[112:127], a[236:239], v[212:215], v[112:127]
    ds_read_b64_tr_b16 a[228:229], v2 offset:5120
    ds_read_b64_tr_b16 a[230:231], v2 offset:33792
    s_add_u32 m0, s55, 13312
    ds_read_b64_tr_b16 a[172:173], v6 offset:2048
    s_waitcnt lgkmcnt(10)
    s_nop 0
    v_mfma_f32_32x32x16_bf16 v[96:111], a[240:243], v[216:219], v[96:111]
    ds_read_b64_tr_b16 a[232:233], v3 offset:5120
    ds_read_b64_tr_b16 a[234:235], v3 offset:33792
    buffer_load_dwordx4 v23, s[28:31], s83 offen sc1 lds
    ds_read_b64_tr_b16 a[174:175], v6 offset:3072
    v_mfma_f32_32x32x16_bf16 v[112:127], a[244:247], v[216:219], v[112:127]
    ds_read_b64_tr_b16 a[236:237], v4 offset:5120
    ds_read_b64_tr_b16 a[238:239], v4 offset:33792
    buffer_load_dwordx4 v24, s[28:31], s83 offen offset:1024 sc1 lds
    v_mfma_f32_32x32x16_bf16 v[96:111], a[248:251], v[220:223], v[96:111]
    ds_read_b64_tr_b16 a[240:241], v1 offset:6144
    ds_read_b64_tr_b16 a[242:243], v1 offset:34816
    s_add_u32 m0, s55, 17408
    s_waitcnt vmcnt(14)
    ds_read_b64_tr_b16 a[176:177], v5 offset:16384
    v_mfma_f32_32x32x16_bf16 v[112:127], a[252:255], v[220:223], v[112:127]
    ds_read_b64_tr_b16 a[244:245], v2 offset:6144
    ds_read_b64_tr_b16 a[246:247], v2 offset:34816
    buffer_load_dwordx4 v23, s[28:31], s85 offen sc1 lds
    s_waitcnt lgkmcnt(5)
    v_mfma_f32_32x32x16_bf16 v[96:111], a[224:227], v[224:227], v[96:111]
    ds_read_b64_tr_b16 a[248:249], v3 offset:6144
    ds_read_b64_tr_b16 a[250:251], v3 offset:34816
    buffer_load_dwordx4 v24, s[28:31], s85 offen offset:1024 sc1 lds
    ds_read_b64_tr_b16 a[178:179], v5 offset:17408
    v_mfma_f32_32x32x16_bf16 v[112:127], a[228:231], v[224:227], v[112:127]
    ds_read_b64_tr_b16 a[252:253], v4 offset:6144
    ds_read_b64_tr_b16 a[254:255], v4 offset:34816
    ds_read_b64_tr_b16 a[180:181], v6 offset:16384
    ds_read_b64_tr_b16 a[182:183], v6 offset:17408
    ds_read_b64_tr_b16 a[184:185], v5 offset:18432
    ds_read_b64_tr_b16 a[186:187], v5 offset:19456
    v_mfma_f32_32x32x16_bf16 v[96:111], a[232:235], v[228:231], v[96:111]
    ds_read_b64_tr_b16 a[188:189], v6 offset:18432
    ds_read_b64_tr_b16 a[190:191], v6 offset:19456
    v_mfma_f32_32x32x16_bf16 v[112:127], a[236:239], v[228:231], v[112:127]
    s_waitcnt lgkmcnt(6)
    v_mfma_f32_32x32x16_bf16 v[96:111], a[240:243], v[232:235], v[96:111]
    v_mfma_f32_32x32x16_bf16 v[112:127], a[244:247], v[232:235], v[112:127]
    v_mfma_f32_32x32x16_bf16 v[96:111], a[248:251], v[236:239], v[96:111]
    v_mfma_f32_32x32x16_bf16 v[112:127], a[252:255], v[236:239], v[112:127]
    s_branch L_att
P_A:
    s_nop 0
    s_waitcnt lgkmcnt(6)
    v_mfma_f32_32x32x16_bf16 v[32:47], v[8:11], v[128:131], v[48:63]
    ds_read_b128 v[160:163], v20 offset:8192
    ds_read_b128 v[164:167], v21 offset:8192
    ds_read_b128 v[168:171], v22 offset:8192
    ds_read_b128 v[172:175], v23 offset:8192
    v_max_f32 v80, 0, v80
    v_cvt_pk_bf16_f32 v80, v80, v80
    v_mfma_f32_32x32x16_bf16 v[32:47], v[12:15], v[132:135], v[32:47]
    s_waitcnt lgkmcnt(8)
    v_mfma_f32_32x32x16_bf16 v[64:79], v[8:11], v[136:139], v[48:63]
    ds_read_b128 v[176:179], v20 offset:12288
    ds_read_b128 v[180:183], v21 offset:12288
    ds_read_b128 v[184:187], v26 offset:12288
    ds_read_b128 v[188:191], v27 offset:12288
    v_lshlrev_b32_e64 v80, 16, v80
    v_add_f32 v80, 925353388, v80
    v_mfma_f32_32x32x16_bf16 v[64:79], v[12:15], v[140:143], v[64:79]
    v_cvt_pk_bf16_f32 v80, v80, v80
    v_lshlrev_b32 v80, 16, v80
    v_sqrt_f32 v80, v80
    v_cvt_pk_bf16_f32 v128, v32, v33
    v_cvt_pk_bf16_f32 v129, v34, v35
    v_cvt_pk_bf16_f32 v130, v36, v37
    v_cvt_pk_bf16_f32 v131, v38, v39
    v_cvt_pk_bf16_f32 v132, v40, v41
    v_cvt_pk_bf16_f32 v133, v42, v43
    v_cvt_pk_bf16_f32 v134, v44, v45
    v_cvt_pk_bf16_f32 v135, v46, v47
    s_waitcnt lgkmcnt(10)
    v_mfma_f32_32x32x16_bf16 v[32:47], v[8:11], v[144:147], v[48:63]
    ds_read_b128 v[192:195], v24 offset:16384
    ds_read_b128 v[196:199], v25 offset:16384
    ds_read_b128 v[200:203], v26 offset:16384
    ds_read_b128 v[204:207], v27 offset:16384
    s_lshl_b32 s58, s40, 7
    v_cvt_pk_bf16_f32 v80, v80, v80
    v_mfma_f32_32x32x16_bf16 v[32:47], v[12:15], v[148:151], v[32:47]
    v_cvt_pk_bf16_f32 v136, v64, v65
    v_cvt_pk_bf16_f32 v137, v66, v67
    v_cvt_pk_bf16_f32 v138, v68, v69
    v_cvt_pk_bf16_f32 v139, v70, v71
    v_cvt_pk_bf16_f32 v140, v72, v73
    v_cvt_pk_bf16_f32 v141, v74, v75
    v_cvt_pk_bf16_f32 v142, v76, v77
    v_cvt_pk_bf16_f32 v143, v78, v79
    s_waitcnt lgkmcnt(12)
    s_nop 0
    v_mfma_f32_32x32x16_bf16 v[64:79], v[8:11], v[152:155], v[48:63]
    ds_read_b128 v[208:211], v24 offset:20480
    ds_read_b128 v[212:215], v25 offset:20480
    ds_read_b128 v[216:219], v26 offset:20480
    ds_read_b128 v[220:223], v27 offset:20480
    v_lshlrev_b32 v80, 16, v80
    v_rcp_f32 v253, v80
    v_mfma_f32_32x32x16_bf16 v[64:79], v[12:15], v[156:159], v[64:79]
    v_cvt_pk_bf16_f32 v144, v32, v33
    v_cvt_pk_bf16_f32 v145, v34, v35
    v_cvt_pk_bf16_f32 v146, v36, v37
    v_cvt_pk_bf16_f32 v147, v38, v39
    v_cvt_pk_bf16_f32 v148, v40, v41
    v_cvt_pk_bf16_f32 v149, v42, v43
    v_cvt_pk_bf16_f32 v150, v44, v45
    v_cvt_pk_bf16_f32 v151, v46, v47
    s_waitcnt lgkmcnt(14)
    s_nop 0
    v_mfma_f32_32x32x16_bf16 v[32:47], v[8:11], v[160:163], v[48:63]
    ds_read_b128 v[224:227], v24 offset:24576
    ds_read_b128 v[228:231], v25 offset:24576
    ds_read_b128 v[232:235], v26 offset:24576
    ds_read_b128 v[236:239], v27 offset:24576
    s_add_u32 s58, s58, 143360
    v_mul_f32_e64 v245, v253, v253
    v_mfma_f32_32x32x16_bf16 v[32:47], v[12:15], v[164:167], v[32:47]
    v_cvt_pk_bf16_f32 v152, v64, v65
    v_cvt_pk_bf16_f32 v153, v66, v67
    v_cvt_pk_bf16_f32 v154, v68, v69
    v_cvt_pk_bf16_f32 v155, v70, v71
    v_cvt_pk_bf16_f32 v156, v72, v73
    v_cvt_pk_bf16_f32 v157, v74, v75
    v_cvt_pk_bf16_f32 v158, v76, v77
    v_cvt_pk_bf16_f32 v159, v78, v79
    s_waitcnt lgkmcnt(15)
    v_mfma_f32_32x32x16_bf16 v[64:79], v[8:11], v[168:171], v[48:63]
    v_mfma_f32_32x32x16_bf16 v[64:79], v[12:15], v[172:175], v[64:79]
    s_nop 0
    v_cvt_pk_bf16_f32 v160, v32, v33
    v_cvt_pk_bf16_f32 v161, v34, v35
    v_cvt_pk_bf16_f32 v162, v36, v37
    v_cvt_pk_bf16_f32 v163, v38, v39
    v_cvt_pk_bf16_f32 v164, v40, v41
    v_cvt_pk_bf16_f32 v165, v42, v43
    v_cvt_pk_bf16_f32 v166, v44, v45
    v_cvt_pk_bf16_f32 v167, v46, v47
    s_waitcnt lgkmcnt(14)
    v_mfma_f32_32x32x16_bf16 v[32:47], v[8:11], v[176:179], v[48:63]
    s_waitcnt lgkmcnt(0)
    s_add_u32 m0, s55, 0
    s_add_u32 s57, s46, s52
    buffer_load_dwordx4 v116, s[8:11], s57 offen offset:0 lds
    buffer_load_dwordx4 v117, s[8:11], s57 offen offset:1024 lds
    v_mfma_f32_32x32x16_bf16 v[32:47], v[12:15], v[180:183], v[32:47]
    v_cvt_pk_bf16_f32 v168, v64, v65
    v_cvt_pk_bf16_f32 v169, v66, v67
    v_cvt_pk_bf16_f32 v170, v68, v69
    v_cvt_pk_bf16_f32 v171, v70, v71
    v_cvt_pk_bf16_f32 v172, v72, v73
    v_cvt_pk_bf16_f32 v173, v74, v75
    v_cvt_pk_bf16_f32 v174, v76, v77
    v_cvt_pk_bf16_f32 v175, v78, v79
    v_mfma_f32_32x32x16_bf16 v[64:79], v[8:11], v[184:187], v[48:63]
    buffer_load_dwordx4 v118, s[8:11], s57 offen offset:2048 lds
    buffer_load_dwordx4 v119, s[8:11], s57 offen offset:3072 lds
    v_mfma_f32_32x32x16_bf16 v[64:79], v[12:15], v[188:191], v[64:79]
    v_cvt_pk_bf16_f32 v176, v32, v33
    v_cvt_pk_bf16_f32 v177, v34, v35
    v_cvt_pk_bf16_f32 v178, v36, v37
    v_cvt_pk_bf16_f32 v179, v38, v39
    v_cvt_pk_bf16_f32 v180, v40, v41
    v_cvt_pk_bf16_f32 v181, v42, v43
    v_cvt_pk_bf16_f32 v182, v44, v45
    v_cvt_pk_bf16_f32 v183, v46, v47
    v_mfma_f32_32x32x16_bf16 v[32:47], v[8:11], v[192:195], v[48:63]
    s_add_u32 m0, s55, 4096
    s_add_u32 s57, s57, 344064
    buffer_load_dwordx4 v116, s[8:11], s57 offen offset:0 lds
    buffer_load_dwordx4 v117, s[8:11], s57 offen offset:1024 lds
    v_mfma_f32_32x32x16_bf16 v[32:47], v[12:15], v[196:199], v[32:47]
    v_cvt_pk_bf16_f32 v184, v64, v65
    v_cvt_pk_bf16_f32 v185, v66, v67
    v_cvt_pk_bf16_f32 v186, v68, v69
    v_cvt_pk_bf16_f32 v187, v70, v71
    v_cvt_pk_bf16_f32 v188, v72, v73
    v_cvt_pk_bf16_f32 v189, v74, v75
    v_cvt_pk_bf16_f32 v190, v76, v77
    v_cvt_pk_bf16_f32 v191, v78, v79
    v_mfma_f32_32x32x16_bf16 v[64:79], v[8:11], v[200:203], v[48:63]
    buffer_load_dwordx4 v118, s[8:11], s57 offen offset:2048 lds
    s_add_u32 m0, s55, 7168
    s_add_u32 s57, s49, s53
    s_nop 0
    buffer_load_dwordx4 v240, s[12:15], s57 offen offset:0 lds
    v_mfma_f32_32x32x16_bf16 v[64:79], v[12:15], v[204:207], v[64:79]
    v_cvt_pk_bf16_f32 v192, v32, v33
    v_cvt_pk_bf16_f32 v193, v34, v35
    v_cvt_pk_bf16_f32 v194, v36, v37
    v_cvt_pk_bf16_f32 v195, v38, v39
    v_cvt_pk_bf16_f32 v196, v40, v41
    v_cvt_pk_bf16_f32 v197, v42, v43
    v_cvt_pk_bf16_f32 v198, v44, v45
    v_cvt_pk_bf16_f32 v199, v46, v47
    v_mfma_f32_32x32x16_bf16 v[32:47], v[8:11], v[208:211], v[48:63]
    buffer_load_dwordx4 v241, s[12:15], s57 offen offset:1024 lds
    buffer_load_dwordx4 v242, s[12:15], s57 offen offset:2048 lds
    v_mfma_f32_32x32x16_bf16 v[32:47], v[12:15], v[212:215], v[32:47]
    v_cvt_pk_bf16_f32 v200, v64, v65
    v_cvt_pk_bf16_f32 v201, v66, v67
    v_cvt_pk_bf16_f32 v202, v68, v69
    v_cvt_pk_bf16_f32 v203, v70, v71
    v_cvt_pk_bf16_f32 v204, v72, v73
    v_cvt_pk_bf16_f32 v205, v74, v75
    v_cvt_pk_bf16_f32 v206, v76, v77
    v_cvt_pk_bf16_f32 v207, v78, v79
    v_mfma_f32_32x32x16_bf16 v[64:79], v[8:11], v[216:219], v[48:63]
    buffer_load_dwordx4 v243, s[12:15], s57 offen offset:3072 lds
    v_mfma_f32_32x32x16_bf16 v[64:79], v[12:15], v[220:223], v[64:79]
    s_nop 0
    s_nop 0
    v_cvt_pk_bf16_f32 v208, v32, v33
    v_cvt_pk_bf16_f32 v209, v34, v35
    v_cvt_pk_bf16_f32 v210, v36, v37
    v_cvt_pk_bf16_f32 v211, v38, v39
    v_cvt_pk_bf16_f32 v212, v40, v41
    v_cvt_pk_bf16_f32 v213, v42, v43
    v_cvt_pk_bf16_f32 v214, v44, v45
    v_cvt_pk_bf16_f32 v215, v46, v47
    v_mfma_f32_32x32x16_bf16 v[32:47], v[8:11], v[224:227], v[48:63]
    s_add_u32 m0, s55, 11264
    s_add_u32 s57, s57, 458752
    buffer_load_dwordx4 v240, s[12:15], s57 offen offset:0 lds
    v_mfma_f32_32x32x16_bf16 v[32:47], v[12:15], v[228:231], v[32:47]
    v_cvt_pk_bf16_f32 v216, v64, v65
    v_cvt_pk_bf16_f32 v217, v66, v67
    v_cvt_pk_bf16_f32 v218, v68, v69
    v_cvt_pk_bf16_f32 v219, v70, v71
    v_cvt_pk_bf16_f32 v220, v72, v73
    v_cvt_pk_bf16_f32 v221, v74, v75
    v_cvt_pk_bf16_f32 v222, v76, v77
    v_cvt_pk_bf16_f32 v223, v78, v79
    v_mfma_f32_32x32x16_bf16 v[64:79], v[8:11], v[232:235], v[48:63]
    buffer_load_dwordx4 v241, s[12:15], s57 offen offset:1024 lds
    v_mfma_f32_32x32x16_bf16 v[64:79], v[12:15], v[236:239], v[64:79]
    s_nop 0
    s_nop 0
    v_cvt_pk_bf16_f32 v224, v32, v33
    v_cvt_pk_bf16_f32 v225, v34, v35
    v_cvt_pk_bf16_f32 v226, v36, v37
    v_cvt_pk_bf16_f32 v227, v38, v39
    v_cvt_pk_bf16_f32 v228, v40, v41
    v_cvt_pk_bf16_f32 v229, v42, v43
    v_cvt_pk_bf16_f32 v230, v44, v45
    v_cvt_pk_bf16_f32 v231, v46, v47
    buffer_load_dwordx4 v242, s[12:15], s57 offen offset:2048 lds
    buffer_load_dword v255, off, s[36:39], 0 sc1
    s_nop 0
    v_cvt_pk_bf16_f32 v232, v64, v65
    v_cvt_pk_bf16_f32 v233, v66, v67
    v_cvt_pk_bf16_f32 v234, v68, v69
    v_cvt_pk_bf16_f32 v235, v70, v71
    v_cvt_pk_bf16_f32 v236, v72, v73
    v_cvt_pk_bf16_f32 v237, v74, v75
    v_cvt_pk_bf16_f32 v238, v76, v77
    v_cvt_pk_bf16_f32 v239, v78, v79
    s_waitcnt vmcnt(16)
    s_waitcnt lgkmcnt(0)
    s_barrier
    ds_read_b64_tr_b16 a[224:225], v96 offset:0
    ds_read_b64_tr_b16 a[226:227], v96 offset:1024
    ds_read_b64_tr_b16 a[228:229], v97 offset:0
    ds_read_b64_tr_b16 a[230:231], v97 offset:1024
    ds_read_b64_tr_b16 a[232:233], v96 offset:2048
    ds_read_b64_tr_b16 a[234:235], v96 offset:3072
    ds_read_b64_tr_b16 a[236:237], v97 offset:2048
    ds_read_b64_tr_b16 a[238:239], v97 offset:3072
    ds_read_b64_tr_b16 a[240:241], v96 offset:4096
    ds_read_b64_tr_b16 a[242:243], v96 offset:5120
    ds_read_b64_tr_b16 a[244:245], v97 offset:4096
    ds_read_b64_tr_b16 a[246:247], v97 offset:5120
    s_waitcnt lgkmcnt(4)
    v_mfma_f32_32x32x16_bf16 v[32:47], a[224:227], v[128:131], 0
    ds_read_b64_tr_b16 a[248:249], v96 offset:6144
    ds_read_b64_tr_b16 a[250:251], v96 offset:7168
    s_lshl_b32 s79, s42, 2
    s_and_b32 s76, s41, 3
    s_add_u32 s79, s79, s76
    v_mfma_f32_32x32x16_bf16 v[48:63], a[228:231], v[128:131], 0
    ds_read_b64_tr_b16 a[252:253], v97 offset:6144
    ds_read_b64_tr_b16 a[254:255], v97 offset:7168
    s_lshl_b32 s79, s79, 1
    s_mul_i32 s95, s79, 33024
    s_lshl_b32 s76, s40, 13
    v_mfma_f32_32x32x16_bf16 v[32:47], a[232:235], v[132:135], v[32:47]
    ds_read_b64_tr_b16 a[224:225], v96 offset:8192
    ds_read_b64_tr_b16 a[226:227], v96 offset:9216
    s_add_u32 s95, s95, s76
    s_add_u32 s95, s95, 5701632
    s_lshl_b32 s76, s79, 1
    v_mfma_f32_32x32x16_bf16 v[48:63], a[236:239], v[132:135], v[48:63]
    ds_read_b64_tr_b16 a[228:229], v97 offset:8192
    ds_read_b64_tr_b16 a[230:231], v97 offset:9216
    s_add_u32 s76, s76, s40
    s_mul_i32 s44, s76, 14336
    s_waitcnt lgkmcnt(4)
    v_mfma_f32_32x32x16_bf16 v[32:47], a[240:243], v[136:139], v[32:47]
    ds_read_b64_tr_b16 a[232:233], v96 offset:10240
    ds_read_b64_tr_b16 a[234:235], v96 offset:11264
    s_lshr_b32 s58, s41, 2
    s_lshl_b32 s58, s58, 7
    s_add_u32 s44, s44, s58
    v_mfma_f32_32x32x16_bf16 v[48:63], a[244:247], v[136:139], v[48:63]
    ds_read_b64_tr_b16 a[236:237], v97 offset:10240
    ds_read_b64_tr_b16 a[238:239], v97 offset:11264
    s_lshl_b32 s45, s79, 9
    s_lshl_b32 s76, s40, 4
    s_add_u32 s45, s45, s76
    v_mfma_f32_32x32x16_bf16 v[32:47], a[248:251], v[140:143], v[32:47]
    ds_read_b64_tr_b16 a[240:241], v96 offset:12288
    ds_read_b64_tr_b16 a[242:243], v96 offset:13312
    global_load_dword v99, v120, s[60:61]
    s_add_u32 s45, s45, 15401216
    v_mfma_f32_32x32x16_bf16 v[48:63], a[252:255], v[140:143], v[48:63]
    ds_read_b64_tr_b16 a[244:245], v97 offset:12288
    ds_read_b64_tr_b16 a[246:247], v97 offset:13312
    v_lshrrev_b32 v29, 4, v7
    v_mov_b32 v30, 2146435072
    s_waitcnt lgkmcnt(4)
    v_mfma_f32_32x32x16_bf16 v[32:47], a[224:227], v[144:147], v[32:47]
    ds_read_b64_tr_b16 a[248:249], v96 offset:14336
    ds_read_b64_tr_b16 a[250:251], v96 offset:15360
    s_add_u32 m0, s55, 14336
    s_add_u32 s57, s49, s54
    s_lshr_b32 s100, s41, 4
    v_mfma_f32_32x32x16_bf16 v[48:63], a[228:231], v[144:147], v[48:63]
    ds_read_b64_tr_b16 a[252:253], v97 offset:14336
    ds_read_b64_tr_b16 a[254:255], v97 offset:15360
    buffer_load_dwordx4 v240, s[12:15], s57 offen offset:0 lds
    s_lshl_b32 s86, s42, 1
    v_mfma_f32_32x32x16_bf16 v[32:47], a[232:235], v[148:151], v[32:47]
    ds_read_b64_tr_b16 a[224:225], v96 offset:16384
    ds_read_b64_tr_b16 a[226:227], v96 offset:17408
    s_add_u32 s86, s86, s100
    s_and_b32 s100, s41, 15
    s_lshl_b32 s100, s100, 2
    v_mfma_f32_32x32x16_bf16 v[48:63], a[236:239], v[148:151], v[48:63]
    ds_read_b64_tr_b16 a[228:229], v97 offset:16384
    ds_read_b64_tr_b16 a[230:231], v97 offset:17408
    s_add_u32 s87, s100, s40
    s_mul_i32 s88, s40, 3
    s_waitcnt lgkmcnt(4)
    v_mfma_f32_32x32x16_bf16 v[32:47], a[240:243], v[152:155], v[32:47]
    ds_read_b64_tr_b16 a[232:233], v96 offset:18432
    ds_read_b64_tr_b16 a[234:235], v96 offset:19456
    buffer_load_dwordx4 v241, s[12:15], s57 offen offset:1024 lds
    s_add_u32 s88, s88, s100
    v_mfma_f32_32x32x16_bf16 v[48:63], a[244:247], v[152:155], v[48:63]
    ds_read_b64_tr_b16 a[236:237], v97 offset:18432
    ds_read_b64_tr_b16 a[238:239], v97 offset:19456
    s_sub_u32 s88, s88, 8
    s_mul_i32 s100, s87, 28928
    s_mul_i32 s101, s86, 1792
    v_mfma_f32_32x32x16_bf16 v[32:47], a[248:251], v[156:159], v[32:47]
    ds_read_b64_tr_b16 a[240:241], v96 offset:20480
    ds_read_b64_tr_b16 a[242:243], v96 offset:21504
    buffer_load_dwordx4 v242, s[12:15], s57 offen offset:2048 lds
    s_add_u32 s96, s100, s101
    v_mfma_f32_32x32x16_bf16 v[48:63], a[252:255], v[156:159], v[48:63]
    ds_read_b64_tr_b16 a[244:245], v97 offset:20480
    ds_read_b64_tr_b16 a[246:247], v97 offset:21504
    s_mul_i32 s100, s87, 33024
    s_lshl_b32 s101, s86, 11
    s_waitcnt lgkmcnt(4)
    v_mfma_f32_32x32x16_bf16 v[32:47], a[224:227], v[160:163], v[32:47]
    ds_read_b64_tr_b16 a[248:249], v96 offset:22528
    ds_read_b64_tr_b16 a[250:251], v96 offset:23552
    buffer_load_dwordx4 v243, s[12:15], s57 offen offset:3072 lds
    s_add_u32 s100, s100, s101
    s_nop 0
    v_mfma_f32_32x32x16_bf16 v[48:63], a[228:231], v[160:163], v[48:63]
    ds_read_b64_tr_b16 a[252:253], v97 offset:22528
    ds_read_b64_tr_b16 a[254:255], v97 offset:23552
    s_add_u32 m0, s55, 18432
    s_add_u32 s57, s57, 458752
    s_add_u32 s43, s100, 5701632
    v_mfma_f32_32x32x16_bf16 v[32:47], a[232:235], v[164:167], v[32:47]
    ds_read_b64_tr_b16 a[224:225], v96 offset:24576
    ds_read_b64_tr_b16 a[226:227], v96 offset:25600
    buffer_load_dwordx4 v240, s[12:15], s57 offen offset:0 lds
    s_lshl_b32 s100, s87, 9
    v_mfma_f32_32x32x16_bf16 v[48:63], a[236:239], v[164:167], v[48:63]
    ds_read_b64_tr_b16 a[228:229], v97 offset:24576
    ds_read_b64_tr_b16 a[230:231], v97 offset:25600
    s_lshl_b32 s101, s86, 2
    s_add_u32 s100, s100, s101
    s_waitcnt lgkmcnt(4)
    v_mfma_f32_32x32x16_bf16 v[32:47], a[240:243], v[168:171], v[32:47]
    ds_read_b64_tr_b16 a[232:233], v96 offset:26624
    ds_read_b64_tr_b16 a[234:235], v96 offset:27648
    buffer_load_dwordx4 v241, s[12:15], s57 offen offset:1024 lds
    s_add_u32 s3, s100, 15401216
    v_mfma_f32_32x32x16_bf16 v[48:63], a[244:247], v[168:171], v[48:63]
    ds_read_b64_tr_b16 a[236:237], v97 offset:26624
    ds_read_b64_tr_b16 a[238:239], v97 offset:27648
    s_waitcnt vmcnt(15) lgkmcnt(0)
    s_barrier
    v_mfma_f32_32x32x16_bf16 v[32:47], a[248:251], v[172:175], v[32:47]
    ds_read_b64_tr_b16 a[240:241], v1 offset:0
    ds_read_b64_tr_b16 a[242:243], v1 offset:28672
    buffer_load_dwordx4 v242, s[12:15], s57 offen offset:2048 lds
    s_mul_i32 s100, s86, 28
    s_nop 0
    v_mfma_f32_32x32x16_bf16 v[48:63], a[252:255], v[172:175], v[48:63]
    ds_read_b64_tr_b16 a[244:245], v2 offset:0
    ds_read_b64_tr_b16 a[246:247], v2 offset:28672
    v_readlane_b32 s56, v31, 0
    s_add_u32 m0, s62, 32768
    v_mfma_f32_32x32x16_bf16 v[32:47], a[224:227], v[176:179], v[32:47]
    ds_read_b64_tr_b16 a[248:249], v3 offset:0
    ds_read_b64_tr_b16 a[250:251], v3 offset:28672
    s_nop 0
    buffer_load_dwordx4 v248, s[20:23], s56 offen offset:0 lds
    s_add_u32 s101, s100, 27
    v_mfma_f32_32x32x16_bf16 v[48:63], a[228:231], v[176:179], v[48:63]
    ds_read_b64_tr_b16 a[252:253], v4 offset:0
    ds_read_b64_tr_b16 a[254:255], v4 offset:28672
    s_lshr_b32 s100, s100, 6
    s_lshr_b32 s101, s101, 6
    v_lshrrev_b32_e64 v24, 2, v29
    v_mfma_f32_32x32x16_bf16 v[32:47], a[232:235], v[180:183], v[32:47]
    ds_read_b64_tr_b16 a[224:225], v1 offset:1024
    ds_read_b64_tr_b16 a[226:227], v1 offset:29696
    buffer_load_dwordx4 v249, s[20:23], s56 offen offset:1024 lds
    v_add_u32_e64 v24, s88, v24
    v_mfma_f32_32x32x16_bf16 v[48:63], a[236:239], v[180:183], v[48:63]
    ds_read_b64_tr_b16 a[228:229], v2 offset:1024
    ds_read_b64_tr_b16 a[230:231], v2 offset:29696
    v_bfe_u32 v25, v29, 1, 1
    v_mad_u32_u24 v25, v25, 7, 7
    v_cmp_gt_u32 s[90:91], 12, v29
    s_waitcnt lgkmcnt(4)
    v_mfma_f32_32x32x16_bf16 v[32:47], a[240:243], v[184:187], v[32:47]
    ds_read_b64_tr_b16 a[232:233], v3 offset:1024
    ds_read_b64_tr_b16 a[234:235], v3 offset:29696
    buffer_load_dwordx4 v250, s[20:23], s56 offen offset:2048 lds
    v_mov_b32 v26, s87
    v_mfma_f32_32x32x16_bf16 v[48:63], a[244:247], v[184:187], v[48:63]
    ds_read_b64_tr_b16 a[236:237], v4 offset:1024
    ds_read_b64_tr_b16 a[238:239], v4 offset:29696
    v_and_b32_e64 v27, 1, v29
    v_cndmask_b32 v24, v26, v24, s[90:91]
    v_cndmask_b32 v25, 0, v25, s[90:91]
    v_cmp_eq_u32 s[90:91], 1, v27
    v_mfma_f32_32x32x16_bf16 v[32:47], a[248:251], v[188:191], v[32:47]
    ds_read_b64_tr_b16 a[240:241], v1 offset:2048
    ds_read_b64_tr_b16 a[242:243], v1 offset:30720
    buffer_load_dwordx4 v251, s[20:23], s56 offen offset:3072 lds
    v_mov_b32_e64 v26, s100
    v_mfma_f32_32x32x16_bf16 v[48:63], a[252:255], v[188:191], v[48:63]
    ds_read_b64_tr_b16 a[244:245], v2 offset:2048
    ds_read_b64_tr_b16 a[246:247], v2 offset:30720
    v_readlane_b32 s56, v31, 1
    s_add_u32 m0, s62, 0
    s_waitcnt lgkmcnt(4)
    v_mfma_f32_32x32x16_bf16 v[32:47], a[224:227], v[192:195], v[32:47]
    ds_read_b64_tr_b16 a[248:249], v3 offset:2048
    ds_read_b64_tr_b16 a[250:251], v3 offset:30720
    buffer_load_dwordx4 v248, s[20:23], s56 offen offset:0 lds
    v_mov_b32_e64 v28, s101
    v_mfma_f32_32x32x16_bf16 v[48:63], a[228:231], v[192:195], v[48:63]
    ds_read_b64_tr_b16 a[252:253], v4 offset:2048
    ds_read_b64_tr_b16 a[254:255], v4 offset:30720
    v_cndmask_b32 v26, v26, v28, s[90:91]
    v_cmp_gt_u32 s[90:91], 14, v29
    v_cmp_le_i32 s[76:77], 0, v24
    v_add_u32_e64 v25, v25, v26
    v_mfma_f32_32x32x16_bf16 v[32:47], a[232:235], v[196:199], v[32:47]
    ds_read_b64_tr_b16 a[224:225], v1 offset:3072
    ds_read_b64_tr_b16 a[226:227], v1 offset:31744
    v_lshlrev_b32 v24, 9, v24
    v_lshl_add_u32 v24, v25, 2, v24
    s_and_b64 s[90:91], s[90:91], s[76:77]
    v_mfma_f32_32x32x16_bf16 v[48:63], a[236:239], v[196:199], v[48:63]
    ds_read_b64_tr_b16 a[228:229], v2 offset:3072
    ds_read_b64_tr_b16 a[230:231], v2 offset:31744
    buffer_load_dwordx4 v249, s[20:23], s56 offen offset:1024 lds
    s_waitcnt lgkmcnt(4)
    v_mfma_f32_32x32x16_bf16 v[32:47], a[240:243], v[200:203], v[32:47]
    ds_read_b64_tr_b16 a[232:233], v3 offset:3072
    ds_read_b64_tr_b16 a[234:235], v3 offset:31744
    v_add_u32 v24, 15400960, v24
    v_cndmask_b32 v244, v30, v24, s[90:91]
    s_add_u32 s100, s88, 0
    v_mfma_f32_32x32x16_bf16 v[48:63], a[244:247], v[200:203], v[48:63]
    ds_read_b64_tr_b16 a[236:237], v4 offset:3072
    ds_read_b64_tr_b16 a[238:239], v4 offset:31744
    buffer_load_dwordx4 v250, s[20:23], s56 offen offset:2048 lds
    s_mul_i32 s101, s100, 28928
    v_mfma_f32_32x32x16_bf16 v[32:47], a[248:251], v[204:207], v[32:47]
    ds_read_b64_tr_b16 a[240:241], v1 offset:4096
    ds_read_b64_tr_b16 a[242:243], v1 offset:32768
    s_mul_i32 s80, s86, 1792
    s_add_u32 s80, s80, s101
    s_add_u32 s80, s80, 1900544
    v_mfma_f32_32x32x16_bf16 v[48:63], a[252:255], v[204:207], v[48:63]
    ds_read_b64_tr_b16 a[244:245], v2 offset:4096
    ds_read_b64_tr_b16 a[246:247], v2 offset:32768
    buffer_load_dwordx4 v251, s[20:23], s56 offen offset:3072 lds
    s_waitcnt lgkmcnt(4)
    v_mfma_f32_32x32x16_bf16 v[32:47], a[224:227], v[208:211], v[32:47]
    ds_read_b64_tr_b16 a[248:249], v3 offset:4096
    ds_read_b64_tr_b16 a[250:251], v3 offset:32768
    v_readlane_b32 s56, v31, 2
    s_add_u32 m0, s62, 16384
    s_mul_i32 s81, s86, 448
    v_mfma_f32_32x32x16_bf16 v[48:63], a[228:231], v[208:211], v[48:63]
    ds_read_b64_tr_b16 a[252:253], v4 offset:4096
    ds_read_b64_tr_b16 a[254:255], v4 offset:32768
    buffer_load_dwordx4 v248, s[20:23], s56 offen offset:0 lds
    s_add_u32 s81, s81, s101
    v_mfma_f32_32x32x16_bf16 v[32:47], a[232:235], v[212:215], v[32:47]
    ds_read_b64_tr_b16 a[224:225], v1 offset:5120
    ds_read_b64_tr_b16 a[226:227], v1 offset:33792
    s_add_u32 s81, s81, 3801088
    s_cmp_lt_i32 s100, 0
    s_cselect_b32 s80, 15532032, s80
    s_cselect_b32 s81, 15532032, s81
    v_mfma_f32_32x32x16_bf16 v[48:63], a[236:239], v[212:215], v[48:63]
    ds_read_b64_tr_b16 a[228:229], v2 offset:5120
    ds_read_b64_tr_b16 a[230:231], v2 offset:33792
    buffer_load_dwordx4 v249, s[20:23], s56 offen offset:1024 lds
    s_waitcnt lgkmcnt(4)
    v_mfma_f32_32x32x16_bf16 v[32:47], a[240:243], v[216:219], v[32:47]
    ds_read_b64_tr_b16 a[232:233], v3 offset:5120
    ds_read_b64_tr_b16 a[234:235], v3 offset:33792
    s_waitcnt vmcnt(18)
    v_cmp_eq_u32 vcc, 0, v255
    s_cbranch_vccnz Lslow_9
Lback_10:
    v_mfma_f32_32x32x16_bf16 v[48:63], a[244:247], v[216:219], v[48:63]
    ds_read_b64_tr_b16 a[236:237], v4 offset:5120
    ds_read_b64_tr_b16 a[238:239], v4 offset:33792
    buffer_load_dwordx4 v250, s[20:23], s56 offen offset:2048 lds
    s_add_u32 s100, s88, 1
    v_mfma_f32_32x32x16_bf16 v[32:47], a[248:251], v[220:223], v[32:47]
    ds_read_b64_tr_b16 a[240:241], v1 offset:6144
    ds_read_b64_tr_b16 a[242:243], v1 offset:34816
    s_mul_i32 s101, s100, 28928
    s_mul_i32 s82, s86, 1792
    s_add_u32 s82, s82, s101
    v_mfma_f32_32x32x16_bf16 v[48:63], a[252:255], v[220:223], v[48:63]
    ds_read_b64_tr_b16 a[244:245], v2 offset:6144
    ds_read_b64_tr_b16 a[246:247], v2 offset:34816
    buffer_load_dwordx4 v251, s[20:23], s56 offen offset:3072 lds
    s_waitcnt lgkmcnt(4)
    v_mfma_f32_32x32x16_bf16 v[32:47], a[224:227], v[224:227], v[32:47]
    ds_read_b64_tr_b16 a[248:249], v3 offset:6144
    ds_read_b64_tr_b16 a[250:251], v3 offset:34816
    s_add_u32 s82, s82, 1900544
    s_mul_i32 s83, s86, 448
    s_add_u32 s83, s83, s101
    v_mfma_f32_32x32x16_bf16 v[48:63], a[228:231], v[224:227], v[48:63]
    ds_read_b64_tr_b16 a[252:253], v4 offset:6144
    ds_read_b64_tr_b16 a[254:255], v4 offset:34816
    s_barrier
    s_add_u32 m0, s55, 21504
    s_add_u32 s57, s49, s53
    v_mfma_f32_32x32x16_bf16 v[32:47], a[232:235], v[228:231], v[32:47]
    ds_read_b64_tr_b16 a[224:225], v1 offset:7168
    ds_read_b64_tr_b16 a[226:227], v1 offset:35840
    buffer_load_dwordx4 v240, s[16:19], s57 offen offset:0 lds
    s_add_u32 s83, s83, 3801088
    v_mfma_f32_32x32x16_bf16 v[48:63], a[236:239], v[228:231], v[48:63]
    ds_read_b64_tr_b16 a[228:229], v2 offset:7168
    ds_read_b64_tr_b16 a[230:231], v2 offset:35840
    s_cmp_lt_i32 s100, 0
    s_cselect_b32 s82, 15532032, s82
    s_cselect_b32 s83, 15532032, s83
    s_waitcnt lgkmcnt(4)
    v_mfma_f32_32x32x16_bf16 v[32:47], a[240:243], v[232:235], v[32:47]
    ds_read_b64_tr_b16 a[232:233], v3 offset:7168
    ds_read_b64_tr_b16 a[234:235], v3 offset:35840
    buffer_load_dwordx4 v241, s[16:19], s57 offen offset:1024 lds
    s_add_u32 s100, s88, 2
    v_mfma_f32_32x32x16_bf16 v[48:63], a[244:247], v[232:235], v[48:63]
    ds_read_b64_tr_b16 a[236:237], v4 offset:7168
    ds_read_b64_tr_b16 a[238:239], v4 offset:35840
    s_mul_i32 s101, s100, 28928
    s_mul_i32 s84, s86, 1792
    s_add_u32 s84, s84, s101
    v_mfma_f32_32x32x16_bf16 v[32:47], a[248:251], v[236:239], v[32:47]
    ds_read_b64_tr_b16 a[240:241], v1 offset:8192
    ds_read_b64_tr_b16 a[242:243], v1 offset:36864
    buffer_load_dwordx4 v242, s[16:19], s57 offen offset:2048 lds
    s_add_u32 s84, s84, 1900544
    v_mfma_f32_32x32x16_bf16 v[48:63], a[252:255], v[236:239], v[48:63]
    ds_read_b64_tr_b16 a[244:245], v2 offset:8192
    ds_read_b64_tr_b16 a[246:247], v2 offset:36864
    s_mul_i32 s85, s86, 448
    s_add_u32 s85, s85, s101
    s_waitcnt lgkmcnt(4)
    v_mfma_f32_32x32x16_bf16 v[64:79], a[224:227], v[128:131], 0
    ds_read_b64_tr_b16 a[248:249], v3 offset:8192
    ds_read_b64_tr_b16 a[250:251], v3 offset:36864
    buffer_load_dwordx4 v243, s[16:19], s57 offen offset:3072 lds
    s_add_u32 s85, s85, 3801088
    v_mfma_f32_32x32x16_bf16 v[80:95], a[228:231], v[128:131], 0
    ds_read_b64_tr_b16 a[252:253], v4 offset:8192
    ds_read_b64_tr_b16 a[254:255], v4 offset:36864
    s_add_u32 m0, s55, 25600
    s_add_u32 s57, s57, 458752
    v_mfma_f32_32x32x16_bf16 v[64:79], a[232:235], v[132:135], v[64:79]
    ds_read_b64_tr_b16 a[224:225], v1 offset:9216
    ds_read_b64_tr_b16 a[226:227], v1 offset:37888
    buffer_load_dwordx4 v240, s[16:19], s57 offen offset:0 lds
    v_mfma_f32_32x32x16_bf16 v[80:95], a[236:239], v[132:135], v[80:95]
    ds_read_b64_tr_b16 a[228:229], v2 offset:9216
    ds_read_b64_tr_b16 a[230:231], v2 offset:37888
    v_mul_f32 v246, s66, v253
    v_mul_f32 v32, v246, v32
    v_mul_f32 v33, v246, v33
    s_waitcnt lgkmcnt(4)
    v_mfma_f32_32x32x16_bf16 v[64:79], a[240:243], v[136:139], v[64:79]
    ds_read_b64_tr_b16 a[232:233], v3 offset:9216
    ds_read_b64_tr_b16 a[234:235], v3 offset:37888
    buffer_load_dwordx4 v241, s[16:19], s57 offen offset:1024 lds
    v_mul_f32_e64 v34, v246, v34
    v_mfma_f32_32x32x16_bf16 v[80:95], a[244:247], v[136:139], v[80:95]
    ds_read_b64_tr_b16 a[236:237], v4 offset:9216
    ds_read_b64_tr_b16 a[238:239], v4 offset:37888
    v_mul_f32_e64 v35, v246, v35
    v_cvt_pk_bf16_f32 v32, v32, v33
    v_cvt_pk_bf16_f32 v33, v34, v35
    v_mul_f32 v36, v246, v36
    v_mul_f32 v37, v246, v37
    v_mfma_f32_32x32x16_bf16 v[64:79], a[248:251], v[140:143], v[64:79]
    ds_read_b64_tr_b16 a[240:241], v1 offset:10240
    ds_read_b64_tr_b16 a[242:243], v1 offset:38912
    buffer_store_dwordx2 v[32:33], v252, s[28:31], s63 offen offset:0 sc1
    v_mul_f32 v38, v246, v38
    v_mul_f32 v39, v246, v39
    v_mfma_f32_32x32x16_bf16 v[80:95], a[252:255], v[140:143], v[80:95]
    ds_read_b64_tr_b16 a[244:245], v2 offset:10240
    ds_read_b64_tr_b16 a[246:247], v2 offset:38912
    buffer_load_dwordx4 v242, s[16:19], s57 offen offset:2048 lds
    v_cvt_pk_bf16_f32 v36, v36, v37
    s_waitcnt lgkmcnt(4)
    v_mfma_f32_32x32x16_bf16 v[64:79], a[224:227], v[144:147], v[64:79]
    ds_read_b64_tr_b16 a[248:249], v3 offset:10240
    ds_read_b64_tr_b16 a[250:251], v3 offset:38912
    s_waitcnt vmcnt(16)
    ds_read_b64_tr_b16 a[0:1], v5 offset:32768
    ds_read_b64_tr_b16 a[2:3], v5 offset:33792
    ds_read_b64_tr_b16 a[4:5], v6 offset:32768
    v_cvt_pk_bf16_f32 v37, v38, v39
    v_mfma_f32_32x32x16_bf16 v[80:95], a[228:231], v[144:147], v[80:95]
    ds_read_b64_tr_b16 a[252:253], v4 offset:10240
    ds_read_b64_tr_b16 a[254:255], v4 offset:38912
    ds_read_b64_tr_b16 a[6:7], v6 offset:33792
    ds_read_b64_tr_b16 a[8:9], v5 offset:34816
    ds_read_b64_tr_b16 a[10:11], v5 offset:35840
    ds_read_b64_tr_b16 a[12:13], v6 offset:34816
    v_mfma_f32_32x32x16_bf16 v[64:79], a[232:235], v[148:151], v[64:79]
    ds_read_b64_tr_b16 a[224:225], v1 offset:11264
    ds_read_b64_tr_b16 a[226:227], v1 offset:39936
    buffer_store_dwordx2 v[36:37], v252, s[28:31], s63 offen offset:512 sc1
    ds_read_b64_tr_b16 a[14:15], v6 offset:35840
    v_mfma_f32_32x32x16_bf16 v[80:95], a[236:239], v[148:151], v[80:95]
    ds_read_b64_tr_b16 a[228:229], v2 offset:11264
    ds_read_b64_tr_b16 a[230:231], v2 offset:39936
    v_mul_f32 v40, v246, v40
    v_mul_f32 v41, v246, v41
    v_mul_f32 v42, v246, v42
    s_waitcnt lgkmcnt(9)
    v_mfma_f32_32x32x16_bf16 v[64:79], a[240:243], v[152:155], v[64:79]
    ds_read_b64_tr_b16 a[232:233], v3 offset:11264
    ds_read_b64_tr_b16 a[234:235], v3 offset:39936
    v_mul_f32_e64 v43, v246, v43
    v_cvt_pk_bf16_f32 v40, v40, v41
    v_cvt_pk_bf16_f32 v41, v42, v43
    v_mul_f32_e64 v44, v246, v44
    v_mfma_f32_32x32x16_bf16 v[80:95], a[244:247], v[152:155], v[80:95]
    ds_read_b64_tr_b16 a[236:237], v4 offset:11264
    ds_read_b64_tr_b16 a[238:239], v4 offset:39936
    v_mul_f32 v45, v246, v45
    v_mul_f32 v46, v246, v46
    v_mfma_f32_32x32x16_bf16 v[64:79], a[248:251], v[156:159], v[64:79]
    ds_read_b64_tr_b16 a[240:241], v1 offset:12288
    ds_read_b64_tr_b16 a[242:243], v1 offset:40960
    buffer_store_dwordx2 v[40:41], v252, s[28:31], s63 offen offset:1024 sc1
    v_mul_f32_e64 v47, v246, v47
    v_mfma_f32_32x32x16_bf16 v[80:95], a[252:255], v[156:159], v[80:95]
    ds_read_b64_tr_b16 a[244:245], v2 offset:12288
    ds_read_b64_tr_b16 a[246:247], v2 offset:40960
    v_readlane_b32 s56, v31, 3
    s_waitcnt lgkmcnt(10)
    s_add_u32 m0, s62, 32768
    s_waitcnt lgkmcnt(4)
    v_mfma_f32_32x32x16_bf16 v[64:79], a[224:227], v[160:163], v[64:79]
    ds_read_b64_tr_b16 a[248:249], v3 offset:12288
    ds_read_b64_tr_b16 a[250:251], v3 offset:40960
    buffer_load_dwordx4 v248, s[20:23], s56 offen offset:0 lds
    v_cvt_pk_bf16_f32 v44, v44, v45
    v_mfma_f32_32x32x16_bf16 v[80:95], a[228:231], v[160:163], v[80:95]
    ds_read_b64_tr_b16 a[252:253], v4 offset:12288
    ds_read_b64_tr_b16 a[254:255], v4 offset:40960
    v_cvt_pk_bf16_f32 v45, v46, v47
    v_mul_f32 v48, v246, v48
    v_mul_f32 v49, v246, v49
    v_mfma_f32_32x32x16_bf16 v[64:79], a[232:235], v[164:167], v[64:79]
    ds_read_b64_tr_b16 a[224:225], v1 offset:13312
    ds_read_b64_tr_b16 a[226:227], v1 offset:41984
    buffer_load_dwordx4 v249, s[20:23], s56 offen offset:1024 lds
    v_mul_f32_e64 v50, v246, v50
    v_mfma_f32_32x32x16_bf16 v[80:95], a[236:239], v[164:167], v[80:95]
    ds_read_b64_tr_b16 a[228:229], v2 offset:13312
    ds_read_b64_tr_b16 a[230:231], v2 offset:41984
    v_mul_f32 v51, v246, v51
    v_cvt_pk_bf16_f32 v48, v48, v49
    s_waitcnt lgkmcnt(4)
    v_mfma_f32_32x32x16_bf16 v[64:79], a[240:243], v[168:171], v[64:79]
    ds_read_b64_tr_b16 a[232:233], v3 offset:13312
    ds_read_b64_tr_b16 a[234:235], v3 offset:41984
    buffer_store_dwordx2 v[44:45], v252, s[28:31], s63 offen offset:1536 sc1
    v_cvt_pk_bf16_f32 v49, v50, v51
    v_mfma_f32_32x32x16_bf16 v[80:95], a[244:247], v[168:171], v[80:95]
    ds_read_b64_tr_b16 a[236:237], v4 offset:13312
    ds_read_b64_tr_b16 a[238:239], v4 offset:41984
    s_barrier
    v_mfma_f32_32x32x16_bf16 v[64:79], a[248:251], v[172:175], v[64:79]
    ds_read_b64_tr_b16 a[240:241], v1 offset:14336
    ds_read_b64_tr_b16 a[242:243], v1 offset:43008
    buffer_load_dwordx4 v250, s[20:23], s56 offen offset:2048 lds
    v_mul_f32 v52, v246, v52
    v_mfma_f32_32x32x16_bf16 v[80:95], a[252:255], v[172:175], v[80:95]
    ds_read_b64_tr_b16 a[244:245], v2 offset:14336
    ds_read_b64_tr_b16 a[246:247], v2 offset:43008
    v_mul_f32 v53, v246, v53
    v_mul_f32 v54, v246, v54
    v_mul_f32 v55, v246, v55
    s_waitcnt lgkmcnt(4)
    v_mfma_f32_32x32x16_bf16 v[64:79], a[224:227], v[176:179], v[64:79]
    ds_read_b64_tr_b16 a[248:249], v3 offset:14336
    ds_read_b64_tr_b16 a[250:251], v3 offset:43008
    buffer_store_dwordx2 v[48:49], v252, s[28:31], s63 offen offset:2048 sc1
    v_cvt_pk_bf16_f32 v52, v52, v53
    v_mfma_f32_32x32x16_bf16 v[80:95], a[228:231], v[176:179], v[80:95]
    ds_read_b64_tr_b16 a[252:253], v4 offset:14336
    ds_read_b64_tr_b16 a[254:255], v4 offset:43008
    buffer_load_dwordx4 v251, s[20:23], s56 offen offset:3072 lds
    v_cvt_pk_bf16_f32 v53, v54, v55
    v_mfma_f32_32x32x16_bf16 v[64:79], a[232:235], v[180:183], v[64:79]
    ds_read_b64_tr_b16 a[224:225], v1 offset:15360
    ds_read_b64_tr_b16 a[226:227], v1 offset:44032
    s_add_u32 m0, s55, 0
    s_add_u32 s57, s49, s54
    v_mul_f32_e64 v56, v246, v56
    v_mfma_f32_32x32x16_bf16 v[80:95], a[236:239], v[180:183], v[80:95]
    ds_read_b64_tr_b16 a[228:229], v2 offset:15360
    ds_read_b64_tr_b16 a[230:231], v2 offset:44032
    buffer_load_dwordx4 v240, s[16:19], s57 offen offset:0 lds
    s_waitcnt lgkmcnt(4)
    v_mfma_f32_32x32x16_bf16 v[64:79], a[240:243], v[184:187], v[64:79]
    ds_read_b64_tr_b16 a[232:233], v3 offset:15360
    ds_read_b64_tr_b16 a[234:235], v3 offset:44032
    v_mul_f32 v57, v246, v57
    v_mul_f32 v58, v246, v58
    v_mul_f32 v59, v246, v59
    v_mfma_f32_32x32x16_bf16 v[80:95], a[244:247], v[184:187], v[80:95]
    ds_read_b64_tr_b16 a[236:237], v4 offset:15360
    ds_read_b64_tr_b16 a[238:239], v4 offset:44032
    buffer_store_dwordx2 v[52:53], v252, s[28:31], s63 offen offset:2560 sc1
    v_cvt_pk_bf16_f32 v56, v56, v57
    v_mfma_f32_32x32x16_bf16 v[64:79], a[248:251], v[188:191], v[64:79]
    ds_read_b64_tr_b16 a[240:241], v1 offset:16384
    ds_read_b64_tr_b16 a[242:243], v1 offset:45056
    buffer_load_dwordx4 v241, s[16:19], s57 offen offset:1024 lds
    v_cvt_pk_bf16_f32 v57, v58, v59
    v_mfma_f32_32x32x16_bf16 v[80:95], a[252:255], v[188:191], v[80:95]
    ds_read_b64_tr_b16 a[244:245], v2 offset:16384
    ds_read_b64_tr_b16 a[246:247], v2 offset:45056
    v_mul_f32_e64 v60, v246, v60
    v_mul_f32 v61, v246, v61
    s_waitcnt lgkmcnt(4)
    v_mfma_f32_32x32x16_bf16 v[64:79], a[224:227], v[192:195], v[64:79]
    ds_read_b64_tr_b16 a[248:249], v3 offset:16384
    ds_read_b64_tr_b16 a[250:251], v3 offset:45056
    buffer_load_dwordx4 v242, s[16:19], s57 offen offset:2048 lds
    v_mul_f32_e64 v62, v246, v62
    v_mfma_f32_32x32x16_bf16 v[80:95], a[228:231], v[192:195], v[80:95]
    ds_read_b64_tr_b16 a[252:253], v4 offset:16384
    ds_read_b64_tr_b16 a[254:255], v4 offset:45056
    v_mul_f32 v63, v246, v63
    s_cmp_lt_i32 s100, 0
    s_cselect_b32 s84, 15532032, s84
    s_cselect_b32 s85, 15532032, s85
    v_mfma_f32_32x32x16_bf16 v[64:79], a[232:235], v[196:199], v[64:79]
    ds_read_b64_tr_b16 a[224:225], v1 offset:17408
    ds_read_b64_tr_b16 a[226:227], v1 offset:46080
    buffer_store_dwordx2 v[56:57], v252, s[28:31], s63 offen offset:3072 sc1
    v_cvt_pk_bf16_f32 v60, v60, v61
    v_mfma_f32_32x32x16_bf16 v[80:95], a[236:239], v[196:199], v[80:95]
    ds_read_b64_tr_b16 a[228:229], v2 offset:17408
    ds_read_b64_tr_b16 a[230:231], v2 offset:46080
    buffer_load_dwordx4 v243, s[16:19], s57 offen offset:3072 lds
    s_waitcnt lgkmcnt(4)
    s_nop 0
    v_mfma_f32_32x32x16_bf16 v[64:79], a[240:243], v[200:203], v[64:79]
    ds_read_b64_tr_b16 a[232:233], v3 offset:17408
    ds_read_b64_tr_b16 a[234:235], v3 offset:46080
    s_add_u32 m0, s55, 4096
    s_add_u32 s57, s57, 458752
    v_cvt_pk_bf16_f32 v61, v62, v63
    v_mfma_f32_32x32x16_bf16 v[80:95], a[244:247], v[200:203], v[80:95]
    ds_read_b64_tr_b16 a[236:237], v4 offset:17408
    ds_read_b64_tr_b16 a[238:239], v4 offset:46080
    buffer_load_dwordx4 v240, s[16:19], s57 offen offset:0 lds
    s_waitcnt vmcnt(27)
    s_nop 0
    v_mfma_f32_32x32x16_bf16 v[64:79], a[248:251], v[204:207], v[64:79]
    ds_read_b64_tr_b16 a[240:241], v1 offset:18432
    ds_read_b64_tr_b16 a[242:243], v1 offset:47104
    ds_read_b64_tr_b16 a[16:17], v5 offset:0
    ds_read_b64_tr_b16 a[18:19], v5 offset:1024
    ds_read_b64_tr_b16 a[20:21], v6 offset:0
    ds_read_b64_tr_b16 a[22:23], v6 offset:1024
    v_mfma_f32_32x32x16_bf16 v[80:95], a[252:255], v[204:207], v[80:95]
    ds_read_b64_tr_b16 a[244:245], v2 offset:18432
    ds_read_b64_tr_b16 a[246:247], v2 offset:47104
    buffer_store_dwordx2 v[60:61], v252, s[28:31], s63 offen offset:3584 sc1
    s_waitcnt lgkmcnt(8)
    s_nop 0
    v_mfma_f32_32x32x16_bf16 v[64:79], a[224:227], v[208:211], v[64:79]
    ds_read_b64_tr_b16 a[248:249], v3 offset:18432
    ds_read_b64_tr_b16 a[250:251], v3 offset:47104
    buffer_load_dwordx4 v241, s[16:19], s57 offen offset:1024 lds
    ds_read_b64_tr_b16 a[24:25], v5 offset:2048
    v_mfma_f32_32x32x16_bf16 v[80:95], a[228:231], v[208:211], v[80:95]
    ds_read_b64_tr_b16 a[252:253], v4 offset:18432
    ds_read_b64_tr_b16 a[254:255], v4 offset:47104
    ds_read_b64_tr_b16 a[26:27], v5 offset:3072
    ds_read_b64_tr_b16 a[28:29], v6 offset:2048
    ds_read_b64_tr_b16 a[30:31], v6 offset:3072
    v_mfma_f32_32x32x16_bf16 v[64:79], a[232:235], v[212:215], v[64:79]
    ds_read_b64_tr_b16 a[224:225], v1 offset:19456
    ds_read_b64_tr_b16 a[226:227], v1 offset:48128
    buffer_load_dwordx4 v242, s[16:19], s57 offen offset:2048 lds
    s_cmp_lt_i32 s88, 0
    s_nop 0
    s_cselect_b32 s86, 0xf149, 0
    v_mfma_f32_32x32x16_bf16 v[80:95], a[236:239], v[212:215], v[80:95]
    ds_read_b64_tr_b16 a[228:229], v2 offset:19456
    ds_read_b64_tr_b16 a[230:231], v2 offset:48128
    s_cmp_lt_i32 s88, -1
    s_cselect_b32 s87, 0xf149, 0
    s_waitcnt lgkmcnt(7)
    v_mfma_f32_32x32x16_bf16 v[64:79], a[240:243], v[216:219], v[64:79]
    ds_read_b64_tr_b16 a[232:233], v3 offset:19456
    ds_read_b64_tr_b16 a[234:235], v3 offset:48128
    v_readlane_b32 s56, v31, 4
    s_waitcnt lgkmcnt(6)
    s_add_u32 m0, s62, 0
    v_mfma_f32_32x32x16_bf16 v[80:95], a[244:247], v[216:219], v[80:95]
    ds_read_b64_tr_b16 a[236:237], v4 offset:19456
    ds_read_b64_tr_b16 a[238:239], v4 offset:48128
    buffer_load_dwordx4 v248, s[20:23], s56 offen offset:0 lds
    s_cmp_lt_i32 s88, -2
    s_nop 0
    s_cselect_b32 s88, 0xf149, 0
    v_mfma_f32_32x32x16_bf16 v[64:79], a[248:251], v[220:223], v[64:79]
    ds_read_b64_tr_b16 a[240:241], v1 offset:20480
    ds_read_b64_tr_b16 a[242:243], v1 offset:49152
    v_lshrrev_b32 v28, 4, v7
    v_lshrrev_b32 v29, 9, v7
    v_and_b32 v30, 31, v28
    v_lshlrev_b32 v24, 2, v29
    v_mfma_f32_32x32x16_bf16 v[80:95], a[252:255], v[220:223], v[80:95]
    ds_read_b64_tr_b16 a[244:245], v2 offset:20480
    ds_read_b64_tr_b16 a[246:247], v2 offset:49152
    buffer_load_dwordx4 v249, s[20:23], s56 offen offset:1024 lds
    s_waitcnt lgkmcnt(4)
    v_mfma_f32_32x32x16_bf16 v[64:79], a[224:227], v[224:227], v[64:79]
    ds_read_b64_tr_b16 a[248:249], v3 offset:20480
    ds_read_b64_tr_b16 a[250:251], v3 offset:49152
    v_sub_u32 v24, v30, v24
    v_mov_b32 v25, 0x0000ffff
    v_mov_b32 v26, 0xffff0000
    v_cmp_le_i32 s[100:101], 0, v24
    v_mfma_f32_32x32x16_bf16 v[80:95], a[228:231], v[224:227], v[80:95]
    ds_read_b64_tr_b16 a[252:253], v4 offset:20480
    ds_read_b64_tr_b16 a[254:255], v4 offset:49152
    s_waitcnt vmcnt(20)
    s_barrier
    v_mfma_f32_32x32x16_bf16 v[64:79], a[232:235], v[228:231], v[64:79]
    ds_read_b64_tr_b16 a[224:225], v1 offset:21504
    ds_read_b64_tr_b16 a[226:227], v1 offset:50176
    buffer_load_dwordx4 v250, s[20:23], s56 offen offset:2048 lds
    v_cmp_le_i32 s[76:77], 1, v24
    v_mfma_f32_32x32x16_bf16 v[80:95], a[236:239], v[228:231], v[80:95]
    ds_read_b64_tr_b16 a[228:229], v2 offset:21504
    ds_read_b64_tr_b16 a[230:231], v2 offset:50176
    v_cndmask_b32 v8, 0, v25, s[100:101]
    v_cndmask_b32 v27, 0, v26, s[76:77]
    v_cmp_le_i32 s[100:101], 2, v24
    s_waitcnt lgkmcnt(4)
    s_nop 0
    v_mfma_f32_32x32x16_bf16 v[64:79], a[240:243], v[232:235], v[64:79]
    ds_read_b64_tr_b16 a[232:233], v3 offset:21504
    ds_read_b64_tr_b16 a[234:235], v3 offset:50176
    buffer_load_dwordx4 v251, s[20:23], s56 offen offset:3072 lds
    v_cmp_le_i32 s[76:77], 3, v24
    v_mfma_f32_32x32x16_bf16 v[80:95], a[244:247], v[232:235], v[80:95]
    ds_read_b64_tr_b16 a[236:237], v4 offset:21504
    ds_read_b64_tr_b16 a[238:239], v4 offset:50176
    s_add_u32 m0, s55, 7168
    s_add_u32 s57, s50, s53
    v_or_b32 v8, v8, v27
    v_mfma_f32_32x32x16_bf16 v[64:79], a[248:251], v[236:239], v[64:79]
    ds_read_b64_tr_b16 a[240:241], v1 offset:22528
    ds_read_b64_tr_b16 a[242:243], v1 offset:51200
    buffer_load_dwordx4 v240, s[12:15], s57 offen offset:0 lds
    v_cndmask_b32 v9, 0, v25, s[100:101]
    v_mfma_f32_32x32x16_bf16 v[80:95], a[252:255], v[236:239], v[80:95]
    ds_read_b64_tr_b16 a[244:245], v2 offset:22528
    ds_read_b64_tr_b16 a[246:247], v2 offset:51200
    v_cndmask_b32 v27, 0, v26, s[76:77]
    v_cmp_le_i32 s[100:101], 8, v24
    v_cmp_le_i32 s[76:77], 9, v24
    s_waitcnt lgkmcnt(4)
    v_mfma_f32_32x32x16_bf16 v[96:111], a[224:227], v[128:131], 0
    ds_read_b64_tr_b16 a[248:249], v3 offset:22528
    ds_read_b64_tr_b16 a[250:251], v3 offset:51200
    buffer_load_dwordx4 v241, s[12:15], s57 offen offset:1024 lds
    v_or_b32 v9, v9, v27
    v_mfma_f32_32x32x16_bf16 v[112:127], a[228:231], v[128:131], 0
    ds_read_b64_tr_b16 a[252:253], v4 offset:22528
    ds_read_b64_tr_b16 a[254:255], v4 offset:51200
    v_cndmask_b32 v10, 0, v25, s[100:101]
    v_cndmask_b32 v27, 0, v26, s[76:77]
    v_cmp_le_i32 s[100:101], 10, v24
    v_cmp_le_i32 s[76:77], 11, v24
    v_mfma_f32_32x32x16_bf16 v[96:111], a[232:235], v[132:135], v[96:111]
    ds_read_b64_tr_b16 a[224:225], v1 offset:23552
    ds_read_b64_tr_b16 a[226:227], v1 offset:52224
    buffer_load_dwordx4 v242, s[12:15], s57 offen offset:2048 lds
    v_or_b32_e64 v10, v10, v27
    v_mfma_f32_32x32x16_bf16 v[112:127], a[236:239], v[132:135], v[112:127]
    ds_read_b64_tr_b16 a[228:229], v2 offset:23552
    ds_read_b64_tr_b16 a[230:231], v2 offset:52224
    v_cndmask_b32 v11, 0, v25, s[100:101]
    v_cndmask_b32 v27, 0, v26, s[76:77]
    v_cmp_le_i32 s[100:101], 16, v24
    s_waitcnt lgkmcnt(4)
    s_nop 0
    v_mfma_f32_32x32x16_bf16 v[96:111], a[240:243], v[136:139], v[96:111]
    ds_read_b64_tr_b16 a[232:233], v3 offset:23552
    ds_read_b64_tr_b16 a[234:235], v3 offset:52224
    buffer_load_dwordx4 v243, s[12:15], s57 offen offset:3072 lds
    v_cmp_le_i32 s[76:77], 17, v24
    v_mfma_f32_32x32x16_bf16 v[112:127], a[244:247], v[136:139], v[112:127]
    ds_read_b64_tr_b16 a[236:237], v4 offset:23552
    ds_read_b64_tr_b16 a[238:239], v4 offset:52224
    s_add_u32 m0, s55, 11264
    s_add_u32 s57, s57, 458752
    v_mfma_f32_32x32x16_bf16 v[96:111], a[248:251], v[140:143], v[96:111]
    ds_read_b64_tr_b16 a[240:241], v1 offset:24576
    ds_read_b64_tr_b16 a[242:243], v1 offset:53248
    buffer_load_dwordx4 v240, s[12:15], s57 offen offset:0 lds
    ds_read_b64_tr_b16 a[32:33], v5 offset:16384
    v_mfma_f32_32x32x16_bf16 v[112:127], a[252:255], v[140:143], v[112:127]
    ds_read_b64_tr_b16 a[244:245], v2 offset:24576
    ds_read_b64_tr_b16 a[246:247], v2 offset:53248
    ds_read_b64_tr_b16 a[34:35], v5 offset:17408
    ds_read_b64_tr_b16 a[36:37], v6 offset:16384
    ds_read_b64_tr_b16 a[38:39], v6 offset:17408
    s_waitcnt lgkmcnt(8)
    v_mfma_f32_32x32x16_bf16 v[96:111], a[224:227], v[144:147], v[96:111]
    ds_read_b64_tr_b16 a[248:249], v3 offset:24576
    ds_read_b64_tr_b16 a[250:251], v3 offset:53248
    buffer_load_dwordx4 v241, s[12:15], s57 offen offset:1024 lds
    ds_read_b64_tr_b16 a[40:41], v5 offset:18432
    v_mfma_f32_32x32x16_bf16 v[112:127], a[228:231], v[144:147], v[112:127]
    ds_read_b64_tr_b16 a[252:253], v4 offset:24576
    ds_read_b64_tr_b16 a[254:255], v4 offset:53248
    s_waitcnt vmcnt(12)
    buffer_store_dword v255, v0, s[28:31], s69 offen sc1
    v_mfma_f32_32x32x16_bf16 v[96:111], a[232:235], v[148:151], v[96:111]
    ds_read_b64_tr_b16 a[224:225], v1 offset:25600
    ds_read_b64_tr_b16 a[226:227], v1 offset:54272
    ds_read_b64_tr_b16 a[42:43], v5 offset:19456
    ds_read_b64_tr_b16 a[44:45], v6 offset:18432
    ds_read_b64_tr_b16 a[46:47], v6 offset:19456
    v_or_b32_e64 v11, v11, v27
    v_mfma_f32_32x32x16_bf16 v[112:127], a[236:239], v[148:151], v[112:127]
    ds_read_b64_tr_b16 a[228:229], v2 offset:25600
    ds_read_b64_tr_b16 a[230:231], v2 offset:54272
    buffer_load_dwordx4 v242, s[12:15], s57 offen offset:2048 lds
    s_waitcnt lgkmcnt(7)
    v_mfma_f32_32x32x16_bf16 v[96:111], a[240:243], v[152:155], v[96:111]
    ds_read_b64_tr_b16 a[232:233], v3 offset:25600
    ds_read_b64_tr_b16 a[234:235], v3 offset:54272
    v_readlane_b32 s56, v31, 5
    s_waitcnt lgkmcnt(4)
    s_add_u32 m0, s62, 16384
    v_cndmask_b32 v12, 0, v25, s[100:101]
    v_mfma_f32_32x32x16_bf16 v[112:127], a[244:247], v[152:155], v[112:127]
    ds_read_b64_tr_b16 a[236:237], v4 offset:25600
    ds_read_b64_tr_b16 a[238:239], v4 offset:54272
    buffer_load_dwordx4 v248, s[20:23], s56 offen offset:0 lds
    v_cndmask_b32 v27, 0, v26, s[76:77]
    v_mfma_f32_32x32x16_bf16 v[96:111], a[248:251], v[156:159], v[96:111]
    ds_read_b64_tr_b16 a[240:241], v1 offset:26624
    ds_read_b64_tr_b16 a[242:243], v1 offset:55296
    ds_read_b64_tr_b16 a[48:49], v5 offset:32768
    ds_read_b64_tr_b16 a[50:51], v5 offset:33792
    ds_read_b64_tr_b16 a[52:53], v6 offset:32768
    v_mfma_f32_32x32x16_bf16 v[112:127], a[252:255], v[156:159], v[112:127]
    ds_read_b64_tr_b16 a[244:245], v2 offset:26624
    ds_read_b64_tr_b16 a[246:247], v2 offset:55296
    buffer_load_dwordx4 v249, s[20:23], s56 offen offset:1024 lds
    s_waitcnt lgkmcnt(7)
    s_nop 0
    v_mfma_f32_32x32x16_bf16 v[96:111], a[224:227], v[160:163], v[96:111]
    ds_read_b64_tr_b16 a[248:249], v3 offset:26624
    ds_read_b64_tr_b16 a[250:251], v3 offset:55296
    ds_read_b64_tr_b16 a[54:55], v6 offset:33792
    ds_read_b64_tr_b16 a[56:57], v5 offset:34816
    ds_read_b64_tr_b16 a[58:59], v5 offset:35840
    ds_read_b64_tr_b16 a[60:61], v6 offset:34816
    v_mfma_f32_32x32x16_bf16 v[112:127], a[228:231], v[160:163], v[112:127]
    ds_read_b64_tr_b16 a[252:253], v4 offset:26624
    ds_read_b64_tr_b16 a[254:255], v4 offset:55296
    buffer_load_dwordx4 v250, s[20:23], s56 offen offset:2048 lds
    ds_read_b64_tr_b16 a[62:63], v6 offset:35840
    v_mfma_f32_32x32x16_bf16 v[96:111], a[232:235], v[164:167], v[96:111]
    ds_read_b64_tr_b16 a[224:225], v1 offset:27648
    ds_read_b64_tr_b16 a[226:227], v1 offset:56320
    v_cmp_le_i32 s[100:101], 18, v24
    v_cmp_le_i32 s[76:77], 19, v24
    v_or_b32_e64 v12, v12, v27
    v_cndmask_b32 v13, 0, v25, s[100:101]
    v_mfma_f32_32x32x16_bf16 v[112:127], a[236:239], v[164:167], v[112:127]
    ds_read_b64_tr_b16 a[228:229], v2 offset:27648
    ds_read_b64_tr_b16 a[230:231], v2 offset:56320
    buffer_load_dwordx4 v251, s[20:23], s56 offen offset:3072 lds
    s_waitcnt lgkmcnt(5)
    s_nop 0
    v_mfma_f32_32x32x16_bf16 v[96:111], a[240:243], v[168:171], v[96:111]
    ds_read_b64_tr_b16 a[232:233], v3 offset:27648
    ds_read_b64_tr_b16 a[234:235], v3 offset:56320
    v_cndmask_b32 v27, 0, v26, s[76:77]
    v_cmp_le_i32 s[100:101], 24, v24
    v_cmp_le_i32 s[76:77], 25, v24
    v_or_b32 v13, v13, v27
    v_mfma_f32_32x32x16_bf16 v[112:127], a[244:247], v[168:171], v[112:127]
    ds_read_b64_tr_b16 a[236:237], v4 offset:27648
    ds_read_b64_tr_b16 a[238:239], v4 offset:56320
    s_waitcnt vmcnt(16)
    s_barrier
    v_readlane_b32 s56, v31, 6
    s_waitcnt lgkmcnt(8)
    s_add_u32 m0, s62, 32768
    v_mfma_f32_32x32x16_bf16 v[96:111], a[248:251], v[172:175], v[96:111]
    ds_read_b64_tr_b16 a[240:241], v1 offset:0
    ds_read_b64_tr_b16 a[242:243], v1 offset:28672
    buffer_load_dwordx4 v248, s[20:23], s56 offen offset:0 lds
    v_cndmask_b32 v14, 0, v25, s[100:101]
    v_mfma_f32_32x32x16_bf16 v[112:127], a[252:255], v[172:175], v[112:127]
    ds_read_b64_tr_b16 a[244:245], v2 offset:0
    ds_read_b64_tr_b16 a[246:247], v2 offset:28672
    v_cndmask_b32 v27, 0, v26, s[76:77]
    v_cmp_le_i32 s[100:101], 26, v24
    v_cmp_le_i32 s[76:77], 27, v24
    s_waitcnt lgkmcnt(4)
    v_mfma_f32_32x32x16_bf16 v[96:111], a[224:227], v[176:179], v[96:111]
    ds_read_b64_tr_b16 a[248:249], v3 offset:0
    ds_read_b64_tr_b16 a[250:251], v3 offset:28672
    buffer_load_dwordx4 v249, s[20:23], s56 offen offset:1024 lds
    v_or_b32 v14, v14, v27
    v_mfma_f32_32x32x16_bf16 v[112:127], a[228:231], v[176:179], v[112:127]
    ds_read_b64_tr_b16 a[252:253], v4 offset:0
    ds_read_b64_tr_b16 a[254:255], v4 offset:28672
    v_cndmask_b32 v15, 0, v25, s[100:101]
    v_cndmask_b32 v27, 0, v26, s[76:77]
    v_cmp_gt_u32 s[100:101], 48, v28
    v_cmp_gt_u32 s[76:77], 28, v30
    v_mfma_f32_32x32x16_bf16 v[96:111], a[232:235], v[180:183], v[96:111]
    ds_read_b64_tr_b16 a[224:225], v1 offset:1024
    ds_read_b64_tr_b16 a[226:227], v1 offset:29696
    buffer_load_dwordx4 v250, s[20:23], s56 offen offset:2048 lds
    v_or_b32_e64 v15, v15, v27
    v_mfma_f32_32x32x16_bf16 v[112:127], a[236:239], v[180:183], v[112:127]
    ds_read_b64_tr_b16 a[228:229], v2 offset:1024
    ds_read_b64_tr_b16 a[230:231], v2 offset:29696
    v_mov_b32 v27, 2146435072
    v_mul_u32_u24 v23, 7168, v29
    v_cndmask_b32 v22, v27, v7, s[100:101]
    s_waitcnt lgkmcnt(4)
    s_nop 0
    v_mfma_f32_32x32x16_bf16 v[96:111], a[240:243], v[184:187], v[96:111]
    ds_read_b64_tr_b16 a[232:233], v3 offset:1024
    ds_read_b64_tr_b16 a[234:235], v3 offset:29696
    buffer_load_dwordx4 v251, s[20:23], s56 offen offset:3072 lds
    v_cmp_gt_u32 s[100:101], 32, v28
    v_mfma_f32_32x32x16_bf16 v[112:127], a[244:247], v[184:187], v[112:127]
    ds_read_b64_tr_b16 a[236:237], v4 offset:1024
    ds_read_b64_tr_b16 a[238:239], v4 offset:29696
    s_add_u32 m0, s55, 14336
    s_add_u32 s57, s50, s54
    s_nop 0
    v_lshl_add_u32 v23, v30, 4, v23
    v_mfma_f32_32x32x16_bf16 v[96:111], a[248:251], v[188:191], v[96:111]
    ds_read_b64_tr_b16 a[240:241], v1 offset:2048
    ds_read_b64_tr_b16 a[242:243], v1 offset:30720
    buffer_load_dwordx4 v240, s[12:15], s57 offen offset:0 lds
    v_cndmask_b32 v23, v27, v23, s[76:77]
    v_mfma_f32_32x32x16_bf16 v[112:127], a[252:255], v[188:191], v[112:127]
    ds_read_b64_tr_b16 a[244:245], v2 offset:2048
    ds_read_b64_tr_b16 a[246:247], v2 offset:30720
    v_cndmask_b32 v25, v27, v252, s[100:101]
    v_and_b32 v26, 62, v28
    s_waitcnt lgkmcnt(4)
    v_mfma_f32_32x32x16_bf16 v[96:111], a[224:227], v[192:195], v[96:111]
    ds_read_b64_tr_b16 a[248:249], v3 offset:2048
    ds_read_b64_tr_b16 a[250:251], v3 offset:30720
    buffer_load_dwordx4 v241, s[12:15], s57 offen offset:1024 lds
    s_mul_i32 s76, s40, 6
    s_nop 0
    v_mfma_f32_32x32x16_bf16 v[112:127], a[228:231], v[192:195], v[112:127]
    ds_read_b64_tr_b16 a[252:253], v4 offset:2048
    ds_read_b64_tr_b16 a[254:255], v4 offset:30720
    s_bfe_u32 s77, s42, 65537
    s_add_u32 s76, s76, s77
    s_xor_b32 s77, s76, 1
    v_mfma_f32_32x32x16_bf16 v[96:111], a[232:235], v[196:199], v[96:111]
    ds_read_b64_tr_b16 a[224:225], v1 offset:3072
    ds_read_b64_tr_b16 a[226:227], v1 offset:31744
    buffer_load_dwordx4 v242, s[12:15], s57 offen offset:2048 lds
    s_sub_u32 s77, s77, 6
    v_mfma_f32_32x32x16_bf16 v[112:127], a[236:239], v[196:199], v[112:127]
    ds_read_b64_tr_b16 a[228:229], v2 offset:3072
    ds_read_b64_tr_b16 a[230:231], v2 offset:31744
    v_cmp_gt_u32 s[100:101], 6, v28
    v_add_u32 v24, s77, v26
    v_add_u32 v26, s76, v26
    s_waitcnt lgkmcnt(4)
    v_mfma_f32_32x32x16_bf16 v[96:111], a[240:243], v[200:203], v[96:111]
    ds_read_b64_tr_b16 a[232:233], v3 offset:3072
    ds_read_b64_tr_b16 a[234:235], v3 offset:31744
    buffer_load_dwordx4 v243, s[12:15], s57 offen offset:3072 lds
    v_cndmask_b32 v26, v24, v26, s[100:101]
    v_mfma_f32_32x32x16_bf16 v[112:127], a[244:247], v[200:203], v[112:127]
    ds_read_b64_tr_b16 a[236:237], v4 offset:3072
    ds_read_b64_tr_b16 a[238:239], v4 offset:31744
    s_add_u32 m0, s55, 18432
    s_add_u32 s57, s57, 458752
    s_waitcnt vmcnt(20)
    s_nop 0
    v_mfma_f32_32x32x16_bf16 v[96:111], a[248:251], v[204:207], v[96:111]
    ds_read_b64_tr_b16 a[240:241], v1 offset:4096
    ds_read_b64_tr_b16 a[242:243], v1 offset:32768
    buffer_load_dwordx4 v240, s[12:15], s57 offen offset:0 lds
    ds_read_b64_tr_b16 a[64:65], v5 offset:0
    v_mfma_f32_32x32x16_bf16 v[112:127], a[252:255], v[204:207], v[112:127]
    ds_read_b64_tr_b16 a[244:245], v2 offset:4096
    ds_read_b64_tr_b16 a[246:247], v2 offset:32768
    ds_read_b64_tr_b16 a[66:67], v5 offset:1024
    ds_read_b64_tr_b16 a[68:69], v6 offset:0
    ds_read_b64_tr_b16 a[70:71], v6 offset:1024
    s_waitcnt lgkmcnt(8)
    s_nop 0
    v_mfma_f32_32x32x16_bf16 v[96:111], a[224:227], v[208:211], v[96:111]
    ds_read_b64_tr_b16 a[248:249], v3 offset:4096
    ds_read_b64_tr_b16 a[250:251], v3 offset:32768
    buffer_load_dwordx4 v241, s[12:15], s57 offen offset:1024 lds
    ds_read_b64_tr_b16 a[72:73], v5 offset:2048
    v_mfma_f32_32x32x16_bf16 v[112:127], a[228:231], v[208:211], v[112:127]
    ds_read_b64_tr_b16 a[252:253], v4 offset:4096
    ds_read_b64_tr_b16 a[254:255], v4 offset:32768
    ds_read_b64_tr_b16 a[74:75], v5 offset:3072
    ds_read_b64_tr_b16 a[76:77], v6 offset:2048
    ds_read_b64_tr_b16 a[78:79], v6 offset:3072
    v_cmp_gt_u32 s[100:101], 12, v28
    v_mfma_f32_32x32x16_bf16 v[96:111], a[232:235], v[212:215], v[96:111]
    ds_read_b64_tr_b16 a[224:225], v1 offset:5120
    ds_read_b64_tr_b16 a[226:227], v1 offset:33792
    buffer_load_dwordx4 v242, s[12:15], s57 offen offset:2048 lds
    s_add_u32 s76, s40, 24
    s_nop 0
    v_mfma_f32_32x32x16_bf16 v[112:127], a[236:239], v[212:215], v[112:127]
    ds_read_b64_tr_b16 a[228:229], v2 offset:5120
    ds_read_b64_tr_b16 a[230:231], v2 offset:33792
    v_mov_b32 v24, s76
    v_cndmask_b32 v26, v24, v26, s[100:101]
    v_cmp_gt_u32 s[100:101], 14, v28
    s_waitcnt lgkmcnt(7)
    v_mfma_f32_32x32x16_bf16 v[96:111], a[240:243], v[216:219], v[96:111]
    ds_read_b64_tr_b16 a[232:233], v3 offset:5120
    ds_read_b64_tr_b16 a[234:235], v3 offset:33792
    v_readlane_b32 s56, v31, 7
    s_waitcnt lgkmcnt(6)
    s_add_u32 m0, s62, 0
    v_and_b32_e64 v24, 1, v28
    v_mfma_f32_32x32x16_bf16 v[112:127], a[244:247], v[216:219], v[112:127]
    ds_read_b64_tr_b16 a[236:237], v4 offset:5120
    ds_read_b64_tr_b16 a[238:239], v4 offset:33792
    buffer_load_dwordx4 v248, s[20:23], s56 offen offset:0 lds
    v_add_u32_e64 v24, s79, v24
    v_mfma_f32_32x32x16_bf16 v[96:111], a[248:251], v[220:223], v[96:111]
    ds_read_b64_tr_b16 a[240:241], v1 offset:6144
    ds_read_b64_tr_b16 a[242:243], v1 offset:34816
    v_lshlrev_b32_e64 v24, 9, v24
    v_lshl_add_u32 v26, v26, 2, v24
    v_add_u32 v26, 15401088, v26
    v_add_u32 v24, 13312, v23
    v_mfma_f32_32x32x16_bf16 v[112:127], a[252:255], v[220:223], v[112:127]
    ds_read_b64_tr_b16 a[244:245], v2 offset:6144
    ds_read_b64_tr_b16 a[246:247], v2 offset:34816
    buffer_load_dwordx4 v249, s[20:23], s56 offen offset:1024 lds
    s_waitcnt lgkmcnt(4)
    s_nop 0
    v_mfma_f32_32x32x16_bf16 v[96:111], a[224:227], v[224:227], v[96:111]
    ds_read_b64_tr_b16 a[248:249], v3 offset:6144
    ds_read_b64_tr_b16 a[250:251], v3 offset:34816
    v_cndmask_b32 v26, v27, v26, s[100:101]
    s_add_u32 s76, s40, 0
    s_cmp_ge_u32 s76, 3
    s_cselect_b32 s77, 16384, 0
    v_mfma_f32_32x32x16_bf16 v[112:127], a[228:231], v[224:227], v[112:127]
    ds_read_b64_tr_b16 a[252:253], v4 offset:6144
    ds_read_b64_tr_b16 a[254:255], v4 offset:34816
    s_waitcnt vmcnt(17)
    s_barrier
    v_mfma_f32_32x32x16_bf16 v[96:111], a[232:235], v[228:231], v[96:111]
    ds_read_b64_tr_b16 a[224:225], v1 offset:7168
    ds_read_b64_tr_b16 a[226:227], v1 offset:35840
    buffer_load_dwordx4 v250, s[20:23], s56 offen offset:2048 lds
    s_lshl_b32 s76, s76, 12
    s_nop 0
    v_mfma_f32_32x32x16_bf16 v[112:127], a[236:239], v[228:231], v[112:127]
    ds_read_b64_tr_b16 a[228:229], v2 offset:7168
    ds_read_b64_tr_b16 a[230:231], v2 offset:35840
    s_add_u32 s76, s76, s77
    s_add_u32 s76, s76, 7168
    s_waitcnt lgkmcnt(4)
    v_mfma_f32_32x32x16_bf16 v[96:111], a[240:243], v[232:235], v[96:111]
    ds_read_b64_tr_b16 a[232:233], v3 offset:7168
    ds_read_b64_tr_b16 a[234:235], v3 offset:35840
    buffer_load_dwordx4 v251, s[20:23], s56 offen offset:3072 lds
    v_add_u32_e64 v16, s76, v252
    v_mfma_f32_32x32x16_bf16 v[112:127], a[244:247], v[232:235], v[112:127]
    ds_read_b64_tr_b16 a[236:237], v4 offset:7168
    ds_read_b64_tr_b16 a[238:239], v4 offset:35840
    s_add_u32 m0, s55, 21504
    s_add_u32 s57, s50, s53
    v_add_u32 v19, s76, v7
    v_mfma_f32_32x32x16_bf16 v[96:111], a[248:251], v[236:239], v[96:111]
    ds_read_b64_tr_b16 a[240:241], v1 offset:8192
    ds_read_b64_tr_b16 a[242:243], v1 offset:36864
    buffer_load_dwordx4 v240, s[16:19], s57 offen offset:0 lds
    s_add_u32 s76, s40, 1
    v_mfma_f32_32x32x16_bf16 v[112:127], a[252:255], v[236:239], v[112:127]
    ds_read_b64_tr_b16 a[244:245], v2 offset:8192
    ds_read_b64_tr_b16 a[246:247], v2 offset:36864
    s_cmp_ge_u32 s76, 3
    s_cselect_b32 s77, 16384, 0
    s_waitcnt lgkmcnt(4)
    v_mfma_f32_32x32x16_bf16 v[32:47], a[224:227], v[128:131], 0
    ds_read_b64_tr_b16 a[248:249], v3 offset:8192
    ds_read_b64_tr_b16 a[250:251], v3 offset:36864
    buffer_load_dwordx4 v241, s[16:19], s57 offen offset:1024 lds
    s_lshl_b32 s76, s76, 12
    v_mfma_f32_32x32x16_bf16 v[48:63], a[228:231], v[128:131], 0
    ds_read_b64_tr_b16 a[252:253], v4 offset:8192
    ds_read_b64_tr_b16 a[254:255], v4 offset:36864
    s_add_u32 s76, s76, s77
    s_add_u32 s76, s76, 7168
    v_add_u32 v17, s76, v252
    v_mfma_f32_32x32x16_bf16 v[32:47], a[232:235], v[132:135], v[32:47]
    ds_read_b64_tr_b16 a[224:225], v1 offset:9216
    ds_read_b64_tr_b16 a[226:227], v1 offset:37888
    buffer_load_dwordx4 v242, s[16:19], s57 offen offset:2048 lds
    v_add_u32_e64 v20, s76, v7
    v_mfma_f32_32x32x16_bf16 v[48:63], a[236:239], v[132:135], v[48:63]
    ds_read_b64_tr_b16 a[228:229], v2 offset:9216
    ds_read_b64_tr_b16 a[230:231], v2 offset:37888
    v_mul_f32 v64, v245, v64
    v_mul_f32 v65, v245, v65
    v_mul_f32_e64 v66, v245, v66
    v_mul_f32 v67, v245, v67
    s_waitcnt lgkmcnt(4)
    v_mfma_f32_32x32x16_bf16 v[32:47], a[240:243], v[136:139], v[32:47]
    ds_read_b64_tr_b16 a[232:233], v3 offset:9216
    ds_read_b64_tr_b16 a[234:235], v3 offset:37888
    buffer_load_dwordx4 v243, s[16:19], s57 offen offset:3072 lds
    v_mul_f32 v68, v245, v68
    v_mul_f32 v69, v245, v69
    v_mul_f32_e64 v70, v245, v70
    v_mfma_f32_32x32x16_bf16 v[48:63], a[244:247], v[136:139], v[48:63]
    ds_read_b64_tr_b16 a[236:237], v4 offset:9216
    ds_read_b64_tr_b16 a[238:239], v4 offset:37888
    s_add_u32 m0, s55, 25600
    s_add_u32 s57, s57, 458752
    v_mul_f32 v71, v245, v71
    v_mul_f32 v64, v96, v64
    v_mul_f32_e64 v65, v97, v65
    v_mfma_f32_32x32x16_bf16 v[32:47], a[248:251], v[140:143], v[32:47]
    ds_read_b64_tr_b16 a[240:241], v1 offset:10240
    ds_read_b64_tr_b16 a[242:243], v1 offset:38912
    buffer_load_dwordx4 v240, s[16:19], s57 offen offset:0 lds
    s_waitcnt vmcnt(20)
    v_mul_f32 v66, v98, v66
    v_mul_f32_e64 v67, v99, v67
    v_mfma_f32_32x32x16_bf16 v[48:63], a[252:255], v[140:143], v[48:63]
    ds_read_b64_tr_b16 a[244:245], v2 offset:10240
    ds_read_b64_tr_b16 a[246:247], v2 offset:38912
    ds_read_b64_tr_b16 a[80:81], v5 offset:16384
    ds_read_b64_tr_b16 a[82:83], v5 offset:17408
    ds_read_b64_tr_b16 a[84:85], v6 offset:16384
    v_mul_f32 v68, v100, v68
    s_waitcnt lgkmcnt(7)
    v_mfma_f32_32x32x16_bf16 v[32:47], a[224:227], v[144:147], v[32:47]
    ds_read_b64_tr_b16 a[248:249], v3 offset:10240
    ds_read_b64_tr_b16 a[250:251], v3 offset:38912
    buffer_load_dwordx4 v241, s[16:19], s57 offen offset:1024 lds
    ds_read_b64_tr_b16 a[86:87], v6 offset:17408
    v_mul_f32 v69, v101, v69
    v_mul_f32 v70, v102, v70
    v_mfma_f32_32x32x16_bf16 v[48:63], a[228:231], v[144:147], v[48:63]
    ds_read_b64_tr_b16 a[252:253], v4 offset:10240
    ds_read_b64_tr_b16 a[254:255], v4 offset:38912
    ds_read_b64_tr_b16 a[88:89], v5 offset:18432
    ds_read_b64_tr_b16 a[90:91], v5 offset:19456
    ds_read_b64_tr_b16 a[92:93], v6 offset:18432
    ds_read_b64_tr_b16 a[94:95], v6 offset:19456
    v_mul_f32_e64 v71, v103, v71
    v_mfma_f32_32x32x16_bf16 v[32:47], a[232:235], v[148:151], v[32:47]
    ds_read_b64_tr_b16 a[224:225], v1 offset:11264
    ds_read_b64_tr_b16 a[226:227], v1 offset:39936
    buffer_load_dwordx4 v242, s[16:19], s57 offen offset:2048 lds
    v_cvt_pk_bf16_f32 v64, v64, v65
    v_cvt_pk_bf16_f32 v65, v66, v67
    v_cvt_pk_bf16_f32 v66, v68, v69
    v_mfma_f32_32x32x16_bf16 v[48:63], a[236:239], v[148:151], v[48:63]
    ds_read_b64_tr_b16 a[228:229], v2 offset:11264
    ds_read_b64_tr_b16 a[230:231], v2 offset:39936
    v_cvt_pk_bf16_f32 v67, v70, v71
    v_mul_f32_e64 v72, v245, v72
    v_mul_f32 v73, v245, v73
    s_waitcnt lgkmcnt(8)
    v_mfma_f32_32x32x16_bf16 v[32:47], a[240:243], v[152:155], v[32:47]
    ds_read_b64_tr_b16 a[232:233], v3 offset:11264
    ds_read_b64_tr_b16 a[234:235], v3 offset:39936
    buffer_store_dwordx4 v[64:67], v7, s[28:31], s72 offen offset:0 sc1
    v_mul_f32_e64 v74, v245, v74
    v_mfma_f32_32x32x16_bf16 v[48:63], a[244:247], v[152:155], v[48:63]
    ds_read_b64_tr_b16 a[236:237], v4 offset:11264
    ds_read_b64_tr_b16 a[238:239], v4 offset:39936
    v_readlane_b32 s56, v31, 8
    s_waitcnt lgkmcnt(8)
    s_add_u32 m0, s62, 16384
    v_mul_f32 v75, v245, v75
    v_mfma_f32_32x32x16_bf16 v[32:47], a[248:251], v[156:159], v[32:47]
    ds_read_b64_tr_b16 a[240:241], v1 offset:12288
    ds_read_b64_tr_b16 a[242:243], v1 offset:40960
    buffer_load_dwordx4 v248, s[20:23], s56 offen offset:0 lds
    v_mul_f32_e64 v76, v245, v76
    v_mfma_f32_32x32x16_bf16 v[48:63], a[252:255], v[156:159], v[48:63]
    ds_read_b64_tr_b16 a[244:245], v2 offset:12288
    ds_read_b64_tr_b16 a[246:247], v2 offset:40960
    v_mul_f32 v77, v245, v77
    v_mul_f32 v78, v245, v78
    v_mul_f32 v79, v245, v79
    s_waitcnt lgkmcnt(4)
    v_mfma_f32_32x32x16_bf16 v[32:47], a[224:227], v[160:163], v[32:47]
    ds_read_b64_tr_b16 a[248:249], v3 offset:12288
    ds_read_b64_tr_b16 a[250:251], v3 offset:40960
    v_mul_f32 v72, v104, v72
    v_mul_f32 v73, v105, v73
    v_mul_f32 v74, v106, v74
    v_mul_f32 v75, v107, v75
    v_mfma_f32_32x32x16_bf16 v[48:63], a[228:231], v[160:163], v[48:63]
    ds_read_b64_tr_b16 a[252:253], v4 offset:12288
    ds_read_b64_tr_b16 a[254:255], v4 offset:40960
    buffer_load_dwordx4 v249, s[20:23], s56 offen offset:1024 lds
    v_mul_f32_e64 v76, v108, v76
    v_mfma_f32_32x32x16_bf16 v[32:47], a[232:235], v[164:167], v[32:47]
    ds_read_b64_tr_b16 a[224:225], v1 offset:13312
    ds_read_b64_tr_b16 a[226:227], v1 offset:41984
    v_mul_f32 v77, v109, v77
    v_mul_f32 v78, v110, v78
    v_mul_f32_e64 v79, v111, v79
    v_cvt_pk_bf16_f32 v72, v72, v73
    v_mfma_f32_32x32x16_bf16 v[48:63], a[236:239], v[164:167], v[48:63]
    ds_read_b64_tr_b16 a[228:229], v2 offset:13312
    ds_read_b64_tr_b16 a[230:231], v2 offset:41984
    buffer_load_dwordx4 v250, s[20:23], s56 offen offset:2048 lds
    s_waitcnt lgkmcnt(4)
    s_nop 0
    v_mfma_f32_32x32x16_bf16 v[32:47], a[240:243], v[168:171], v[32:47]
    ds_read_b64_tr_b16 a[232:233], v3 offset:13312
    ds_read_b64_tr_b16 a[234:235], v3 offset:41984
    v_cvt_pk_bf16_f32 v73, v74, v75
    v_cvt_pk_bf16_f32 v74, v76, v77
    v_cvt_pk_bf16_f32 v75, v78, v79
    v_mul_f32_e64 v80, v245, v80
    v_mfma_f32_32x32x16_bf16 v[48:63], a[244:247], v[168:171], v[48:63]
    ds_read_b64_tr_b16 a[236:237], v4 offset:13312
    ds_read_b64_tr_b16 a[238:239], v4 offset:41984
    s_waitcnt vmcnt(15)
    s_barrier
    v_mfma_f32_32x32x16_bf16 v[32:47], a[248:251], v[172:175], v[32:47]
    ds_read_b64_tr_b16 a[240:241], v1 offset:14336
    ds_read_b64_tr_b16 a[242:243], v1 offset:43008
    buffer_store_dwordx4 v[72:75], v7, s[28:31], s72 offen offset:1024 sc1
    v_mul_f32_e64 v81, v245, v81
    v_mfma_f32_32x32x16_bf16 v[48:63], a[252:255], v[172:175], v[48:63]
    ds_read_b64_tr_b16 a[244:245], v2 offset:14336
    ds_read_b64_tr_b16 a[246:247], v2 offset:43008
    v_mul_f32 v82, v245, v82
    v_mul_f32 v83, v245, v83
    v_mul_f32 v84, v245, v84
    s_waitcnt lgkmcnt(4)
    v_mfma_f32_32x32x16_bf16 v[32:47], a[224:227], v[176:179], v[32:47]
    ds_read_b64_tr_b16 a[248:249], v3 offset:14336
    ds_read_b64_tr_b16 a[250:251], v3 offset:43008
    buffer_load_dwordx4 v251, s[20:23], s56 offen offset:3072 lds
    v_mul_f32_e64 v85, v245, v85
    v_mfma_f32_32x32x16_bf16 v[48:63], a[228:231], v[176:179], v[48:63]
    ds_read_b64_tr_b16 a[252:253], v4 offset:14336
    ds_read_b64_tr_b16 a[254:255], v4 offset:43008
    s_add_u32 m0, s55, 0
    s_add_u32 s57, s50, s54
    v_mul_f32_e64 v86, v245, v86
    v_mfma_f32_32x32x16_bf16 v[32:47], a[232:235], v[180:183], v[32:47]
    ds_read_b64_tr_b16 a[224:225], v1 offset:15360
    ds_read_b64_tr_b16 a[226:227], v1 offset:44032
    buffer_load_dwordx4 v240, s[16:19], s57 offen offset:0 lds
    v_mul_f32_e64 v87, v245, v87
    v_mfma_f32_32x32x16_bf16 v[48:63], a[236:239], v[180:183], v[48:63]
    ds_read_b64_tr_b16 a[228:229], v2 offset:15360
    ds_read_b64_tr_b16 a[230:231], v2 offset:44032
    v_mul_f32 v80, v112, v80
    v_mul_f32 v81, v113, v81
    v_mul_f32 v82, v114, v82
    s_waitcnt lgkmcnt(4)
    v_mfma_f32_32x32x16_bf16 v[32:47], a[240:243], v[184:187], v[32:47]
    ds_read_b64_tr_b16 a[232:233], v3 offset:15360
    ds_read_b64_tr_b16 a[234:235], v3 offset:44032
    buffer_load_dwordx4 v241, s[16:19], s57 offen offset:1024 lds
    v_mul_f32_e64 v83, v115, v83
    v_mfma_f32_32x32x16_bf16 v[48:63], a[244:247], v[184:187], v[48:63]
    ds_read_b64_tr_b16 a[236:237], v4 offset:15360
    ds_read_b64_tr_b16 a[238:239], v4 offset:44032
    v_mul_f32 v84, v116, v84
    v_mul_f32 v85, v117, v85
    v_mul_f32 v86, v118, v86
    v_mul_f32 v87, v119, v87
    v_mfma_f32_32x32x16_bf16 v[32:47], a[248:251], v[188:191], v[32:47]
    ds_read_b64_tr_b16 a[240:241], v1 offset:16384
    ds_read_b64_tr_b16 a[242:243], v1 offset:45056
    buffer_load_dwordx4 v242, s[16:19], s57 offen offset:2048 lds
    v_cvt_pk_bf16_f32 v80, v80, v81
    v_mfma_f32_32x32x16_bf16 v[48:63], a[252:255], v[188:191], v[48:63]
    ds_read_b64_tr_b16 a[244:245], v2 offset:16384
    ds_read_b64_tr_b16 a[246:247], v2 offset:45056
    v_cvt_pk_bf16_f32 v81, v82, v83
    v_cvt_pk_bf16_f32 v82, v84, v85
    v_cvt_pk_bf16_f32 v83, v86, v87
    v_mul_f32 v88, v245, v88
    s_waitcnt lgkmcnt(4)
    v_mfma_f32_32x32x16_bf16 v[32:47], a[224:227], v[192:195], v[32:47]
    ds_read_b64_tr_b16 a[248:249], v3 offset:16384
    ds_read_b64_tr_b16 a[250:251], v3 offset:45056
    buffer_store_dwordx4 v[80:83], v7, s[28:31], s72 offen offset:2048 sc1
    v_mul_f32 v89, v245, v89
    v_mul_f32 v90, v245, v90
    v_mfma_f32_32x32x16_bf16 v[48:63], a[228:231], v[192:195], v[48:63]
    ds_read_b64_tr_b16 a[252:253], v4 offset:16384
    ds_read_b64_tr_b16 a[254:255], v4 offset:45056
    v_mul_f32 v91, v245, v91
    v_mul_f32 v92, v245, v92
    v_mul_f32 v93, v245, v93
    v_mul_f32 v94, v245, v94
    v_mul_f32_e64 v95, v245, v95
    v_mfma_f32_32x32x16_bf16 v[32:47], a[232:235], v[196:199], v[32:47]
    ds_read_b64_tr_b16 a[224:225], v1 offset:17408
    ds_read_b64_tr_b16 a[226:227], v1 offset:46080
    buffer_load_dwordx4 v243, s[16:19], s57 offen offset:3072 lds
    v_mul_f32 v88, v120, v88
    v_mul_f32 v89, v121, v89
    v_mfma_f32_32x32x16_bf16 v[48:63], a[236:239], v[196:199], v[48:63]
    ds_read_b64_tr_b16 a[228:229], v2 offset:17408
    ds_read_b64_tr_b16 a[230:231], v2 offset:46080
    s_add_u32 m0, s55, 4096
    s_add_u32 s57, s57, 458752
    v_mul_f32 v90, v122, v90
    s_waitcnt lgkmcnt(4)
    v_mfma_f32_32x32x16_bf16 v[32:47], a[240:243], v[200:203], v[32:47]
    ds_read_b64_tr_b16 a[232:233], v3 offset:17408
    ds_read_b64_tr_b16 a[234:235], v3 offset:46080
    buffer_load_dwordx4 v240, s[16:19], s57 offen offset:0 lds
    v_mul_f32 v91, v123, v91
    v_mul_f32 v92, v124, v92
    v_mfma_f32_32x32x16_bf16 v[48:63], a[244:247], v[200:203], v[48:63]
    ds_read_b64_tr_b16 a[236:237], v4 offset:17408
    ds_read_b64_tr_b16 a[238:239], v4 offset:46080
    ds_read_b64_tr_b16 a[96:97], v5 offset:32768
    ds_read_b64_tr_b16 a[98:99], v5 offset:33792
    ds_read_b64_tr_b16 a[100:101], v6 offset:32768
    v_mul_f32_e64 v93, v125, v93
    v_mfma_f32_32x32x16_bf16 v[32:47], a[248:251], v[204:207], v[32:47]
    ds_read_b64_tr_b16 a[240:241], v1 offset:18432
    ds_read_b64_tr_b16 a[242:243], v1 offset:47104
    buffer_load_dwordx4 v241, s[16:19], s57 offen offset:1024 lds
    ds_read_b64_tr_b16 a[102:103], v6 offset:33792
    v_mul_f32_e64 v94, v126, v94
    v_mfma_f32_32x32x16_bf16 v[48:63], a[252:255], v[204:207], v[48:63]
    ds_read_b64_tr_b16 a[244:245], v2 offset:18432
    ds_read_b64_tr_b16 a[246:247], v2 offset:47104
    ds_read_b64_tr_b16 a[104:105], v5 offset:34816
    ds_read_b64_tr_b16 a[106:107], v5 offset:35840
    ds_read_b64_tr_b16 a[108:109], v6 offset:34816
    v_mul_f32 v95, v127, v95
    s_waitcnt lgkmcnt(11)
    v_mfma_f32_32x32x16_bf16 v[32:47], a[224:227], v[208:211], v[32:47]
    ds_read_b64_tr_b16 a[248:249], v3 offset:18432
    ds_read_b64_tr_b16 a[250:251], v3 offset:47104
    buffer_load_dwordx4 v242, s[16:19], s57 offen offset:2048 lds
    ds_read_b64_tr_b16 a[110:111], v6 offset:35840
    v_cvt_pk_bf16_f32 v88, v88, v89
    v_mfma_f32_32x32x16_bf16 v[48:63], a[228:231], v[208:211], v[48:63]
    ds_read_b64_tr_b16 a[252:253], v4 offset:18432
    ds_read_b64_tr_b16 a[254:255], v4 offset:47104
    v_cvt_pk_bf16_f32 v89, v90, v91
    v_cvt_pk_bf16_f32 v90, v92, v93
    v_cvt_pk_bf16_f32 v91, v94, v95
    v_mfma_f32_32x32x16_bf16 v[32:47], a[232:235], v[212:215], v[32:47]
    ds_read_b64_tr_b16 a[224:225], v1 offset:19456
    ds_read_b64_tr_b16 a[226:227], v1 offset:48128
    buffer_store_dwordx4 v[88:91], v7, s[28:31], s72 offen offset:3072 sc1
    v_mfma_f32_32x32x16_bf16 v[48:63], a[236:239], v[212:215], v[48:63]
    ds_read_b64_tr_b16 a[228:229], v2 offset:19456
    ds_read_b64_tr_b16 a[230:231], v2 offset:48128
    s_add_u32 s76, s40, 2
    s_cmp_ge_u32 s76, 3
    s_cselect_b32 s77, 16384, 0
    s_waitcnt lgkmcnt(4)
    v_mfma_f32_32x32x16_bf16 v[32:47], a[240:243], v[216:219], v[32:47]
    ds_read_b64_tr_b16 a[232:233], v3 offset:19456
    ds_read_b64_tr_b16 a[234:235], v3 offset:48128
    v_readlane_b32 s56, v31, 9
    s_add_u32 m0, s62, 32768
    s_lshl_b32 s76, s76, 12
    v_mfma_f32_32x32x16_bf16 v[48:63], a[244:247], v[216:219], v[48:63]
    ds_read_b64_tr_b16 a[236:237], v4 offset:19456
    ds_read_b64_tr_b16 a[238:239], v4 offset:48128
    buffer_load_dwordx4 v248, s[20:23], s56 offen offset:0 lds
    s_add_u32 s76, s76, s77
    v_mfma_f32_32x32x16_bf16 v[32:47], a[248:251], v[220:223], v[32:47]
    ds_read_b64_tr_b16 a[240:241], v1 offset:20480
    ds_read_b64_tr_b16 a[242:243], v1 offset:49152
    s_waitcnt vmcnt(23)
    ds_read_b64_tr_b16 a[112:113], v5 offset:0
    ds_read_b64_tr_b16 a[114:115], v5 offset:1024
    ds_read_b64_tr_b16 a[116:117], v6 offset:0
    v_mfma_f32_32x32x16_bf16 v[48:63], a[252:255], v[220:223], v[48:63]
    ds_read_b64_tr_b16 a[244:245], v2 offset:20480
    ds_read_b64_tr_b16 a[246:247], v2 offset:49152
    buffer_load_dwordx4 v249, s[20:23], s56 offen offset:1024 lds
    s_waitcnt lgkmcnt(7)
    s_nop 0
    v_mfma_f32_32x32x16_bf16 v[32:47], a[224:227], v[224:227], v[32:47]
    ds_read_b64_tr_b16 a[248:249], v3 offset:20480
    ds_read_b64_tr_b16 a[250:251], v3 offset:49152
    ds_read_b64_tr_b16 a[118:119], v6 offset:1024
    ds_read_b64_tr_b16 a[120:121], v5 offset:2048
    ds_read_b64_tr_b16 a[122:123], v5 offset:3072
    ds_read_b64_tr_b16 a[124:125], v6 offset:2048
    v_mfma_f32_32x32x16_bf16 v[48:63], a[228:231], v[224:227], v[48:63]
    ds_read_b64_tr_b16 a[252:253], v4 offset:20480
    ds_read_b64_tr_b16 a[254:255], v4 offset:49152
    s_waitcnt vmcnt(17)
    s_barrier
    v_mfma_f32_32x32x16_bf16 v[32:47], a[232:235], v[228:231], v[32:47]
    ds_read_b64_tr_b16 a[224:225], v1 offset:21504
    ds_read_b64_tr_b16 a[226:227], v1 offset:50176
    buffer_load_dwordx4 v250, s[20:23], s56 offen offset:2048 lds
    ds_read_b64_tr_b16 a[126:127], v6 offset:3072
    v_mfma_f32_32x32x16_bf16 v[48:63], a[236:239], v[228:231], v[48:63]
    ds_read_b64_tr_b16 a[228:229], v2 offset:21504
    ds_read_b64_tr_b16 a[230:231], v2 offset:50176
    s_add_u32 s76, s76, 7168
    v_add_u32 v18, s76, v252
    s_waitcnt lgkmcnt(5)
    v_mfma_f32_32x32x16_bf16 v[32:47], a[240:243], v[232:235], v[32:47]
    ds_read_b64_tr_b16 a[232:233], v3 offset:21504
    ds_read_b64_tr_b16 a[234:235], v3 offset:50176
    buffer_load_dwordx4 v251, s[20:23], s56 offen offset:3072 lds
    v_add_u32_e64 v21, s76, v7
    v_mfma_f32_32x32x16_bf16 v[48:63], a[244:247], v[232:235], v[48:63]
    ds_read_b64_tr_b16 a[236:237], v4 offset:21504
    ds_read_b64_tr_b16 a[238:239], v4 offset:50176
    v_readlane_b32 s56, v31, 10
    s_waitcnt lgkmcnt(6)
    s_add_u32 m0, s62, 0
    v_lshrrev_b32_e64 v27, 3, v28
    v_mfma_f32_32x32x16_bf16 v[32:47], a[248:251], v[236:239], v[32:47]
    ds_read_b64_tr_b16 a[240:241], v1 offset:22528
    ds_read_b64_tr_b16 a[242:243], v1 offset:51200
    buffer_load_dwordx4 v248, s[20:23], s56 offen offset:0 lds
    v_mul_u32_u24 v27, 896, v27
    v_mfma_f32_32x32x16_bf16 v[48:63], a[252:255], v[236:239], v[48:63]
    ds_read_b64_tr_b16 a[244:245], v2 offset:22528
    ds_read_b64_tr_b16 a[246:247], v2 offset:51200
    v_and_b32_e64 v29, 7, v28
    v_lshl_add_u32 v27, v29, 4, v27
    v_and_b32 v30, 3, v28
    s_waitcnt lgkmcnt(4)
    v_mfma_f32_32x32x16_bf16 v[96:111], a[224:227], v[128:131], 0
    ds_read_b64_tr_b16 a[248:249], v3 offset:22528
    ds_read_b64_tr_b16 a[250:251], v3 offset:51200
    buffer_load_dword v247, v244, s[28:31], 0 offen sc1
    v_lshrrev_b32_e64 v28, 2, v28
    v_mfma_f32_32x32x16_bf16 v[112:127], a[228:231], v[128:131], 0
    ds_read_b64_tr_b16 a[252:253], v4 offset:22528
    ds_read_b64_tr_b16 a[254:255], v4 offset:51200
    buffer_load_dwordx4 v249, s[20:23], s56 offen offset:1024 lds
    v_lshlrev_b32 v28, 12, v28
    v_mfma_f32_32x32x16_bf16 v[96:111], a[232:235], v[132:135], v[96:111]
    ds_read_b64_tr_b16 a[224:225], v1 offset:23552
    ds_read_b64_tr_b16 a[226:227], v1 offset:52224
    s_waitcnt vmcnt(16)
    ds_read_b64_tr_b16 a[128:129], v5 offset:16384
    ds_read_b64_tr_b16 a[130:131], v5 offset:17408
    ds_read_b64_tr_b16 a[132:133], v6 offset:16384
    v_mfma_f32_32x32x16_bf16 v[112:127], a[236:239], v[132:135], v[112:127]
    ds_read_b64_tr_b16 a[228:229], v2 offset:23552
    ds_read_b64_tr_b16 a[230:231], v2 offset:52224
    buffer_load_dwordx4 v250, s[20:23], s56 offen offset:2048 lds
    s_waitcnt lgkmcnt(7)
    s_nop 0
    v_mfma_f32_32x32x16_bf16 v[96:111], a[240:243], v[136:139], v[96:111]
    ds_read_b64_tr_b16 a[232:233], v3 offset:23552
    ds_read_b64_tr_b16 a[234:235], v3 offset:52224
    ds_read_b64_tr_b16 a[134:135], v6 offset:17408
    ds_read_b64_tr_b16 a[136:137], v5 offset:18432
    ds_read_b64_tr_b16 a[138:139], v5 offset:19456
    ds_read_b64_tr_b16 a[140:141], v6 offset:18432
    v_mfma_f32_32x32x16_bf16 v[112:127], a[244:247], v[136:139], v[112:127]
    ds_read_b64_tr_b16 a[236:237], v4 offset:23552
    ds_read_b64_tr_b16 a[238:239], v4 offset:52224
    buffer_load_dwordx4 v251, s[20:23], s56 offen offset:3072 lds
    ds_read_b64_tr_b16 a[142:143], v6 offset:19456
    v_mfma_f32_32x32x16_bf16 v[96:111], a[248:251], v[140:143], v[96:111]
    ds_read_b64_tr_b16 a[240:241], v1 offset:24576
    ds_read_b64_tr_b16 a[242:243], v1 offset:53248
    v_lshl_add_u32 v28, v30, 9, v28
    v_add_u32_e64 v28, s55, v28
    v_add_u32 v28, 9664, v28
    v_and_b32 v29, 0xff, v252
    v_mfma_f32_32x32x16_bf16 v[112:127], a[252:255], v[140:143], v[112:127]
    ds_read_b64_tr_b16 a[244:245], v2 offset:24576
    ds_read_b64_tr_b16 a[246:247], v2 offset:53248
    v_add_u32_e64 v29, s55, v29
    v_add_u32 v30, 114944, v7
    v_lshrrev_b32 v72, 9, v7
    s_waitcnt lgkmcnt(5)
    v_mfma_f32_32x32x16_bf16 v[96:111], a[224:227], v[144:147], v[96:111]
    ds_read_b64_tr_b16 a[248:249], v3 offset:24576
    ds_read_b64_tr_b16 a[250:251], v3 offset:53248
    v_lshlrev_b32_e64 v72, 2, v72
    v_bfe_u32 v73, v7, 4, 5
    v_sub_u32_e64 v72, v73, v72
    v_cmp_le_i32 s[8:9], 0, v72
    v_mfma_f32_32x32x16_bf16 v[112:127], a[228:231], v[144:147], v[112:127]
    ds_read_b64_tr_b16 a[252:253], v4 offset:24576
    ds_read_b64_tr_b16 a[254:255], v4 offset:53248
    v_readlane_b32 s56, v31, 11
    s_waitcnt lgkmcnt(8)
    s_nop 0
    s_add_u32 m0, s62, 16384
    v_cmp_le_i32 s[10:11], 1, v72
    v_mfma_f32_32x32x16_bf16 v[96:111], a[232:235], v[148:151], v[96:111]
    ds_read_b64_tr_b16 a[224:225], v1 offset:25600
    ds_read_b64_tr_b16 a[226:227], v1 offset:54272
    buffer_load_dwordx4 v248, s[20:23], s56 offen offset:0 lds
    v_cmp_le_i32 s[12:13], 2, v72
    v_mfma_f32_32x32x16_bf16 v[112:127], a[236:239], v[148:151], v[112:127]
    ds_read_b64_tr_b16 a[228:229], v2 offset:25600
    ds_read_b64_tr_b16 a[230:231], v2 offset:54272
    v_cmp_le_i32 s[14:15], 3, v72
    v_cmp_le_i32 s[16:17], 8, v72
    v_cmp_le_i32 s[18:19], 9, v72
    s_waitcnt lgkmcnt(4)
    v_mfma_f32_32x32x16_bf16 v[96:111], a[240:243], v[152:155], v[96:111]
    ds_read_b64_tr_b16 a[232:233], v3 offset:25600
    ds_read_b64_tr_b16 a[234:235], v3 offset:54272
    s_waitcnt vmcnt(10)
    buffer_store_dword v255, v0, s[28:31], s74 offen sc1
    v_mfma_f32_32x32x16_bf16 v[112:127], a[244:247], v[152:155], v[112:127]
    ds_read_b64_tr_b16 a[236:237], v4 offset:25600
    ds_read_b64_tr_b16 a[238:239], v4 offset:54272
    buffer_load_dwordx4 v249, s[20:23], s56 offen offset:1024 lds
    v_cmp_le_i32 s[36:37], 10, v72
    v_mfma_f32_32x32x16_bf16 v[96:111], a[248:251], v[156:159], v[96:111]
    ds_read_b64_tr_b16 a[240:241], v1 offset:26624
    ds_read_b64_tr_b16 a[242:243], v1 offset:55296
    v_cmp_le_i32 s[38:39], 11, v72
    v_cmp_le_i32 s[46:47], 16, v72
    v_cmp_le_i32 s[48:49], 17, v72
    v_cmp_le_i32 s[50:51], 18, v72
    v_mfma_f32_32x32x16_bf16 v[112:127], a[252:255], v[156:159], v[112:127]
    ds_read_b64_tr_b16 a[244:245], v2 offset:26624
    ds_read_b64_tr_b16 a[246:247], v2 offset:55296
    buffer_load_dwordx4 v250, s[20:23], s56 offen offset:2048 lds
    s_waitcnt lgkmcnt(4)
    s_nop 0
    v_mfma_f32_32x32x16_bf16 v[96:111], a[224:227], v[160:163], v[96:111]
    ds_read_b64_tr_b16 a[248:249], v3 offset:26624
    ds_read_b64_tr_b16 a[250:251], v3 offset:55296
    v_cmp_le_i32 s[52:53], 19, v72
    v_cmp_le_i32 s[64:65], 24, v72
    v_cmp_le_i32 s[66:67], 25, v72
    v_cmp_le_i32 s[68:69], 26, v72
    v_mfma_f32_32x32x16_bf16 v[112:127], a[228:231], v[160:163], v[112:127]
    ds_read_b64_tr_b16 a[252:253], v4 offset:26624
    ds_read_b64_tr_b16 a[254:255], v4 offset:55296
    buffer_load_dwordx4 v251, s[20:23], s56 offen offset:3072 lds
    v_cmp_le_i32 s[76:77], 27, v72
    v_mfma_f32_32x32x16_bf16 v[96:111], a[232:235], v[164:167], v[96:111]
    ds_read_b64_tr_b16 a[224:225], v1 offset:27648
    ds_read_b64_tr_b16 a[226:227], v1 offset:56320
    v_mov_b32 v240, 0x3f803f80
    v_mov_b32 v241, 0x3f803f80
    v_mov_b32 v242, 0x3f803f80
    v_mov_b32 v243, 0x3f803f80
    v_mfma_f32_32x32x16_bf16 v[112:127], a[236:239], v[164:167], v[112:127]
    ds_read_b64_tr_b16 a[228:229], v2 offset:27648
    ds_read_b64_tr_b16 a[230:231], v2 offset:56320
    v_mov_b32 v74, s86
    v_mov_b32 v75, s87
    v_mov_b32 v76, s88
    s_waitcnt lgkmcnt(4)
    v_mfma_f32_32x32x16_bf16 v[96:111], a[240:243], v[168:171], v[96:111]
    ds_read_b64_tr_b16 a[232:233], v3 offset:27648
    ds_read_b64_tr_b16 a[234:235], v3 offset:56320
    v_mov_b32 v77, 0x3f80
    v_readfirstlane_b32 s100, v255
    v_mfma_f32_32x32x16_bf16 v[112:127], a[244:247], v[168:171], v[112:127]
    ds_read_b64_tr_b16 a[236:237], v4 offset:27648
    ds_read_b64_tr_b16 a[238:239], v4 offset:56320
    s_barrier
    v_mfma_f32_32x32x16_bf16 v[96:111], a[248:251], v[172:175], v[96:111]
    ds_read_b64_tr_b16 a[240:241], v1 offset:0
    ds_read_b64_tr_b16 a[242:243], v1 offset:28672
    s_cmp_lt_u32 s41, 28
    s_cselect_b32 s78, 0x3f, 0
    s_mov_b32 s79, 0
    v_mfma_f32_32x32x16_bf16 v[112:127], a[252:255], v[172:175], v[112:127]
    ds_read_b64_tr_b16 a[244:245], v2 offset:0
    ds_read_b64_tr_b16 a[246:247], v2 offset:28672
    s_waitcnt lgkmcnt(4)
    v_mfma_f32_32x32x16_bf16 v[96:111], a[224:227], v[176:179], v[96:111]
    ds_read_b64_tr_b16 a[248:249], v3 offset:0
    ds_read_b64_tr_b16 a[250:251], v3 offset:28672
    s_waitcnt vmcnt(8)
    v_cmp_ne_u32 vcc, v247, v255
    s_and_b64 vcc, vcc, s[90:91]
    s_cbranch_vccnz Lslow_11
Lback_12:
    v_mfma_f32_32x32x16_bf16 v[112:127], a[228:231], v[176:179], v[112:127]
    ds_read_b64_tr_b16 a[252:253], v4 offset:0
    ds_read_b64_tr_b16 a[254:255], v4 offset:28672
    s_add_u32 m0, s55, 7168
    v_mfma_f32_32x32x16_bf16 v[96:111], a[232:235], v[180:183], v[96:111]
    ds_read_b64_tr_b16 a[224:225], v1 offset:1024
    ds_read_b64_tr_b16 a[226:227], v1 offset:29696
    buffer_load_dwordx4 v7, s[28:31], s80 offen sc1 lds
    v_mfma_f32_32x32x16_bf16 v[112:127], a[236:239], v[180:183], v[112:127]
    ds_read_b64_tr_b16 a[228:229], v2 offset:1024
    ds_read_b64_tr_b16 a[230:231], v2 offset:29696
    buffer_load_dwordx4 v22, s[28:31], s80 offen offset:1024 sc1 lds
    s_waitcnt lgkmcnt(4)
    s_nop 0
    v_mfma_f32_32x32x16_bf16 v[96:111], a[240:243], v[184:187], v[96:111]
    ds_read_b64_tr_b16 a[232:233], v3 offset:1024
    ds_read_b64_tr_b16 a[234:235], v3 offset:29696
    s_add_u32 m0, s55, 11264
    v_mfma_f32_32x32x16_bf16 v[112:127], a[244:247], v[184:187], v[112:127]
    ds_read_b64_tr_b16 a[236:237], v4 offset:1024
    ds_read_b64_tr_b16 a[238:239], v4 offset:29696
    buffer_load_dwordx4 v7, s[28:31], s82 offen sc1 lds
    v_mfma_f32_32x32x16_bf16 v[96:111], a[248:251], v[188:191], v[96:111]
    ds_read_b64_tr_b16 a[240:241], v1 offset:2048
    ds_read_b64_tr_b16 a[242:243], v1 offset:30720
    ds_read_b64_tr_b16 a[144:145], v5 offset:32768
    ds_read_b64_tr_b16 a[146:147], v5 offset:33792
    ds_read_b64_tr_b16 a[148:149], v6 offset:32768
    v_mfma_f32_32x32x16_bf16 v[112:127], a[252:255], v[188:191], v[112:127]
    ds_read_b64_tr_b16 a[244:245], v2 offset:2048
    ds_read_b64_tr_b16 a[246:247], v2 offset:30720
    buffer_load_dwordx4 v22, s[28:31], s82 offen offset:1024 sc1 lds
    s_waitcnt lgkmcnt(7)
    s_nop 0
    v_mfma_f32_32x32x16_bf16 v[96:111], a[224:227], v[192:195], v[96:111]
    ds_read_b64_tr_b16 a[248:249], v3 offset:2048
    ds_read_b64_tr_b16 a[250:251], v3 offset:30720
    s_add_u32 m0, s55, 15360
    ds_read_b64_tr_b16 a[150:151], v6 offset:33792
    ds_read_b64_tr_b16 a[152:153], v5 offset:34816
    v_mfma_f32_32x32x16_bf16 v[112:127], a[228:231], v[192:195], v[112:127]
    ds_read_b64_tr_b16 a[252:253], v4 offset:2048
    ds_read_b64_tr_b16 a[254:255], v4 offset:30720
    buffer_load_dwordx4 v7, s[28:31], s84 offen sc1 lds
    ds_read_b64_tr_b16 a[154:155], v5 offset:35840
    v_mfma_f32_32x32x16_bf16 v[96:111], a[232:235], v[196:199], v[96:111]
    ds_read_b64_tr_b16 a[224:225], v1 offset:3072
    ds_read_b64_tr_b16 a[226:227], v1 offset:31744
    ds_read_b64_tr_b16 a[156:157], v6 offset:34816
    ds_read_b64_tr_b16 a[158:159], v6 offset:35840
    v_mfma_f32_32x32x16_bf16 v[112:127], a[236:239], v[196:199], v[112:127]
    ds_read_b64_tr_b16 a[228:229], v2 offset:3072
    ds_read_b64_tr_b16 a[230:231], v2 offset:31744
    buffer_load_dwordx4 v22, s[28:31], s84 offen offset:1024 sc1 lds
    s_waitcnt lgkmcnt(7)
    s_nop 0
    v_mfma_f32_32x32x16_bf16 v[96:111], a[240:243], v[200:203], v[96:111]
    ds_read_b64_tr_b16 a[232:233], v3 offset:3072
    ds_read_b64_tr_b16 a[234:235], v3 offset:31744
    buffer_load_dwordx2 v[64:65], v252, s[28:31], s96 offen offset:0 sc1
    v_mfma_f32_32x32x16_bf16 v[112:127], a[244:247], v[200:203], v[112:127]
    ds_read_b64_tr_b16 a[236:237], v4 offset:3072
    ds_read_b64_tr_b16 a[238:239], v4 offset:31744
    buffer_load_dwordx2 v[66:67], v252, s[28:31], s96 offen offset:512 sc1
    v_mfma_f32_32x32x16_bf16 v[96:111], a[248:251], v[204:207], v[96:111]
    ds_read_b64_tr_b16 a[240:241], v1 offset:4096
    ds_read_b64_tr_b16 a[242:243], v1 offset:32768
    buffer_load_dwordx2 v[68:69], v252, s[28:31], s96 offen offset:1024 sc1
    v_mfma_f32_32x32x16_bf16 v[112:127], a[252:255], v[204:207], v[112:127]
    ds_read_b64_tr_b16 a[244:245], v2 offset:4096
    ds_read_b64_tr_b16 a[246:247], v2 offset:32768
    buffer_load_dwordx2 v[70:71], v25, s[28:31], s96 offen offset:1536 sc1
    s_add_u32 m0, s55, 9216
    s_waitcnt lgkmcnt(4)
    v_mfma_f32_32x32x16_bf16 v[96:111], a[224:227], v[208:211], v[96:111]
    ds_read_b64_tr_b16 a[248:249], v3 offset:4096
    ds_read_b64_tr_b16 a[250:251], v3 offset:32768
    buffer_load_dwordx4 v23, s[28:31], s81 offen sc1 lds
    s_waitcnt vmcnt(16)
    v_mfma_f32_32x32x16_bf16 v[112:127], a[228:231], v[208:211], v[112:127]
    ds_read_b64_tr_b16 a[252:253], v4 offset:4096
    ds_read_b64_tr_b16 a[254:255], v4 offset:32768
    ds_read_b64_tr_b16 a[160:161], v5 offset:0
    ds_read_b64_tr_b16 a[162:163], v5 offset:1024
    ds_read_b64_tr_b16 a[164:165], v6 offset:0
    ds_read_b64_tr_b16 a[166:167], v6 offset:1024
    v_mfma_f32_32x32x16_bf16 v[96:111], a[232:235], v[212:215], v[96:111]
    ds_read_b64_tr_b16 a[224:225], v1 offset:5120
    ds_read_b64_tr_b16 a[226:227], v1 offset:33792
    buffer_load_dwordx4 v24, s[28:31], s81 offen offset:1024 sc1 lds
    ds_read_b64_tr_b16 a[168:169], v5 offset:2048
    v_mfma_f32_32x32x16_bf16 v[112:127], a[236:239], v[212:215], v[112:127]
    ds_read_b64_tr_b16 a[228:229], v2 offset:5120
    ds_read_b64_tr_b16 a[230:231], v2 offset:33792
    s_add_u32 m0, s55, 13312
    ds_read_b64_tr_b16 a[170:171], v5 offset:3072
    s_waitcnt lgkmcnt(10)
    s_nop 0
    v_mfma_f32_32x32x16_bf16 v[96:111], a[240:243], v[216:219], v[96:111]
    ds_read_b64_tr_b16 a[232:233], v3 offset:5120
    ds_read_b64_tr_b16 a[234:235], v3 offset:33792
    buffer_load_dwordx4 v23, s[28:31], s83 offen sc1 lds
    ds_read_b64_tr_b16 a[172:173], v6 offset:2048
    v_mfma_f32_32x32x16_bf16 v[112:127], a[244:247], v[216:219], v[112:127]
    ds_read_b64_tr_b16 a[236:237], v4 offset:5120
    ds_read_b64_tr_b16 a[238:239], v4 offset:33792
    buffer_load_dwordx4 v24, s[28:31], s83 offen offset:1024 sc1 lds
    ds_read_b64_tr_b16 a[174:175], v6 offset:3072
    v_mfma_f32_32x32x16_bf16 v[96:111], a[248:251], v[220:223], v[96:111]
    ds_read_b64_tr_b16 a[240:241], v1 offset:6144
    ds_read_b64_tr_b16 a[242:243], v1 offset:34816
    s_add_u32 m0, s55, 17408
    v_mfma_f32_32x32x16_bf16 v[112:127], a[252:255], v[220:223], v[112:127]
    ds_read_b64_tr_b16 a[244:245], v2 offset:6144
    ds_read_b64_tr_b16 a[246:247], v2 offset:34816
    buffer_load_dwordx4 v23, s[28:31], s85 offen sc1 lds
    s_waitcnt lgkmcnt(5)
    v_mfma_f32_32x32x16_bf16 v[96:111], a[224:227], v[224:227], v[96:111]
    ds_read_b64_tr_b16 a[248:249], v3 offset:6144
    ds_read_b64_tr_b16 a[250:251], v3 offset:34816
    buffer_load_dwordx4 v24, s[28:31], s85 offen offset:1024 sc1 lds
    s_waitcnt vmcnt(16)
    v_mfma_f32_32x32x16_bf16 v[112:127], a[228:231], v[224:227], v[112:127]
    ds_read_b64_tr_b16 a[252:253], v4 offset:6144
    ds_read_b64_tr_b16 a[254:255], v4 offset:34816
    ds_read_b64_tr_b16 a[176:177], v5 offset:16384
    ds_read_b64_tr_b16 a[178:179], v5 offset:17408
    ds_read_b64_tr_b16 a[180:181], v6 offset:16384
    ds_read_b64_tr_b16 a[182:183], v6 offset:17408
    v_mfma_f32_32x32x16_bf16 v[96:111], a[232:235], v[228:231], v[96:111]
    ds_read_b64_tr_b16 a[184:185], v5 offset:18432
    ds_read_b64_tr_b16 a[186:187], v5 offset:19456
    ds_read_b64_tr_b16 a[188:189], v6 offset:18432
    ds_read_b64_tr_b16 a[190:191], v6 offset:19456
    v_mfma_f32_32x32x16_bf16 v[112:127], a[236:239], v[228:231], v[112:127]
    s_waitcnt lgkmcnt(8)
    v_mfma_f32_32x32x16_bf16 v[96:111], a[240:243], v[232:235], v[96:111]
    v_mfma_f32_32x32x16_bf16 v[112:127], a[244:247], v[232:235], v[112:127]
    v_mfma_f32_32x32x16_bf16 v[96:111], a[248:251], v[236:239], v[96:111]
    v_mfma_f32_32x32x16_bf16 v[112:127], a[252:255], v[236:239], v[112:127]
    s_branch L_att
P_C1:
    s_nop 0
    s_waitcnt lgkmcnt(6)
    v_mfma_f32_32x32x16_bf16 v[32:47], v[8:11], v[128:131], v[48:63]
    ds_read_b128 v[160:163], v20 offset:8192
    ds_read_b128 v[164:167], v21 offset:8192
    ds_read_b128 v[168:171], v22 offset:8192
    ds_read_b128 v[172:175], v23 offset:8192
    v_max_f32 v80, 0, v80
    v_cvt_pk_bf16_f32 v80, v80, v80
    v_mfma_f32_32x32x16_bf16 v[32:47], v[12:15], v[132:135], v[32:47]
    s_waitcnt lgkmcnt(8)
    v_mfma_f32_32x32x16_bf16 v[64:79], v[8:11], v[136:139], v[48:63]
    ds_read_b128 v[176:179], v20 offset:12288
    ds_read_b128 v[180:183], v21 offset:12288
    ds_read_b128 v[184:187], v26 offset:12288
    ds_read_b128 v[188:191], v27 offset:12288
    v_lshlrev_b32_e64 v80, 16, v80
    v_add_f32 v80, 925353388, v80
    v_mfma_f32_32x32x16_bf16 v[64:79], v[12:15], v[140:143], v[64:79]
    v_cvt_pk_bf16_f32 v80, v80, v80
    v_lshlrev_b32 v80, 16, v80
    v_sqrt_f32 v80, v80
    v_cvt_pk_bf16_f32 v128, v32, v33
    v_cvt_pk_bf16_f32 v129, v34, v35
    v_cvt_pk_bf16_f32 v130, v36, v37
    v_cvt_pk_bf16_f32 v131, v38, v39
    v_cvt_pk_bf16_f32 v132, v40, v41
    v_cvt_pk_bf16_f32 v133, v42, v43
    v_cvt_pk_bf16_f32 v134, v44, v45
    v_cvt_pk_bf16_f32 v135, v46, v47
    s_waitcnt lgkmcnt(10)
    v_mfma_f32_32x32x16_bf16 v[32:47], v[8:11], v[144:147], v[48:63]
    ds_read_b128 v[192:195], v24 offset:16384
    ds_read_b128 v[196:199], v25 offset:16384
    ds_read_b128 v[200:203], v26 offset:16384
    ds_read_b128 v[204:207], v27 offset:16384
    s_lshl_b32 s58, s40, 7
    v_cvt_pk_bf16_f32 v80, v80, v80
    v_mfma_f32_32x32x16_bf16 v[32:47], v[12:15], v[148:151], v[32:47]
    v_cvt_pk_bf16_f32 v136, v64, v65
    v_cvt_pk_bf16_f32 v137, v66, v67
    v_cvt_pk_bf16_f32 v138, v68, v69
    v_cvt_pk_bf16_f32 v139, v70, v71
    v_cvt_pk_bf16_f32 v140, v72, v73
    v_cvt_pk_bf16_f32 v141, v74, v75
    v_cvt_pk_bf16_f32 v142, v76, v77
    v_cvt_pk_bf16_f32 v143, v78, v79
    s_waitcnt lgkmcnt(12)
    s_nop 0
    v_mfma_f32_32x32x16_bf16 v[64:79], v[8:11], v[152:155], v[48:63]
    ds_read_b128 v[208:211], v24 offset:20480
    ds_read_b128 v[212:215], v25 offset:20480
    ds_read_b128 v[216:219], v26 offset:20480
    ds_read_b128 v[220:223], v27 offset:20480
    v_lshlrev_b32 v80, 16, v80
    v_rcp_f32 v253, v80
    v_mfma_f32_32x32x16_bf16 v[64:79], v[12:15], v[156:159], v[64:79]
    v_cvt_pk_bf16_f32 v144, v32, v33
    v_cvt_pk_bf16_f32 v145, v34, v35
    v_cvt_pk_bf16_f32 v146, v36, v37
    v_cvt_pk_bf16_f32 v147, v38, v39
    v_cvt_pk_bf16_f32 v148, v40, v41
    v_cvt_pk_bf16_f32 v149, v42, v43
    v_cvt_pk_bf16_f32 v150, v44, v45
    v_cvt_pk_bf16_f32 v151, v46, v47
    s_waitcnt lgkmcnt(14)
    s_nop 0
    v_mfma_f32_32x32x16_bf16 v[32:47], v[8:11], v[160:163], v[48:63]
    ds_read_b128 v[224:227], v24 offset:24576
    ds_read_b128 v[228:231], v25 offset:24576
    ds_read_b128 v[232:235], v26 offset:24576
    ds_read_b128 v[236:239], v27 offset:24576
    s_add_u32 s58, s58, 143360
    v_mul_f32_e64 v245, v253, v253
    v_mfma_f32_32x32x16_bf16 v[32:47], v[12:15], v[164:167], v[32:47]
    v_cvt_pk_bf16_f32 v152, v64, v65
    v_cvt_pk_bf16_f32 v153, v66, v67
    v_cvt_pk_bf16_f32 v154, v68, v69
    v_cvt_pk_bf16_f32 v155, v70, v71
    v_cvt_pk_bf16_f32 v156, v72, v73
    v_cvt_pk_bf16_f32 v157, v74, v75
    v_cvt_pk_bf16_f32 v158, v76, v77
    v_cvt_pk_bf16_f32 v159, v78, v79
    s_waitcnt lgkmcnt(15)
    v_mfma_f32_32x32x16_bf16 v[64:79], v[8:11], v[168:171], v[48:63]
    v_mfma_f32_32x32x16_bf16 v[64:79], v[12:15], v[172:175], v[64:79]
    s_nop 0
    v_cvt_pk_bf16_f32 v160, v32, v33
    v_cvt_pk_bf16_f32 v161, v34, v35
    v_cvt_pk_bf16_f32 v162, v36, v37
    v_cvt_pk_bf16_f32 v163, v38, v39
    v_cvt_pk_bf16_f32 v164, v40, v41
    v_cvt_pk_bf16_f32 v165, v42, v43
    v_cvt_pk_bf16_f32 v166, v44, v45
    v_cvt_pk_bf16_f32 v167, v46, v47
    s_waitcnt lgkmcnt(14)
    v_mfma_f32_32x32x16_bf16 v[32:47], v[8:11], v[176:179], v[48:63]
    s_waitcnt lgkmcnt(0)
    s_add_u32 m0, s55, 0
    s_add_u32 s57, s46, s52
    buffer_load_dwordx4 v116, s[8:11], s57 offen offset:0 lds
    buffer_load_dwordx4 v117, s[8:11], s57 offen offset:1024 lds
    v_mfma_f32_32x32x16_bf16 v[32:47], v[12:15], v[180:183], v[32:47]
    v_cvt_pk_bf16_f32 v168, v64, v65
    v_cvt_pk_bf16_f32 v169, v66, v67
    v_cvt_pk_bf16_f32 v170, v68, v69
    v_cvt_pk_bf16_f32 v171, v70, v71
    v_cvt_pk_bf16_f32 v172, v72, v73
    v_cvt_pk_bf16_f32 v173, v74, v75
    v_cvt_pk_bf16_f32 v174, v76, v77
    v_cvt_pk_bf16_f32 v175, v78, v79
    v_mfma_f32_32x32x16_bf16 v[64:79], v[8:11], v[184:187], v[48:63]
    buffer_load_dwordx4 v118, s[8:11], s57 offen offset:2048 lds
    buffer_load_dwordx4 v119, s[8:11], s57 offen offset:3072 lds
    v_mfma_f32_32x32x16_bf16 v[64:79], v[12:15], v[188:191], v[64:79]
    v_cvt_pk_bf16_f32 v176, v32, v33
    v_cvt_pk_bf16_f32 v177, v34, v35
    v_cvt_pk_bf16_f32 v178, v36, v37
    v_cvt_pk_bf16_f32 v179, v38, v39
    v_cvt_pk_bf16_f32 v180, v40, v41
    v_cvt_pk_bf16_f32 v181, v42, v43
    v_cvt_pk_bf16_f32 v182, v44, v45
    v_cvt_pk_bf16_f32 v183, v46, v47
    v_mfma_f32_32x32x16_bf16 v[32:47], v[8:11], v[192:195], v[48:63]
    s_add_u32 m0, s55, 4096
    s_add_u32 s57, s57, 344064
    buffer_load_dwordx4 v116, s[8:11], s57 offen offset:0 lds
    buffer_load_dwordx4 v117, s[8:11], s57 offen offset:1024 lds
    v_mfma_f32_32x32x16_bf16 v[32:47], v[12:15], v[196:199], v[32:47]
    v_cvt_pk_bf16_f32 v184, v64, v65
    v_cvt_pk_bf16_f32 v185, v66, v67
    v_cvt_pk_bf16_f32 v186, v68, v69
    v_cvt_pk_bf16_f32 v187, v70, v71
    v_cvt_pk_bf16_f32 v188, v72, v73
    v_cvt_pk_bf16_f32 v189, v74, v75
    v_cvt_pk_bf16_f32 v190, v76, v77
    v_cvt_pk_bf16_f32 v191, v78, v79
    v_mfma_f32_32x32x16_bf16 v[64:79], v[8:11], v[200:203], v[48:63]
    buffer_load_dwordx4 v118, s[8:11], s57 offen offset:2048 lds
    s_add_u32 m0, s55, 7168
    s_add_u32 s57, s47, s51
    s_nop 0
    buffer_load_dwordx4 v116, s[8:11], s57 offen offset:0 lds
    v_mfma_f32_32x32x16_bf16 v[64:79], v[12:15], v[204:207], v[64:79]
    v_cvt_pk_bf16_f32 v192, v32, v33
    v_cvt_pk_bf16_f32 v193, v34, v35
    v_cvt_pk_bf16_f32 v194, v36, v37
    v_cvt_pk_bf16_f32 v195, v38, v39
    v_cvt_pk_bf16_f32 v196, v40, v41
    v_cvt_pk_bf16_f32 v197, v42, v43
    v_cvt_pk_bf16_f32 v198, v44, v45
    v_cvt_pk_bf16_f32 v199, v46, v47
    v_mfma_f32_32x32x16_bf16 v[32:47], v[8:11], v[208:211], v[48:63]
    buffer_load_dwordx4 v117, s[8:11], s57 offen offset:1024 lds
    buffer_load_dwordx4 v118, s[8:11], s57 offen offset:2048 lds
    v_mfma_f32_32x32x16_bf16 v[32:47], v[12:15], v[212:215], v[32:47]
    v_cvt_pk_bf16_f32 v200, v64, v65
    v_cvt_pk_bf16_f32 v201, v66, v67
    v_cvt_pk_bf16_f32 v202, v68, v69
    v_cvt_pk_bf16_f32 v203, v70, v71
    v_cvt_pk_bf16_f32 v204, v72, v73
    v_cvt_pk_bf16_f32 v205, v74, v75
    v_cvt_pk_bf16_f32 v206, v76, v77
    v_cvt_pk_bf16_f32 v207, v78, v79
    v_mfma_f32_32x32x16_bf16 v[64:79], v[8:11], v[216:219], v[48:63]
    buffer_load_dwordx4 v119, s[8:11], s57 offen offset:3072 lds
    v_mfma_f32_32x32x16_bf16 v[64:79], v[12:15], v[220:223], v[64:79]
    s_nop 0
    s_nop 0
    v_cvt_pk_bf16_f32 v208, v32, v33
    v_cvt_pk_bf16_f32 v209, v34, v35
    v_cvt_pk_bf16_f32 v210, v36, v37
    v_cvt_pk_bf16_f32 v211, v38, v39
    v_cvt_pk_bf16_f32 v212, v40, v41
    v_cvt_pk_bf16_f32 v213, v42, v43
    v_cvt_pk_bf16_f32 v214, v44, v45
    v_cvt_pk_bf16_f32 v215, v46, v47
    v_mfma_f32_32x32x16_bf16 v[32:47], v[8:11], v[224:227], v[48:63]
    s_add_u32 m0, s55, 11264
    s_add_u32 s57, s57, 344064
    buffer_load_dwordx4 v116, s[8:11], s57 offen offset:0 lds
    v_mfma_f32_32x32x16_bf16 v[32:47], v[12:15], v[228:231], v[32:47]
    v_cvt_pk_bf16_f32 v216, v64, v65
    v_cvt_pk_bf16_f32 v217, v66, v67
    v_cvt_pk_bf16_f32 v218, v68, v69
    v_cvt_pk_bf16_f32 v219, v70, v71
    v_cvt_pk_bf16_f32 v220, v72, v73
    v_cvt_pk_bf16_f32 v221, v74, v75
    v_cvt_pk_bf16_f32 v222, v76, v77
    v_cvt_pk_bf16_f32 v223, v78, v79
    v_mfma_f32_32x32x16_bf16 v[64:79], v[8:11], v[232:235], v[48:63]
    buffer_load_dwordx4 v117, s[8:11], s57 offen offset:1024 lds
    v_mfma_f32_32x32x16_bf16 v[64:79], v[12:15], v[236:239], v[64:79]
    s_nop 0
    s_nop 0
    v_cvt_pk_bf16_f32 v224, v32, v33
    v_cvt_pk_bf16_f32 v225, v34, v35
    v_cvt_pk_bf16_f32 v226, v36, v37
    v_cvt_pk_bf16_f32 v227, v38, v39
    v_cvt_pk_bf16_f32 v228, v40, v41
    v_cvt_pk_bf16_f32 v229, v42, v43
    v_cvt_pk_bf16_f32 v230, v44, v45
    v_cvt_pk_bf16_f32 v231, v46, v47
    buffer_load_dwordx4 v118, s[8:11], s57 offen offset:2048 lds
    buffer_load_dword v255, off, s[36:39], 0 sc1
    s_nop 0
    v_cvt_pk_bf16_f32 v232, v64, v65
    v_cvt_pk_bf16_f32 v233, v66, v67
    v_cvt_pk_bf16_f32 v234, v68, v69
    v_cvt_pk_bf16_f32 v235, v70, v71
    v_cvt_pk_bf16_f32 v236, v72, v73
    v_cvt_pk_bf16_f32 v237, v74, v75
    v_cvt_pk_bf16_f32 v238, v76, v77
    v_cvt_pk_bf16_f32 v239, v78, v79
    s_waitcnt vmcnt(16)
    s_waitcnt lgkmcnt(0)
    s_barrier
    ds_read_b64_tr_b16 a[224:225], v96 offset:0
    ds_read_b64_tr_b16 a[226:227], v96 offset:1024
    ds_read_b64_tr_b16 a[228:229], v97 offset:0
    ds_read_b64_tr_b16 a[230:231], v97 offset:1024
    ds_read_b64_tr_b16 a[232:233], v96 offset:2048
    ds_read_b64_tr_b16 a[234:235], v96 offset:3072
    ds_read_b64_tr_b16 a[236:237], v97 offset:2048
    ds_read_b64_tr_b16 a[238:239], v97 offset:3072
    ds_read_b64_tr_b16 a[240:241], v96 offset:4096
    ds_read_b64_tr_b16 a[242:243], v96 offset:5120
    ds_read_b64_tr_b16 a[244:245], v97 offset:4096
    ds_read_b64_tr_b16 a[246:247], v97 offset:5120
    s_waitcnt lgkmcnt(4)
    v_mfma_f32_32x32x16_bf16 v[64:79], a[224:227], v[128:131], 0
    ds_read_b64_tr_b16 a[248:249], v96 offset:6144
    ds_read_b64_tr_b16 a[250:251], v96 offset:7168
    s_lshl_b32 s79, s42, 2
    s_and_b32 s76, s41, 3
    s_add_u32 s79, s79, s76
    v_mfma_f32_32x32x16_bf16 v[80:95], a[228:231], v[128:131], 0
    ds_read_b64_tr_b16 a[252:253], v97 offset:6144
    ds_read_b64_tr_b16 a[254:255], v97 offset:7168
    s_lshl_b32 s79, s79, 1
    s_mul_i32 s95, s79, 33024
    s_lshl_b32 s76, s40, 13
    v_mfma_f32_32x32x16_bf16 v[64:79], a[232:235], v[132:135], v[64:79]
    ds_read_b64_tr_b16 a[224:225], v96 offset:8192
    ds_read_b64_tr_b16 a[226:227], v96 offset:9216
    s_add_u32 s95, s95, s76
    s_add_u32 s95, s95, 5701632
    s_lshl_b32 s76, s79, 1
    v_mfma_f32_32x32x16_bf16 v[80:95], a[236:239], v[132:135], v[80:95]
    ds_read_b64_tr_b16 a[228:229], v97 offset:8192
    ds_read_b64_tr_b16 a[230:231], v97 offset:9216
    s_add_u32 s76, s76, s40
    s_mul_i32 s44, s76, 14336
    s_waitcnt lgkmcnt(4)
    v_mfma_f32_32x32x16_bf16 v[64:79], a[240:243], v[136:139], v[64:79]
    ds_read_b64_tr_b16 a[232:233], v96 offset:10240
    ds_read_b64_tr_b16 a[234:235], v96 offset:11264
    s_lshr_b32 s58, s41, 2
    s_lshl_b32 s58, s58, 7
    s_add_u32 s44, s44, s58
    v_mfma_f32_32x32x16_bf16 v[80:95], a[244:247], v[136:139], v[80:95]
    ds_read_b64_tr_b16 a[236:237], v97 offset:10240
    ds_read_b64_tr_b16 a[238:239], v97 offset:11264
    s_lshl_b32 s45, s79, 9
    s_lshl_b32 s76, s40, 4
    s_add_u32 s45, s45, s76
    v_mfma_f32_32x32x16_bf16 v[64:79], a[248:251], v[140:143], v[64:79]
    ds_read_b64_tr_b16 a[240:241], v96 offset:12288
    ds_read_b64_tr_b16 a[242:243], v96 offset:13312
    global_load_dword v99, v120, s[60:61]
    s_add_u32 s45, s45, 15401216
    v_mfma_f32_32x32x16_bf16 v[80:95], a[252:255], v[140:143], v[80:95]
    ds_read_b64_tr_b16 a[244:245], v97 offset:12288
    ds_read_b64_tr_b16 a[246:247], v97 offset:13312
    v_lshrrev_b32 v29, 4, v7
    v_mov_b32 v30, 2146435072
    s_waitcnt lgkmcnt(4)
    v_mfma_f32_32x32x16_bf16 v[64:79], a[224:227], v[144:147], v[64:79]
    ds_read_b64_tr_b16 a[248:249], v96 offset:14336
    ds_read_b64_tr_b16 a[250:251], v96 offset:15360
    s_add_u32 m0, s55, 14336
    s_add_u32 s57, s47, s52
    s_lshr_b32 s100, s41, 4
    v_mfma_f32_32x32x16_bf16 v[80:95], a[228:231], v[144:147], v[80:95]
    ds_read_b64_tr_b16 a[252:253], v97 offset:14336
    ds_read_b64_tr_b16 a[254:255], v97 offset:15360
    buffer_load_dwordx4 v116, s[8:11], s57 offen offset:0 lds
    s_lshl_b32 s86, s42, 1
    v_mfma_f32_32x32x16_bf16 v[64:79], a[232:235], v[148:151], v[64:79]
    ds_read_b64_tr_b16 a[224:225], v96 offset:16384
    ds_read_b64_tr_b16 a[226:227], v96 offset:17408
    s_add_u32 s86, s86, s100
    s_and_b32 s100, s41, 15
    s_lshl_b32 s100, s100, 2
    v_mfma_f32_32x32x16_bf16 v[80:95], a[236:239], v[148:151], v[80:95]
    ds_read_b64_tr_b16 a[228:229], v97 offset:16384
    ds_read_b64_tr_b16 a[230:231], v97 offset:17408
    s_add_u32 s87, s100, s40
    s_mul_i32 s88, s40, 3
    s_waitcnt lgkmcnt(4)
    v_mfma_f32_32x32x16_bf16 v[64:79], a[240:243], v[152:155], v[64:79]
    ds_read_b64_tr_b16 a[232:233], v96 offset:18432
    ds_read_b64_tr_b16 a[234:235], v96 offset:19456
    buffer_load_dwordx4 v117, s[8:11], s57 offen offset:1024 lds
    s_add_u32 s88, s88, s100
    v_mfma_f32_32x32x16_bf16 v[80:95], a[244:247], v[152:155], v[80:95]
    ds_read_b64_tr_b16 a[236:237], v97 offset:18432
    ds_read_b64_tr_b16 a[238:239], v97 offset:19456
    s_sub_u32 s88, s88, 8
    s_mul_i32 s100, s87, 28928
    s_mul_i32 s101, s86, 1792
    v_mfma_f32_32x32x16_bf16 v[64:79], a[248:251], v[156:159], v[64:79]
    ds_read_b64_tr_b16 a[240:241], v96 offset:20480
    ds_read_b64_tr_b16 a[242:243], v96 offset:21504
    buffer_load_dwordx4 v118, s[8:11], s57 offen offset:2048 lds
    s_add_u32 s96, s100, s101
    v_mfma_f32_32x32x16_bf16 v[80:95], a[252:255], v[156:159], v[80:95]
    ds_read_b64_tr_b16 a[244:245], v97 offset:20480
    ds_read_b64_tr_b16 a[246:247], v97 offset:21504
    s_mul_i32 s100, s87, 33024
    s_lshl_b32 s101, s86, 11
    s_waitcnt lgkmcnt(4)
    v_mfma_f32_32x32x16_bf16 v[64:79], a[224:227], v[160:163], v[64:79]
    ds_read_b64_tr_b16 a[248:249], v96 offset:22528
    ds_read_b64_tr_b16 a[250:251], v96 offset:23552
    buffer_load_dwordx4 v119, s[8:11], s57 offen offset:3072 lds
    s_add_u32 s100, s100, s101
    s_nop 0
    v_mfma_f32_32x32x16_bf16 v[80:95], a[228:231], v[160:163], v[80:95]
    ds_read_b64_tr_b16 a[252:253], v97 offset:22528
    ds_read_b64_tr_b16 a[254:255], v97 offset:23552
    s_add_u32 m0, s55, 18432
    s_add_u32 s57, s57, 344064
    s_add_u32 s43, s100, 5701632
    v_mfma_f32_32x32x16_bf16 v[64:79], a[232:235], v[164:167], v[64:79]
    ds_read_b64_tr_b16 a[224:225], v96 offset:24576
    ds_read_b64_tr_b16 a[226:227], v96 offset:25600
    buffer_load_dwordx4 v116, s[8:11], s57 offen offset:0 lds
    s_lshl_b32 s100, s87, 9
    v_mfma_f32_32x32x16_bf16 v[80:95], a[236:239], v[164:167], v[80:95]
    ds_read_b64_tr_b16 a[228:229], v97 offset:24576
    ds_read_b64_tr_b16 a[230:231], v97 offset:25600
    s_lshl_b32 s101, s86, 2
    s_add_u32 s100, s100, s101
    s_waitcnt lgkmcnt(4)
    v_mfma_f32_32x32x16_bf16 v[64:79], a[240:243], v[168:171], v[64:79]
    ds_read_b64_tr_b16 a[232:233], v96 offset:26624
    ds_read_b64_tr_b16 a[234:235], v96 offset:27648
    buffer_load_dwordx4 v117, s[8:11], s57 offen offset:1024 lds
    s_add_u32 s3, s100, 15401216
    v_mfma_f32_32x32x16_bf16 v[80:95], a[244:247], v[168:171], v[80:95]
    ds_read_b64_tr_b16 a[236:237], v97 offset:26624
    ds_read_b64_tr_b16 a[238:239], v97 offset:27648
    s_waitcnt vmcnt(15) lgkmcnt(0)
    s_barrier
    v_mfma_f32_32x32x16_bf16 v[64:79], a[248:251], v[172:175], v[64:79]
    ds_read_b64_tr_b16 a[240:241], v1 offset:0
    ds_read_b64_tr_b16 a[242:243], v1 offset:28672
    buffer_load_dwordx4 v118, s[8:11], s57 offen offset:2048 lds
    s_mul_i32 s100, s86, 28
    v_mfma_f32_32x32x16_bf16 v[80:95], a[252:255], v[172:175], v[80:95]
    ds_read_b64_tr_b16 a[244:245], v2 offset:0
    ds_read_b64_tr_b16 a[246:247], v2 offset:28672
    s_add_u32 m0, s55, 21504
    s_add_u32 s57, s48, s51
    v_mfma_f32_32x32x16_bf16 v[64:79], a[224:227], v[176:179], v[64:79]
    ds_read_b64_tr_b16 a[248:249], v3 offset:0
    ds_read_b64_tr_b16 a[250:251], v3 offset:28672
    buffer_load_dwordx4 v116, s[8:11], s57 offen offset:0 lds
    s_add_u32 s101, s100, 27
    v_mfma_f32_32x32x16_bf16 v[80:95], a[228:231], v[176:179], v[80:95]
    ds_read_b64_tr_b16 a[252:253], v4 offset:0
    ds_read_b64_tr_b16 a[254:255], v4 offset:28672
    s_lshr_b32 s100, s100, 6
    s_lshr_b32 s101, s101, 6
    v_lshrrev_b32 v24, 2, v29
    v_mfma_f32_32x32x16_bf16 v[64:79], a[232:235], v[180:183], v[64:79]
    ds_read_b64_tr_b16 a[224:225], v1 offset:1024
    ds_read_b64_tr_b16 a[226:227], v1 offset:29696
    buffer_load_dwordx4 v117, s[8:11], s57 offen offset:1024 lds
    v_add_u32_e64 v24, s88, v24
    v_mfma_f32_32x32x16_bf16 v[80:95], a[236:239], v[180:183], v[80:95]
    ds_read_b64_tr_b16 a[228:229], v2 offset:1024
    ds_read_b64_tr_b16 a[230:231], v2 offset:29696
    v_bfe_u32 v25, v29, 1, 1
    v_mad_u32_u24 v25, v25, 7, 7
    v_cmp_gt_u32 s[90:91], 12, v29
    s_waitcnt lgkmcnt(4)
    v_mfma_f32_32x32x16_bf16 v[64:79], a[240:243], v[184:187], v[64:79]
    ds_read_b64_tr_b16 a[232:233], v3 offset:1024
    ds_read_b64_tr_b16 a[234:235], v3 offset:29696
    buffer_load_dwordx4 v118, s[8:11], s57 offen offset:2048 lds
    v_mov_b32 v26, s87
    v_mfma_f32_32x32x16_bf16 v[80:95], a[244:247], v[184:187], v[80:95]
    ds_read_b64_tr_b16 a[236:237], v4 offset:1024
    ds_read_b64_tr_b16 a[238:239], v4 offset:29696
    v_and_b32_e64 v27, 1, v29
    v_cndmask_b32 v24, v26, v24, s[90:91]
    v_cndmask_b32 v25, 0, v25, s[90:91]
    v_cmp_eq_u32 s[90:91], 1, v27
    v_mfma_f32_32x32x16_bf16 v[64:79], a[248:251], v[188:191], v[64:79]
    ds_read_b64_tr_b16 a[240:241], v1 offset:2048
    ds_read_b64_tr_b16 a[242:243], v1 offset:30720
    buffer_load_dwordx4 v119, s[8:11], s57 offen offset:3072 lds
    v_mov_b32_e64 v26, s100
    v_mfma_f32_32x32x16_bf16 v[80:95], a[252:255], v[188:191], v[80:95]
    ds_read_b64_tr_b16 a[244:245], v2 offset:2048
    ds_read_b64_tr_b16 a[246:247], v2 offset:30720
    s_add_u32 m0, s55, 25600
    s_add_u32 s57, s57, 344064
    s_waitcnt lgkmcnt(4)
    v_mfma_f32_32x32x16_bf16 v[64:79], a[224:227], v[192:195], v[64:79]
    ds_read_b64_tr_b16 a[248:249], v3 offset:2048
    ds_read_b64_tr_b16 a[250:251], v3 offset:30720
    buffer_load_dwordx4 v116, s[8:11], s57 offen offset:0 lds
    v_mov_b32 v28, s101
    v_mfma_f32_32x32x16_bf16 v[80:95], a[228:231], v[192:195], v[80:95]
    ds_read_b64_tr_b16 a[252:253], v4 offset:2048
    ds_read_b64_tr_b16 a[254:255], v4 offset:30720
    v_cndmask_b32 v26, v26, v28, s[90:91]
    v_cmp_gt_u32 s[90:91], 14, v29
    v_cmp_le_i32 s[76:77], 0, v24
    v_add_u32_e64 v25, v25, v26
    v_mfma_f32_32x32x16_bf16 v[64:79], a[232:235], v[196:199], v[64:79]
    ds_read_b64_tr_b16 a[224:225], v1 offset:3072
    ds_read_b64_tr_b16 a[226:227], v1 offset:31744
    v_lshlrev_b32 v24, 9, v24
    v_lshl_add_u32 v24, v25, 2, v24
    s_and_b64 s[90:91], s[90:91], s[76:77]
    v_mfma_f32_32x32x16_bf16 v[80:95], a[236:239], v[196:199], v[80:95]
    ds_read_b64_tr_b16 a[228:229], v2 offset:3072
    ds_read_b64_tr_b16 a[230:231], v2 offset:31744
    buffer_load_dwordx4 v117, s[8:11], s57 offen offset:1024 lds
    s_waitcnt lgkmcnt(4)
    v_mfma_f32_32x32x16_bf16 v[64:79], a[240:243], v[200:203], v[64:79]
    ds_read_b64_tr_b16 a[232:233], v3 offset:3072
    ds_read_b64_tr_b16 a[234:235], v3 offset:31744
    v_add_u32 v24, 15400960, v24
    v_cndmask_b32 v244, v30, v24, s[90:91]
    s_add_u32 s100, s88, 0
    v_mfma_f32_32x32x16_bf16 v[80:95], a[244:247], v[200:203], v[80:95]
    ds_read_b64_tr_b16 a[236:237], v4 offset:3072
    ds_read_b64_tr_b16 a[238:239], v4 offset:31744
    buffer_load_dwordx4 v118, s[8:11], s57 offen offset:2048 lds
    s_mul_i32 s101, s100, 28928
    v_mfma_f32_32x32x16_bf16 v[64:79], a[248:251], v[204:207], v[64:79]
    ds_read_b64_tr_b16 a[240:241], v1 offset:4096
    ds_read_b64_tr_b16 a[242:243], v1 offset:32768
    s_mul_i32 s80, s86, 1792
    s_add_u32 s80, s80, s101
    s_nop 0
    s_add_u32 s80, s80, 1900544
    v_mfma_f32_32x32x16_bf16 v[80:95], a[252:255], v[204:207], v[80:95]
    ds_read_b64_tr_b16 a[244:245], v2 offset:4096
    ds_read_b64_tr_b16 a[246:247], v2 offset:32768
    s_mul_i32 s81, s86, 448
    s_add_u32 s81, s81, s101
    s_waitcnt lgkmcnt(4)
    v_mfma_f32_32x32x16_bf16 v[64:79], a[224:227], v[208:211], v[64:79]
    ds_read_b64_tr_b16 a[248:249], v3 offset:4096
    ds_read_b64_tr_b16 a[250:251], v3 offset:32768
    s_add_u32 s81, s81, 3801088
    s_cmp_lt_i32 s100, 0
    s_nop 0
    s_cselect_b32 s80, 15532032, s80
    s_cselect_b32 s81, 15532032, s81
    v_mfma_f32_32x32x16_bf16 v[80:95], a[228:231], v[208:211], v[80:95]
    ds_read_b64_tr_b16 a[252:253], v4 offset:4096
    ds_read_b64_tr_b16 a[254:255], v4 offset:32768
    s_add_u32 s100, s88, 1
    s_mul_i32 s101, s100, 28928
    s_mul_i32 s82, s86, 1792
    v_mfma_f32_32x32x16_bf16 v[64:79], a[232:235], v[212:215], v[64:79]
    ds_read_b64_tr_b16 a[224:225], v1 offset:5120
    ds_read_b64_tr_b16 a[226:227], v1 offset:33792
    s_add_u32 s82, s82, s101
    s_add_u32 s82, s82, 1900544
    s_mul_i32 s83, s86, 448
    v_mfma_f32_32x32x16_bf16 v[80:95], a[236:239], v[212:215], v[80:95]
    ds_read_b64_tr_b16 a[228:229], v2 offset:5120
    ds_read_b64_tr_b16 a[230:231], v2 offset:33792
    s_add_u32 s83, s83, s101
    s_add_u32 s83, s83, 3801088
    s_waitcnt lgkmcnt(4)
    v_mfma_f32_32x32x16_bf16 v[64:79], a[240:243], v[216:219], v[64:79]
    ds_read_b64_tr_b16 a[232:233], v3 offset:5120
    ds_read_b64_tr_b16 a[234:235], v3 offset:33792
    s_waitcnt vmcnt(15)
    v_cmp_eq_u32_e64 vcc, 0, v255
    s_cbranch_vccnz Lslow_13
Lback_14:
    v_mfma_f32_32x32x16_bf16 v[80:95], a[244:247], v[216:219], v[80:95]
    ds_read_b64_tr_b16 a[236:237], v4 offset:5120
    ds_read_b64_tr_b16 a[238:239], v4 offset:33792
    s_cmp_lt_i32 s100, 0
    s_cselect_b32 s82, 15532032, s82
    s_cselect_b32 s83, 15532032, s83
    v_mfma_f32_32x32x16_bf16 v[64:79], a[248:251], v[220:223], v[64:79]
    ds_read_b64_tr_b16 a[240:241], v1 offset:6144
    ds_read_b64_tr_b16 a[242:243], v1 offset:34816
    s_add_u32 s100, s88, 2
    s_mul_i32 s101, s100, 28928
    s_mul_i32 s84, s86, 1792
    v_mfma_f32_32x32x16_bf16 v[80:95], a[252:255], v[220:223], v[80:95]
    ds_read_b64_tr_b16 a[244:245], v2 offset:6144
    ds_read_b64_tr_b16 a[246:247], v2 offset:34816
    s_add_u32 s84, s84, s101
    s_add_u32 s84, s84, 1900544
    s_waitcnt lgkmcnt(4)
    v_mfma_f32_32x32x16_bf16 v[64:79], a[224:227], v[224:227], v[64:79]
    ds_read_b64_tr_b16 a[248:249], v3 offset:6144
    ds_read_b64_tr_b16 a[250:251], v3 offset:34816
    s_mul_i32 s85, s86, 448
    s_add_u32 s85, s85, s101
    s_nop 0
    s_add_u32 s85, s85, 3801088
    v_mfma_f32_32x32x16_bf16 v[80:95], a[228:231], v[224:227], v[80:95]
    ds_read_b64_tr_b16 a[252:253], v4 offset:6144
    ds_read_b64_tr_b16 a[254:255], v4 offset:34816
    s_barrier
    v_mfma_f32_32x32x16_bf16 v[64:79], a[232:235], v[228:231], v[64:79]
    ds_read_b64_tr_b16 a[224:225], v1 offset:7168
    ds_read_b64_tr_b16 a[226:227], v1 offset:35840
    s_cmp_lt_i32 s100, 0
    s_cselect_b32 s84, 15532032, s84
    s_cselect_b32 s85, 15532032, s85
    v_mfma_f32_32x32x16_bf16 v[80:95], a[236:239], v[228:231], v[80:95]
    ds_read_b64_tr_b16 a[228:229], v2 offset:7168
    ds_read_b64_tr_b16 a[230:231], v2 offset:35840
    s_cmp_lt_i32 s88, 0
    s_cselect_b32 s86, 0xf149, 0
    s_waitcnt lgkmcnt(4)
    v_mfma_f32_32x32x16_bf16 v[64:79], a[240:243], v[232:235], v[64:79]
    ds_read_b64_tr_b16 a[232:233], v3 offset:7168
    ds_read_b64_tr_b16 a[234:235], v3 offset:35840
    s_cmp_lt_i32 s88, -1
    s_cselect_b32 s87, 0xf149, 0
    s_cmp_lt_i32 s88, -2
    s_cselect_b32 s88, 0xf149, 0
    v_mfma_f32_32x32x16_bf16 v[80:95], a[244:247], v[232:235], v[80:95]
    ds_read_b64_tr_b16 a[236:237], v4 offset:7168
    ds_read_b64_tr_b16 a[238:239], v4 offset:35840
    v_lshrrev_b32 v28, 4, v7
    v_lshrrev_b32 v29, 9, v7
    v_and_b32 v30, 31, v28
    v_lshlrev_b32 v24, 2, v29
    v_mfma_f32_32x32x16_bf16 v[64:79], a[248:251], v[236:239], v[64:79]
    ds_read_b64_tr_b16 a[240:241], v1 offset:8192
    ds_read_b64_tr_b16 a[242:243], v1 offset:36864
    v_sub_u32_e64 v24, v30, v24
    v_mov_b32 v25, 0x0000ffff
    v_mov_b32 v26, 0xffff0000
    v_cmp_le_i32 s[100:101], 0, v24
    v_mfma_f32_32x32x16_bf16 v[80:95], a[252:255], v[236:239], v[80:95]
    ds_read_b64_tr_b16 a[244:245], v2 offset:8192
    ds_read_b64_tr_b16 a[246:247], v2 offset:36864
    v_cmp_le_i32 s[76:77], 1, v24
    v_cndmask_b32 v8, 0, v25, s[100:101]
    s_nop 0
    v_cndmask_b32 v27, 0, v26, s[76:77]
    s_waitcnt lgkmcnt(4)
    v_mfma_f32_32x32x16_bf16 v[32:47], a[224:227], v[128:131], 0
    ds_read_b64_tr_b16 a[248:249], v3 offset:8192
    ds_read_b64_tr_b16 a[250:251], v3 offset:36864
    v_cmp_le_i32 s[100:101], 2, v24
    v_cmp_le_i32 s[76:77], 3, v24
    v_or_b32_e64 v8, v8, v27
    v_cndmask_b32 v9, 0, v25, s[100:101]
    v_mfma_f32_32x32x16_bf16 v[48:63], a[228:231], v[128:131], 0
    ds_read_b64_tr_b16 a[252:253], v4 offset:8192
    ds_read_b64_tr_b16 a[254:255], v4 offset:36864
    v_cndmask_b32 v27, 0, v26, s[76:77]
    v_cmp_le_i32 s[100:101], 8, v24
    v_cmp_le_i32 s[76:77], 9, v24
    v_or_b32_e64 v9, v9, v27
    v_mfma_f32_32x32x16_bf16 v[32:47], a[232:235], v[132:135], v[32:47]
    ds_read_b64_tr_b16 a[224:225], v1 offset:9216
    ds_read_b64_tr_b16 a[226:227], v1 offset:37888
    v_cndmask_b32 v10, 0, v25, s[100:101]
    v_cndmask_b32 v27, 0, v26, s[76:77]
    v_cmp_le_i32 s[100:101], 10, v24
    v_cmp_le_i32 s[76:77], 11, v24
    v_mfma_f32_32x32x16_bf16 v[48:63], a[236:239], v[132:135], v[48:63]
    ds_read_b64_tr_b16 a[228:229], v2 offset:9216
    ds_read_b64_tr_b16 a[230:231], v2 offset:37888
    v_mul_f32 v246, s66, v253
    v_mul_f32 v64, v246, v64
    v_mul_f32 v65, v246, v65
    s_waitcnt lgkmcnt(4)
    v_mfma_f32_32x32x16_bf16 v[32:47], a[240:243], v[136:139], v[32:47]
    ds_read_b64_tr_b16 a[232:233], v3 offset:9216
    ds_read_b64_tr_b16 a[234:235], v3 offset:37888
    v_mul_f32 v66, v246, v66
    v_mul_f32 v67, v246, v67
    v_cvt_pk_bf16_f32 v64, v64, v65
    v_cvt_pk_bf16_f32 v65, v66, v67
    v_mfma_f32_32x32x16_bf16 v[48:63], a[244:247], v[136:139], v[48:63]
    ds_read_b64_tr_b16 a[236:237], v4 offset:9216
    ds_read_b64_tr_b16 a[238:239], v4 offset:37888
    buffer_store_dwordx2 v[64:65], v252, s[28:31], s63 offen offset:0 sc1
    v_mul_f32_e64 v68, v246, v68
    v_mfma_f32_32x32x16_bf16 v[32:47], a[248:251], v[140:143], v[32:47]
    ds_read_b64_tr_b16 a[240:241], v1 offset:10240
    ds_read_b64_tr_b16 a[242:243], v1 offset:38912
    v_mul_f32 v69, v246, v69
    v_mul_f32 v70, v246, v70
    v_mul_f32_e64 v71, v246, v71
    v_cvt_pk_bf16_f32 v68, v68, v69
    v_mfma_f32_32x32x16_bf16 v[48:63], a[252:255], v[140:143], v[48:63]
    ds_read_b64_tr_b16 a[244:245], v2 offset:10240
    ds_read_b64_tr_b16 a[246:247], v2 offset:38912
    v_cvt_pk_bf16_f32 v69, v70, v71
    v_mul_f32_e64 v72, v246, v72
    v_mul_f32 v73, v246, v73
    s_waitcnt lgkmcnt(4)
    v_mfma_f32_32x32x16_bf16 v[32:47], a[224:227], v[144:147], v[32:47]
    ds_read_b64_tr_b16 a[248:249], v3 offset:10240
    ds_read_b64_tr_b16 a[250:251], v3 offset:38912
    v_mul_f32 v74, v246, v74
    v_or_b32 v10, v10, v27
    v_cndmask_b32 v11, 0, v25, s[100:101]
    v_cndmask_b32 v27, 0, v26, s[76:77]
    v_mfma_f32_32x32x16_bf16 v[48:63], a[228:231], v[144:147], v[48:63]
    ds_read_b64_tr_b16 a[252:253], v4 offset:10240
    ds_read_b64_tr_b16 a[254:255], v4 offset:38912
    v_mul_f32_e64 v75, v246, v75
    v_cvt_pk_bf16_f32 v72, v72, v73
    v_cmp_le_i32 s[100:101], 16, v24
    v_cmp_le_i32 s[76:77], 17, v24
    v_mfma_f32_32x32x16_bf16 v[32:47], a[232:235], v[148:151], v[32:47]
    ds_read_b64_tr_b16 a[224:225], v1 offset:11264
    ds_read_b64_tr_b16 a[226:227], v1 offset:39936
    buffer_store_dwordx2 v[68:69], v252, s[28:31], s63 offen offset:512 sc1
    v_cvt_pk_bf16_f32 v73, v74, v75
    v_mfma_f32_32x32x16_bf16 v[48:63], a[236:239], v[148:151], v[48:63]
    ds_read_b64_tr_b16 a[228:229], v2 offset:11264
    ds_read_b64_tr_b16 a[230:231], v2 offset:39936
    v_mul_f32 v76, v246, v76
    v_mul_f32 v77, v246, v77
    v_or_b32 v11, v11, v27
    s_waitcnt lgkmcnt(4)
    v_mfma_f32_32x32x16_bf16 v[32:47], a[240:243], v[152:155], v[32:47]
    ds_read_b64_tr_b16 a[232:233], v3 offset:11264
    ds_read_b64_tr_b16 a[234:235], v3 offset:39936
    v_mul_f32_e64 v78, v246, v78
    v_cndmask_b32 v12, 0, v25, s[100:101]
    v_cndmask_b32 v27, 0, v26, s[76:77]
    v_cmp_le_i32 s[100:101], 18, v24
    v_mfma_f32_32x32x16_bf16 v[48:63], a[244:247], v[152:155], v[48:63]
    ds_read_b64_tr_b16 a[236:237], v4 offset:11264
    ds_read_b64_tr_b16 a[238:239], v4 offset:39936
    v_mul_f32_e64 v79, v246, v79
    v_cmp_le_i32 s[76:77], 19, v24
    v_or_b32_e64 v12, v12, v27
    v_cndmask_b32 v13, 0, v25, s[100:101]
    v_mfma_f32_32x32x16_bf16 v[32:47], a[248:251], v[156:159], v[32:47]
    ds_read_b64_tr_b16 a[240:241], v1 offset:12288
    ds_read_b64_tr_b16 a[242:243], v1 offset:40960
    buffer_store_dwordx2 v[72:73], v252, s[28:31], s63 offen offset:1024 sc1
    v_cvt_pk_bf16_f32 v76, v76, v77
    v_mfma_f32_32x32x16_bf16 v[48:63], a[252:255], v[156:159], v[48:63]
    ds_read_b64_tr_b16 a[244:245], v2 offset:12288
    ds_read_b64_tr_b16 a[246:247], v2 offset:40960
    v_cvt_pk_bf16_f32 v77, v78, v79
    v_mul_f32 v80, v246, v80
    v_cndmask_b32 v27, 0, v26, s[76:77]
    s_waitcnt lgkmcnt(4)
    v_mfma_f32_32x32x16_bf16 v[32:47], a[224:227], v[160:163], v[32:47]
    ds_read_b64_tr_b16 a[248:249], v3 offset:12288
    ds_read_b64_tr_b16 a[250:251], v3 offset:40960
    v_mul_f32_e64 v81, v246, v81
    v_cmp_le_i32 s[100:101], 24, v24
    v_cmp_le_i32 s[76:77], 25, v24
    v_or_b32_e64 v13, v13, v27
    v_mfma_f32_32x32x16_bf16 v[48:63], a[228:231], v[160:163], v[48:63]
    ds_read_b64_tr_b16 a[252:253], v4 offset:12288
    ds_read_b64_tr_b16 a[254:255], v4 offset:40960
    v_mul_f32_e64 v82, v246, v82
    v_cndmask_b32 v14, 0, v25, s[100:101]
    v_cndmask_b32 v27, 0, v26, s[76:77]
    v_cmp_le_i32 s[100:101], 26, v24
    v_mfma_f32_32x32x16_bf16 v[32:47], a[232:235], v[164:167], v[32:47]
    ds_read_b64_tr_b16 a[224:225], v1 offset:13312
    ds_read_b64_tr_b16 a[226:227], v1 offset:41984
    v_mul_f32_e64 v83, v246, v83
    v_cmp_le_i32 s[76:77], 27, v24
    v_or_b32_e64 v14, v14, v27
    v_cndmask_b32 v15, 0, v25, s[100:101]
    v_mfma_f32_32x32x16_bf16 v[48:63], a[236:239], v[164:167], v[48:63]
    ds_read_b64_tr_b16 a[228:229], v2 offset:13312
    ds_read_b64_tr_b16 a[230:231], v2 offset:41984
    buffer_store_dwordx2 v[76:77], v252, s[28:31], s63 offen offset:1536 sc1
    s_waitcnt lgkmcnt(4)
    s_nop 0
    v_mfma_f32_32x32x16_bf16 v[32:47], a[240:243], v[168:171], v[32:47]
    ds_read_b64_tr_b16 a[232:233], v3 offset:13312
    ds_read_b64_tr_b16 a[234:235], v3 offset:41984
    v_cvt_pk_bf16_f32 v80, v80, v81
    v_cvt_pk_bf16_f32 v81, v82, v83
    v_mul_f32 v84, v246, v84
    v_mul_f32 v85, v246, v85
    v_mfma_f32_32x32x16_bf16 v[48:63], a[244:247], v[168:171], v[48:63]
    ds_read_b64_tr_b16 a[236:237], v4 offset:13312
    ds_read_b64_tr_b16 a[238:239], v4 offset:41984
    s_waitcnt vmcnt(11)
    s_barrier
    v_mfma_f32_32x32x16_bf16 v[32:47], a[248:251], v[172:175], v[32:47]
    ds_read_b64_tr_b16 a[240:241], v1 offset:14336
    ds_read_b64_tr_b16 a[242:243], v1 offset:43008
    s_add_u32 m0, s55, 0
    s_add_u32 s57, s48, s52
    v_mul_f32_e64 v86, v246, v86
    v_mfma_f32_32x32x16_bf16 v[48:63], a[252:255], v[172:175], v[48:63]
    ds_read_b64_tr_b16 a[244:245], v2 offset:14336
    ds_read_b64_tr_b16 a[246:247], v2 offset:43008
    buffer_load_dwordx4 v116, s[8:11], s57 offen offset:0 lds
    s_waitcnt lgkmcnt(4)
    v_mfma_f32_32x32x16_bf16 v[32:47], a[224:227], v[176:179], v[32:47]
    ds_read_b64_tr_b16 a[248:249], v3 offset:14336
    ds_read_b64_tr_b16 a[250:251], v3 offset:43008
    v_mul_f32 v87, v246, v87
    v_cvt_pk_bf16_f32 v84, v84, v85
    v_cvt_pk_bf16_f32 v85, v86, v87
    v_mul_f32_e64 v88, v246, v88
    v_mfma_f32_32x32x16_bf16 v[48:63], a[228:231], v[176:179], v[48:63]
    ds_read_b64_tr_b16 a[252:253], v4 offset:14336
    ds_read_b64_tr_b16 a[254:255], v4 offset:43008
    buffer_store_dwordx2 v[80:81], v252, s[28:31], s63 offen offset:2048 sc1
    v_mul_f32_e64 v89, v246, v89
    v_mfma_f32_32x32x16_bf16 v[32:47], a[232:235], v[180:183], v[32:47]
    ds_read_b64_tr_b16 a[224:225], v1 offset:15360
    ds_read_b64_tr_b16 a[226:227], v1 offset:44032
    buffer_load_dwordx4 v117, s[8:11], s57 offen offset:1024 lds
    v_mul_f32_e64 v90, v246, v90
    v_mfma_f32_32x32x16_bf16 v[48:63], a[236:239], v[180:183], v[48:63]
    ds_read_b64_tr_b16 a[228:229], v2 offset:15360
    ds_read_b64_tr_b16 a[230:231], v2 offset:44032
    v_mul_f32 v91, v246, v91
    v_cndmask_b32 v27, 0, v26, s[76:77]
    v_cmp_gt_u32 s[100:101], 48, v28
    s_waitcnt lgkmcnt(4)
    v_mfma_f32_32x32x16_bf16 v[32:47], a[240:243], v[184:187], v[32:47]
    ds_read_b64_tr_b16 a[232:233], v3 offset:15360
    ds_read_b64_tr_b16 a[234:235], v3 offset:44032
    buffer_store_dwordx2 v[84:85], v252, s[28:31], s63 offen offset:2560 sc1
    v_cvt_pk_bf16_f32 v88, v88, v89
    v_mfma_f32_32x32x16_bf16 v[48:63], a[244:247], v[184:187], v[48:63]
    ds_read_b64_tr_b16 a[236:237], v4 offset:15360
    ds_read_b64_tr_b16 a[238:239], v4 offset:44032
    buffer_load_dwordx4 v118, s[8:11], s57 offen offset:2048 lds
    v_cvt_pk_bf16_f32 v89, v90, v91
    v_mfma_f32_32x32x16_bf16 v[32:47], a[248:251], v[188:191], v[32:47]
    ds_read_b64_tr_b16 a[240:241], v1 offset:16384
    ds_read_b64_tr_b16 a[242:243], v1 offset:45056
    v_mul_f32 v92, v246, v92
    v_mul_f32 v93, v246, v93
    v_cmp_gt_u32 s[76:77], 28, v30
    v_or_b32_e64 v15, v15, v27
    v_mfma_f32_32x32x16_bf16 v[48:63], a[252:255], v[188:191], v[48:63]
    ds_read_b64_tr_b16 a[244:245], v2 offset:16384
    ds_read_b64_tr_b16 a[246:247], v2 offset:45056
    buffer_load_dwordx4 v119, s[8:11], s57 offen offset:3072 lds
    s_waitcnt lgkmcnt(4)
    v_mfma_f32_32x32x16_bf16 v[32:47], a[224:227], v[192:195], v[32:47]
    ds_read_b64_tr_b16 a[248:249], v3 offset:16384
    ds_read_b64_tr_b16 a[250:251], v3 offset:45056
    v_mul_f32 v94, v246, v94
    v_mul_f32_e64 v95, v246, v95
    v_mov_b32 v27, 2146435072
    v_mul_u32_u24 v23, 7168, v29
    v_mfma_f32_32x32x16_bf16 v[48:63], a[228:231], v[192:195], v[48:63]
    ds_read_b64_tr_b16 a[252:253], v4 offset:16384
    ds_read_b64_tr_b16 a[254:255], v4 offset:45056
    buffer_store_dwordx2 v[88:89], v252, s[28:31], s63 offen offset:3072 sc1
    s_add_u32 m0, s55, 4096
    s_add_u32 s57, s57, 344064
    v_mfma_f32_32x32x16_bf16 v[32:47], a[232:235], v[196:199], v[32:47]
    ds_read_b64_tr_b16 a[224:225], v1 offset:17408
    ds_read_b64_tr_b16 a[226:227], v1 offset:46080
    buffer_load_dwordx4 v116, s[8:11], s57 offen offset:0 lds
    v_cvt_pk_bf16_f32 v92, v92, v93
    v_mfma_f32_32x32x16_bf16 v[48:63], a[236:239], v[196:199], v[48:63]
    ds_read_b64_tr_b16 a[228:229], v2 offset:17408
    ds_read_b64_tr_b16 a[230:231], v2 offset:46080
    v_cvt_pk_bf16_f32 v93, v94, v95
    v_cndmask_b32 v22, v27, v7, s[100:101]
    v_cmp_gt_u32 s[100:101], 32, v28
    s_waitcnt lgkmcnt(4)
    s_nop 0
    v_mfma_f32_32x32x16_bf16 v[32:47], a[240:243], v[200:203], v[32:47]
    ds_read_b64_tr_b16 a[232:233], v3 offset:17408
    ds_read_b64_tr_b16 a[234:235], v3 offset:46080
    buffer_load_dwordx4 v117, s[8:11], s57 offen offset:1024 lds
    v_lshl_add_u32 v23, v30, 4, v23
    v_mfma_f32_32x32x16_bf16 v[48:63], a[244:247], v[200:203], v[48:63]
    ds_read_b64_tr_b16 a[236:237], v4 offset:17408
    ds_read_b64_tr_b16 a[238:239], v4 offset:46080
    v_cndmask_b32 v23, v27, v23, s[76:77]
    v_cndmask_b32 v25, v27, v252, s[100:101]
    v_and_b32_e64 v26, 62, v28
    v_mfma_f32_32x32x16_bf16 v[32:47], a[248:251], v[204:207], v[32:47]
    ds_read_b64_tr_b16 a[240:241], v1 offset:18432
    ds_read_b64_tr_b16 a[242:243], v1 offset:47104
    buffer_store_dwordx2 v[92:93], v252, s[28:31], s63 offen offset:3584 sc1
    s_mul_i32 s76, s40, 6
    v_mfma_f32_32x32x16_bf16 v[48:63], a[252:255], v[204:207], v[48:63]
    ds_read_b64_tr_b16 a[244:245], v2 offset:18432
    ds_read_b64_tr_b16 a[246:247], v2 offset:47104
    buffer_load_dwordx4 v118, s[8:11], s57 offen offset:2048 lds
    s_waitcnt lgkmcnt(4)
    v_mfma_f32_32x32x16_bf16 v[32:47], a[224:227], v[208:211], v[32:47]
    ds_read_b64_tr_b16 a[248:249], v3 offset:18432
    ds_read_b64_tr_b16 a[250:251], v3 offset:47104
    s_bfe_u32 s77, s42, 65537
    s_add_u32 s76, s76, s77
    s_xor_b32 s77, s76, 1
    v_mfma_f32_32x32x16_bf16 v[48:63], a[228:231], v[208:211], v[48:63]
    ds_read_b64_tr_b16 a[252:253], v4 offset:18432
    ds_read_b64_tr_b16 a[254:255], v4 offset:47104
    s_sub_u32 s77, s77, 6
    v_cmp_gt_u32 s[100:101], 6, v28
    v_add_u32 v24, s77, v26
    v_mfma_f32_32x32x16_bf16 v[32:47], a[232:235], v[212:215], v[32:47]
    ds_read_b64_tr_b16 a[224:225], v1 offset:19456
    ds_read_b64_tr_b16 a[226:227], v1 offset:48128
    v_add_u32_e64 v26, s76, v26
    v_cndmask_b32 v26, v24, v26, s[100:101]
    v_cmp_gt_u32 s[100:101], 12, v28
    v_mfma_f32_32x32x16_bf16 v[48:63], a[236:239], v[212:215], v[48:63]
    ds_read_b64_tr_b16 a[228:229], v2 offset:19456
    ds_read_b64_tr_b16 a[230:231], v2 offset:48128
    s_add_u32 s76, s40, 24
    v_mov_b32_e64 v24, s76
    s_waitcnt lgkmcnt(4)
    v_mfma_f32_32x32x16_bf16 v[32:47], a[240:243], v[216:219], v[32:47]
    ds_read_b64_tr_b16 a[232:233], v3 offset:19456
    ds_read_b64_tr_b16 a[234:235], v3 offset:48128
    v_cndmask_b32 v26, v24, v26, s[100:101]
    v_cmp_gt_u32 s[100:101], 14, v28
    v_and_b32 v24, 1, v28
    v_add_u32 v24, s79, v24
    v_mfma_f32_32x32x16_bf16 v[48:63], a[244:247], v[216:219], v[48:63]
    ds_read_b64_tr_b16 a[236:237], v4 offset:19456
    ds_read_b64_tr_b16 a[238:239], v4 offset:48128
    v_lshlrev_b32_e64 v24, 9, v24
    v_lshl_add_u32 v26, v26, 2, v24
    v_add_u32 v26, 15401088, v26
    v_add_u32 v24, 13312, v23
    v_mfma_f32_32x32x16_bf16 v[32:47], a[248:251], v[220:223], v[32:47]
    ds_read_b64_tr_b16 a[240:241], v1 offset:20480
    ds_read_b64_tr_b16 a[242:243], v1 offset:49152
    v_cndmask_b32 v26, v27, v26, s[100:101]
    s_add_u32 s76, s40, 0
    s_cmp_ge_u32 s76, 3
    s_cselect_b32 s77, 16384, 0
    v_mfma_f32_32x32x16_bf16 v[48:63], a[252:255], v[220:223], v[48:63]
    ds_read_b64_tr_b16 a[244:245], v2 offset:20480
    ds_read_b64_tr_b16 a[246:247], v2 offset:49152
    s_lshl_b32 s76, s76, 12
    s_nop 0
    s_add_u32 s76, s76, s77
    s_waitcnt lgkmcnt(4)
    v_mfma_f32_32x32x16_bf16 v[32:47], a[224:227], v[224:227], v[32:47]
    ds_read_b64_tr_b16 a[248:249], v3 offset:20480
    ds_read_b64_tr_b16 a[250:251], v3 offset:49152
    s_add_u32 s76, s76, 7168
    v_add_u32 v16, s76, v252
    v_add_u32 v19, s76, v7
    v_mfma_f32_32x32x16_bf16 v[48:63], a[228:231], v[224:227], v[48:63]
    ds_read_b64_tr_b16 a[252:253], v4 offset:20480
    ds_read_b64_tr_b16 a[254:255], v4 offset:49152
    s_waitcnt vmcnt(15)
    s_barrier
    v_mfma_f32_32x32x16_bf16 v[32:47], a[232:235], v[228:231], v[32:47]
    ds_read_b64_tr_b16 a[224:225], v1 offset:21504
    ds_read_b64_tr_b16 a[226:227], v1 offset:50176
    s_add_u32 m0, s55, 7168
    s_add_u32 s57, s50, s53
    s_add_u32 s76, s40, 1
    v_mfma_f32_32x32x16_bf16 v[48:63], a[236:239], v[228:231], v[48:63]
    ds_read_b64_tr_b16 a[228:229], v2 offset:21504
    ds_read_b64_tr_b16 a[230:231], v2 offset:50176
    buffer_load_dwordx4 v240, s[12:15], s57 offen offset:0 lds
    s_waitcnt lgkmcnt(4)
    v_mfma_f32_32x32x16_bf16 v[32:47], a[240:243], v[232:235], v[32:47]
    ds_read_b64_tr_b16 a[232:233], v3 offset:21504
    ds_read_b64_tr_b16 a[234:235], v3 offset:50176
    s_cmp_ge_u32 s76, 3
    s_cselect_b32 s77, 16384, 0
    s_lshl_b32 s76, s76, 12
    v_mfma_f32_32x32x16_bf16 v[48:63], a[244:247], v[232:235], v[48:63]
    ds_read_b64_tr_b16 a[236:237], v4 offset:21504
    ds_read_b64_tr_b16 a[238:239], v4 offset:50176
    buffer_load_dwordx4 v241, s[12:15], s57 offen offset:1024 lds
    s_add_u32 s76, s76, s77
    v_mfma_f32_32x32x16_bf16 v[32:47], a[248:251], v[236:239], v[32:47]
    ds_read_b64_tr_b16 a[240:241], v1 offset:22528
    ds_read_b64_tr_b16 a[242:243], v1 offset:51200
    s_add_u32 s76, s76, 7168
    v_add_u32 v17, s76, v252
    v_add_u32 v20, s76, v7
    v_mfma_f32_32x32x16_bf16 v[48:63], a[252:255], v[236:239], v[48:63]
    ds_read_b64_tr_b16 a[244:245], v2 offset:22528
    ds_read_b64_tr_b16 a[246:247], v2 offset:51200
    buffer_load_dwordx4 v242, s[12:15], s57 offen offset:2048 lds
    s_waitcnt lgkmcnt(4)
    s_nop 0
    v_mfma_f32_32x32x16_bf16 v[64:79], a[224:227], v[128:131], 0
    ds_read_b64_tr_b16 a[248:249], v3 offset:22528
    ds_read_b64_tr_b16 a[250:251], v3 offset:51200
    s_add_u32 s76, s40, 2
    s_cmp_ge_u32 s76, 3
    s_cselect_b32 s77, 16384, 0
    v_mfma_f32_32x32x16_bf16 v[80:95], a[228:231], v[128:131], 0
    ds_read_b64_tr_b16 a[252:253], v4 offset:22528
    ds_read_b64_tr_b16 a[254:255], v4 offset:51200
    buffer_load_dwordx4 v243, s[12:15], s57 offen offset:3072 lds
    s_lshl_b32 s76, s76, 12
    v_mfma_f32_32x32x16_bf16 v[64:79], a[232:235], v[132:135], v[64:79]
    ds_read_b64_tr_b16 a[224:225], v1 offset:23552
    ds_read_b64_tr_b16 a[226:227], v1 offset:52224
    s_add_u32 m0, s55, 11264
    s_add_u32 s57, s57, 458752
    s_add_u32 s76, s76, s77
    v_mfma_f32_32x32x16_bf16 v[80:95], a[236:239], v[132:135], v[80:95]
    ds_read_b64_tr_b16 a[228:229], v2 offset:23552
    ds_read_b64_tr_b16 a[230:231], v2 offset:52224
    buffer_load_dwordx4 v240, s[12:15], s57 offen offset:0 lds
    v_mul_f32_e64 v246, s67, v253
    v_mul_f32 v32, v246, v32
    s_waitcnt lgkmcnt(4)
    v_mfma_f32_32x32x16_bf16 v[64:79], a[240:243], v[136:139], v[64:79]
    ds_read_b64_tr_b16 a[232:233], v3 offset:23552
    ds_read_b64_tr_b16 a[234:235], v3 offset:52224
    v_mul_f32 v33, v246, v33
    v_mul_f32 v34, v246, v34
    v_mul_f32_e64 v35, v246, v35
    v_cvt_pk_bf16_f32 v32, v32, v33
    v_cvt_pk_bf16_f32 v33, v34, v35
    v_mfma_f32_32x32x16_bf16 v[80:95], a[244:247], v[136:139], v[80:95]
    ds_read_b64_tr_b16 a[236:237], v4 offset:23552
    ds_read_b64_tr_b16 a[238:239], v4 offset:52224
    buffer_store_dwordx2 v[32:33], v252, s[28:31], s64 offen offset:0 sc1
    v_mul_f32_e64 v36, v246, v36
    v_mfma_f32_32x32x16_bf16 v[64:79], a[248:251], v[140:143], v[64:79]
    ds_read_b64_tr_b16 a[240:241], v1 offset:24576
    ds_read_b64_tr_b16 a[242:243], v1 offset:53248
    buffer_load_dwordx4 v241, s[12:15], s57 offen offset:1024 lds
    v_mul_f32_e64 v37, v246, v37
    v_mfma_f32_32x32x16_bf16 v[80:95], a[252:255], v[140:143], v[80:95]
    ds_read_b64_tr_b16 a[244:245], v2 offset:24576
    ds_read_b64_tr_b16 a[246:247], v2 offset:53248
    v_mul_f32 v38, v246, v38
    v_mul_f32 v39, v246, v39
    v_cvt_pk_bf16_f32 v36, v36, v37
    s_waitcnt lgkmcnt(4)
    v_mfma_f32_32x32x16_bf16 v[64:79], a[224:227], v[144:147], v[64:79]
    ds_read_b64_tr_b16 a[248:249], v3 offset:24576
    ds_read_b64_tr_b16 a[250:251], v3 offset:53248
    s_waitcnt vmcnt(8)
    buffer_store_dword v255, v0, s[28:31], s69 offen sc1
    v_mfma_f32_32x32x16_bf16 v[80:95], a[228:231], v[144:147], v[80:95]
    ds_read_b64_tr_b16 a[252:253], v4 offset:24576
    ds_read_b64_tr_b16 a[254:255], v4 offset:53248
    buffer_load_dwordx4 v242, s[12:15], s57 offen offset:2048 lds
    v_cvt_pk_bf16_f32 v37, v38, v39
    v_mfma_f32_32x32x16_bf16 v[64:79], a[232:235], v[148:151], v[64:79]
    ds_read_b64_tr_b16 a[224:225], v1 offset:25600
    ds_read_b64_tr_b16 a[226:227], v1 offset:54272
    v_mul_f32 v40, v246, v40
    v_mul_f32 v41, v246, v41
    v_mul_f32 v42, v246, v42
    v_mul_f32 v43, v246, v43
    v_mfma_f32_32x32x16_bf16 v[80:95], a[236:239], v[148:151], v[80:95]
    ds_read_b64_tr_b16 a[228:229], v2 offset:25600
    ds_read_b64_tr_b16 a[230:231], v2 offset:54272
    buffer_store_dwordx2 v[36:37], v252, s[28:31], s64 offen offset:512 sc1
    s_waitcnt lgkmcnt(4)
    s_nop 0
    v_mfma_f32_32x32x16_bf16 v[64:79], a[240:243], v[152:155], v[64:79]
    ds_read_b64_tr_b16 a[232:233], v3 offset:25600
    ds_read_b64_tr_b16 a[234:235], v3 offset:54272
    v_cvt_pk_bf16_f32 v40, v40, v41
    v_cvt_pk_bf16_f32 v41, v42, v43
    v_mul_f32 v44, v246, v44
    v_mul_f32 v45, v246, v45
    v_mfma_f32_32x32x16_bf16 v[80:95], a[244:247], v[152:155], v[80:95]
    ds_read_b64_tr_b16 a[236:237], v4 offset:25600
    ds_read_b64_tr_b16 a[238:239], v4 offset:54272
    v_mul_f32_e64 v46, v246, v46
    s_add_u32 s76, s76, 7168
    v_add_u32_e64 v18, s76, v252
    v_mfma_f32_32x32x16_bf16 v[64:79], a[248:251], v[156:159], v[64:79]
    ds_read_b64_tr_b16 a[240:241], v1 offset:26624
    ds_read_b64_tr_b16 a[242:243], v1 offset:55296
    buffer_store_dwordx2 v[40:41], v252, s[28:31], s64 offen offset:1024 sc1
    v_mul_f32_e64 v47, v246, v47
    v_mfma_f32_32x32x16_bf16 v[80:95], a[252:255], v[156:159], v[80:95]
    ds_read_b64_tr_b16 a[244:245], v2 offset:26624
    ds_read_b64_tr_b16 a[246:247], v2 offset:55296
    v_cvt_pk_bf16_f32 v44, v44, v45
    v_cvt_pk_bf16_f32 v45, v46, v47
    v_mul_f32 v48, v246, v48
    s_waitcnt lgkmcnt(4)
    v_mfma_f32_32x32x16_bf16 v[64:79], a[224:227], v[160:163], v[64:79]
    ds_read_b64_tr_b16 a[248:249], v3 offset:26624
    ds_read_b64_tr_b16 a[250:251], v3 offset:55296
    v_mul_f32 v49, v246, v49
    v_add_u32 v21, s76, v7
    v_lshrrev_b32_e64 v27, 3, v28
    v_mul_u32_u24 v27, 896, v27
    v_mfma_f32_32x32x16_bf16 v[80:95], a[228:231], v[160:163], v[80:95]
    ds_read_b64_tr_b16 a[252:253], v4 offset:26624
    ds_read_b64_tr_b16 a[254:255], v4 offset:55296
    v_mul_f32 v50, v246, v50
    v_and_b32 v29, 7, v28
    v_lshl_add_u32 v27, v29, 4, v27
    v_and_b32_e64 v30, 3, v28
    v_mfma_f32_32x32x16_bf16 v[64:79], a[232:235], v[164:167], v[64:79]
    ds_read_b64_tr_b16 a[224:225], v1 offset:27648
    ds_read_b64_tr_b16 a[226:227], v1 offset:56320
    v_mul_f32 v51, v246, v51
    v_lshrrev_b32 v28, 2, v28
    v_lshlrev_b32_e64 v28, 12, v28
    v_lshl_add_u32 v28, v30, 9, v28
    v_mfma_f32_32x32x16_bf16 v[80:95], a[236:239], v[164:167], v[80:95]
    ds_read_b64_tr_b16 a[228:229], v2 offset:27648
    ds_read_b64_tr_b16 a[230:231], v2 offset:56320
    buffer_store_dwordx2 v[44:45], v252, s[28:31], s64 offen offset:1536 sc1
    s_waitcnt lgkmcnt(4)
    s_nop 0
    v_mfma_f32_32x32x16_bf16 v[64:79], a[240:243], v[168:171], v[64:79]
    ds_read_b64_tr_b16 a[232:233], v3 offset:27648
    ds_read_b64_tr_b16 a[234:235], v3 offset:56320
    v_cvt_pk_bf16_f32 v48, v48, v49
    v_cvt_pk_bf16_f32 v49, v50, v51
    v_mul_f32 v52, v246, v52
    v_mul_f32 v53, v246, v53
    v_mfma_f32_32x32x16_bf16 v[80:95], a[244:247], v[168:171], v[80:95]
    ds_read_b64_tr_b16 a[236:237], v4 offset:27648
    ds_read_b64_tr_b16 a[238:239], v4 offset:56320
    s_waitcnt vmcnt(12)
    s_barrier
    v_mfma_f32_32x32x16_bf16 v[64:79], a[248:251], v[172:175], v[64:79]
    ds_read_b64_tr_b16 a[240:241], v1 offset:0
    ds_read_b64_tr_b16 a[242:243], v1 offset:28672
    s_add_u32 m0, s55, 14336
    s_add_u32 s57, s50, s54
    v_mul_f32 v54, v246, v54
    v_mfma_f32_32x32x16_bf16 v[80:95], a[252:255], v[172:175], v[80:95]
    ds_read_b64_tr_b16 a[244:245], v2 offset:0
    ds_read_b64_tr_b16 a[246:247], v2 offset:28672
    buffer_load_dwordx4 v240, s[12:15], s57 offen offset:0 lds
    s_waitcnt lgkmcnt(4)
    v_mfma_f32_32x32x16_bf16 v[64:79], a[224:227], v[176:179], v[64:79]
    ds_read_b64_tr_b16 a[248:249], v3 offset:0
    ds_read_b64_tr_b16 a[250:251], v3 offset:28672
    v_mul_f32 v55, v246, v55
    v_cvt_pk_bf16_f32 v52, v52, v53
    v_cvt_pk_bf16_f32 v53, v54, v55
    v_mul_f32_e64 v56, v246, v56
    v_mfma_f32_32x32x16_bf16 v[80:95], a[228:231], v[176:179], v[80:95]
    ds_read_b64_tr_b16 a[252:253], v4 offset:0
    ds_read_b64_tr_b16 a[254:255], v4 offset:28672
    buffer_store_dwordx2 v[48:49], v252, s[28:31], s64 offen offset:2048 sc1
    v_mul_f32_e64 v57, v246, v57
    v_mfma_f32_32x32x16_bf16 v[64:79], a[232:235], v[180:183], v[64:79]
    ds_read_b64_tr_b16 a[224:225], v1 offset:1024
    ds_read_b64_tr_b16 a[226:227], v1 offset:29696
    buffer_load_dwordx4 v241, s[12:15], s57 offen offset:1024 lds
    v_mul_f32_e64 v58, v246, v58
    v_mfma_f32_32x32x16_bf16 v[80:95], a[236:239], v[180:183], v[80:95]
    ds_read_b64_tr_b16 a[228:229], v2 offset:1024
    ds_read_b64_tr_b16 a[230:231], v2 offset:29696
    v_mul_f32_e64 v59, v246, v59
    v_add_u32 v28, s55, v28
    v_add_u32 v28, 9664, v28
    s_waitcnt lgkmcnt(4)
    v_mfma_f32_32x32x16_bf16 v[64:79], a[240:243], v[184:187], v[64:79]
    ds_read_b64_tr_b16 a[232:233], v3 offset:1024
    ds_read_b64_tr_b16 a[234:235], v3 offset:29696
    buffer_store_dwordx2 v[52:53], v252, s[28:31], s64 offen offset:2560 sc1
    v_cvt_pk_bf16_f32 v56, v56, v57
    v_mfma_f32_32x32x16_bf16 v[80:95], a[244:247], v[184:187], v[80:95]
    ds_read_b64_tr_b16 a[236:237], v4 offset:1024
    ds_read_b64_tr_b16 a[238:239], v4 offset:29696
    buffer_load_dwordx4 v242, s[12:15], s57 offen offset:2048 lds
    v_cvt_pk_bf16_f32 v57, v58, v59
    v_mfma_f32_32x32x16_bf16 v[64:79], a[248:251], v[188:191], v[64:79]
    ds_read_b64_tr_b16 a[240:241], v1 offset:2048
    ds_read_b64_tr_b16 a[242:243], v1 offset:30720
    v_mul_f32 v60, v246, v60
    v_mul_f32 v61, v246, v61
    v_and_b32 v29, 0xff, v252
    v_add_u32_e64 v29, s55, v29
    v_mfma_f32_32x32x16_bf16 v[80:95], a[252:255], v[188:191], v[80:95]
    ds_read_b64_tr_b16 a[244:245], v2 offset:2048
    ds_read_b64_tr_b16 a[246:247], v2 offset:30720
    buffer_load_dwordx4 v243, s[12:15], s57 offen offset:3072 lds
    s_waitcnt lgkmcnt(4)
    v_mfma_f32_32x32x16_bf16 v[64:79], a[224:227], v[192:195], v[64:79]
    ds_read_b64_tr_b16 a[248:249], v3 offset:2048
    ds_read_b64_tr_b16 a[250:251], v3 offset:30720
    v_mul_f32 v62, v246, v62
    v_mul_f32_e64 v63, v246, v63
    v_add_u32 v30, 114944, v7
    v_mfma_f32_32x32x16_bf16 v[80:95], a[228:231], v[192:195], v[80:95]
    ds_read_b64_tr_b16 a[252:253], v4 offset:2048
    ds_read_b64_tr_b16 a[254:255], v4 offset:30720
    buffer_store_dwordx2 v[56:57], v252, s[28:31], s64 offen offset:3072 sc1
    s_add_u32 m0, s55, 18432
    s_add_u32 s57, s57, 458752
    v_mfma_f32_32x32x16_bf16 v[64:79], a[232:235], v[196:199], v[64:79]
    ds_read_b64_tr_b16 a[224:225], v1 offset:3072
    ds_read_b64_tr_b16 a[226:227], v1 offset:31744
    buffer_load_dwordx4 v240, s[12:15], s57 offen offset:0 lds
    v_cvt_pk_bf16_f32 v60, v60, v61
    v_mfma_f32_32x32x16_bf16 v[80:95], a[236:239], v[196:199], v[80:95]
    ds_read_b64_tr_b16 a[228:229], v2 offset:3072
    ds_read_b64_tr_b16 a[230:231], v2 offset:31744
    v_cvt_pk_bf16_f32 v61, v62, v63
    s_waitcnt lgkmcnt(4)
    s_nop 0
    v_mfma_f32_32x32x16_bf16 v[64:79], a[240:243], v[200:203], v[64:79]
    ds_read_b64_tr_b16 a[232:233], v3 offset:3072
    ds_read_b64_tr_b16 a[234:235], v3 offset:31744
    buffer_load_dwordx4 v241, s[12:15], s57 offen offset:1024 lds
    v_mfma_f32_32x32x16_bf16 v[80:95], a[244:247], v[200:203], v[80:95]
    ds_read_b64_tr_b16 a[236:237], v4 offset:3072
    ds_read_b64_tr_b16 a[238:239], v4 offset:31744
    v_mfma_f32_32x32x16_bf16 v[64:79], a[248:251], v[204:207], v[64:79]
    ds_read_b64_tr_b16 a[240:241], v1 offset:4096
    ds_read_b64_tr_b16 a[242:243], v1 offset:32768
    buffer_store_dwordx2 v[60:61], v252, s[28:31], s64 offen offset:3584 sc1
    v_mfma_f32_32x32x16_bf16 v[80:95], a[252:255], v[204:207], v[80:95]
    ds_read_b64_tr_b16 a[244:245], v2 offset:4096
    ds_read_b64_tr_b16 a[246:247], v2 offset:32768
    buffer_load_dwordx4 v242, s[12:15], s57 offen offset:2048 lds
    s_waitcnt lgkmcnt(4)
    s_nop 0
    v_mfma_f32_32x32x16_bf16 v[64:79], a[224:227], v[208:211], v[64:79]
    ds_read_b64_tr_b16 a[248:249], v3 offset:4096
    ds_read_b64_tr_b16 a[250:251], v3 offset:32768
    v_mfma_f32_32x32x16_bf16 v[80:95], a[228:231], v[208:211], v[80:95]
    ds_read_b64_tr_b16 a[252:253], v4 offset:4096
    ds_read_b64_tr_b16 a[254:255], v4 offset:32768
    v_mfma_f32_32x32x16_bf16 v[64:79], a[232:235], v[212:215], v[64:79]
    ds_read_b64_tr_b16 a[224:225], v1 offset:5120
    ds_read_b64_tr_b16 a[226:227], v1 offset:33792
    v_mfma_f32_32x32x16_bf16 v[80:95], a[236:239], v[212:215], v[80:95]
    ds_read_b64_tr_b16 a[228:229], v2 offset:5120
    ds_read_b64_tr_b16 a[230:231], v2 offset:33792
    s_waitcnt lgkmcnt(4)
    s_nop 0
    v_mfma_f32_32x32x16_bf16 v[64:79], a[240:243], v[216:219], v[64:79]
    ds_read_b64_tr_b16 a[232:233], v3 offset:5120
    ds_read_b64_tr_b16 a[234:235], v3 offset:33792
    v_mfma_f32_32x32x16_bf16 v[80:95], a[244:247], v[216:219], v[80:95]
    ds_read_b64_tr_b16 a[236:237], v4 offset:5120
    ds_read_b64_tr_b16 a[238:239], v4 offset:33792
    v_mfma_f32_32x32x16_bf16 v[64:79], a[248:251], v[220:223], v[64:79]
    ds_read_b64_tr_b16 a[240:241], v1 offset:6144
    ds_read_b64_tr_b16 a[242:243], v1 offset:34816
    v_mfma_f32_32x32x16_bf16 v[80:95], a[252:255], v[220:223], v[80:95]
    ds_read_b64_tr_b16 a[244:245], v2 offset:6144
    ds_read_b64_tr_b16 a[246:247], v2 offset:34816
    s_waitcnt lgkmcnt(4)
    s_nop 0
    v_mfma_f32_32x32x16_bf16 v[64:79], a[224:227], v[224:227], v[64:79]
    ds_read_b64_tr_b16 a[248:249], v3 offset:6144
    ds_read_b64_tr_b16 a[250:251], v3 offset:34816
    v_mfma_f32_32x32x16_bf16 v[80:95], a[228:231], v[224:227], v[80:95]
    ds_read_b64_tr_b16 a[252:253], v4 offset:6144
    ds_read_b64_tr_b16 a[254:255], v4 offset:34816
    s_waitcnt vmcnt(14)
    s_barrier
    v_mfma_f32_32x32x16_bf16 v[64:79], a[232:235], v[228:231], v[64:79]
    ds_read_b64_tr_b16 a[224:225], v1 offset:7168
    ds_read_b64_tr_b16 a[226:227], v1 offset:35840
    s_add_u32 m0, s55, 21504
    s_add_u32 s57, s50, s53
    v_mfma_f32_32x32x16_bf16 v[80:95], a[236:239], v[228:231], v[80:95]
    ds_read_b64_tr_b16 a[228:229], v2 offset:7168
    ds_read_b64_tr_b16 a[230:231], v2 offset:35840
    buffer_load_dwordx4 v240, s[16:19], s57 offen offset:0 lds
    s_waitcnt lgkmcnt(4)
    v_mfma_f32_32x32x16_bf16 v[64:79], a[240:243], v[232:235], v[64:79]
    ds_read_b64_tr_b16 a[232:233], v3 offset:7168
    ds_read_b64_tr_b16 a[234:235], v3 offset:35840
    v_mfma_f32_32x32x16_bf16 v[80:95], a[244:247], v[232:235], v[80:95]
    ds_read_b64_tr_b16 a[236:237], v4 offset:7168
    ds_read_b64_tr_b16 a[238:239], v4 offset:35840
    buffer_load_dwordx4 v241, s[16:19], s57 offen offset:1024 lds
    v_mfma_f32_32x32x16_bf16 v[64:79], a[248:251], v[236:239], v[64:79]
    ds_read_b64_tr_b16 a[240:241], v1 offset:8192
    ds_read_b64_tr_b16 a[242:243], v1 offset:36864
    v_mfma_f32_32x32x16_bf16 v[80:95], a[252:255], v[236:239], v[80:95]
    ds_read_b64_tr_b16 a[244:245], v2 offset:8192
    ds_read_b64_tr_b16 a[246:247], v2 offset:36864
    buffer_load_dwordx4 v242, s[16:19], s57 offen offset:2048 lds
    s_waitcnt lgkmcnt(4)
    s_nop 0
    v_mfma_f32_32x32x16_bf16 v[32:47], a[224:227], v[128:131], 0
    ds_read_b64_tr_b16 a[248:249], v3 offset:8192
    ds_read_b64_tr_b16 a[250:251], v3 offset:36864
    v_mfma_f32_32x32x16_bf16 v[48:63], a[228:231], v[128:131], 0
    ds_read_b64_tr_b16 a[252:253], v4 offset:8192
    ds_read_b64_tr_b16 a[254:255], v4 offset:36864
    buffer_load_dwordx4 v243, s[16:19], s57 offen offset:3072 lds
    v_mfma_f32_32x32x16_bf16 v[32:47], a[232:235], v[132:135], v[32:47]
    ds_read_b64_tr_b16 a[224:225], v1 offset:9216
    ds_read_b64_tr_b16 a[226:227], v1 offset:37888
    s_add_u32 m0, s55, 25600
    s_add_u32 s57, s57, 458752
    v_mfma_f32_32x32x16_bf16 v[48:63], a[236:239], v[132:135], v[48:63]
    ds_read_b64_tr_b16 a[228:229], v2 offset:9216
    ds_read_b64_tr_b16 a[230:231], v2 offset:37888
    buffer_load_dwordx4 v240, s[16:19], s57 offen offset:0 lds
    v_mul_f32_e64 v246, s68, v253
    v_mul_f32 v64, v246, v64
    s_waitcnt lgkmcnt(4)
    v_mfma_f32_32x32x16_bf16 v[32:47], a[240:243], v[136:139], v[32:47]
    ds_read_b64_tr_b16 a[232:233], v3 offset:9216
    ds_read_b64_tr_b16 a[234:235], v3 offset:37888
    v_mul_f32 v65, v246, v65
    v_mul_f32 v66, v246, v66
    v_mul_f32_e64 v67, v246, v67
    v_cvt_pk_bf16_f32 v64, v64, v65
    v_cvt_pk_bf16_f32 v65, v66, v67
    v_mul_f32 v68, v246, v68
    v_mul_f32 v69, v246, v69
    v_mfma_f32_32x32x16_bf16 v[48:63], a[244:247], v[136:139], v[48:63]
    ds_read_b64_tr_b16 a[236:237], v4 offset:9216
    ds_read_b64_tr_b16 a[238:239], v4 offset:37888
    buffer_store_dwordx2 v[64:65], v252, s[28:31], s65 offen offset:0 sc1
    v_mul_f32 v70, v246, v70
    v_mul_f32 v71, v246, v71
    v_cvt_pk_bf16_f32 v68, v68, v69
    v_cvt_pk_bf16_f32 v69, v70, v71
    v_mfma_f32_32x32x16_bf16 v[32:47], a[248:251], v[140:143], v[32:47]
    ds_read_b64_tr_b16 a[240:241], v1 offset:10240
    ds_read_b64_tr_b16 a[242:243], v1 offset:38912
    buffer_store_dwordx2 v[68:69], v252, s[28:31], s65 offen offset:512 sc1
    v_mul_f32 v72, v246, v72
    v_mul_f32 v73, v246, v73
    v_mfma_f32_32x32x16_bf16 v[48:63], a[252:255], v[140:143], v[48:63]
    ds_read_b64_tr_b16 a[244:245], v2 offset:10240
    ds_read_b64_tr_b16 a[246:247], v2 offset:38912
    buffer_load_dwordx4 v241, s[16:19], s57 offen offset:1024 lds
    v_mul_f32 v74, v246, v74
    s_waitcnt lgkmcnt(4)
    v_mfma_f32_32x32x16_bf16 v[32:47], a[224:227], v[144:147], v[32:47]
    ds_read_b64_tr_b16 a[248:249], v3 offset:10240
    ds_read_b64_tr_b16 a[250:251], v3 offset:38912
    s_waitcnt vmcnt(9)
    buffer_store_dword v255, v0, s[28:31], s70 offen sc1
    v_mul_f32 v75, v246, v75
    v_mfma_f32_32x32x16_bf16 v[48:63], a[228:231], v[144:147], v[48:63]
    ds_read_b64_tr_b16 a[252:253], v4 offset:10240
    ds_read_b64_tr_b16 a[254:255], v4 offset:38912
    v_cvt_pk_bf16_f32 v72, v72, v73
    v_cvt_pk_bf16_f32 v73, v74, v75
    v_mul_f32 v76, v246, v76
    v_mul_f32 v77, v246, v77
    v_mul_f32_e64 v78, v246, v78
    v_mfma_f32_32x32x16_bf16 v[32:47], a[232:235], v[148:151], v[32:47]
    ds_read_b64_tr_b16 a[224:225], v1 offset:11264
    ds_read_b64_tr_b16 a[226:227], v1 offset:39936
    buffer_store_dwordx2 v[72:73], v252, s[28:31], s65 offen offset:1024 sc1
    v_mul_f32_e64 v79, v246, v79
    v_cvt_pk_bf16_f32 v76, v76, v77
    v_cvt_pk_bf16_f32 v77, v78, v79
    v_mfma_f32_32x32x16_bf16 v[48:63], a[236:239], v[148:151], v[48:63]
    ds_read_b64_tr_b16 a[228:229], v2 offset:11264
    ds_read_b64_tr_b16 a[230:231], v2 offset:39936
    buffer_store_dwordx2 v[76:77], v252, s[28:31], s65 offen offset:1536 sc1
    v_mul_f32 v80, v246, v80
    s_waitcnt lgkmcnt(4)
    v_mfma_f32_32x32x16_bf16 v[32:47], a[240:243], v[152:155], v[32:47]
    ds_read_b64_tr_b16 a[232:233], v3 offset:11264
    ds_read_b64_tr_b16 a[234:235], v3 offset:39936
    buffer_load_dwordx4 v242, s[16:19], s57 offen offset:2048 lds
    v_mul_f32 v81, v246, v81
    v_mul_f32 v82, v246, v82
    v_mfma_f32_32x32x16_bf16 v[48:63], a[244:247], v[152:155], v[48:63]
    ds_read_b64_tr_b16 a[236:237], v4 offset:11264
    ds_read_b64_tr_b16 a[238:239], v4 offset:39936
    v_mul_f32_e64 v83, v246, v83
    v_cvt_pk_bf16_f32 v80, v80, v81
    v_cvt_pk_bf16_f32 v81, v82, v83
    v_mul_f32_e64 v84, v246, v84
    v_mfma_f32_32x32x16_bf16 v[32:47], a[248:251], v[156:159], v[32:47]
    ds_read_b64_tr_b16 a[240:241], v1 offset:12288
    ds_read_b64_tr_b16 a[242:243], v1 offset:40960
    buffer_store_dwordx2 v[80:81], v252, s[28:31], s65 offen offset:2048 sc1
    v_mul_f32 v85, v246, v85
    v_mul_f32 v86, v246, v86
    v_mfma_f32_32x32x16_bf16 v[48:63], a[252:255], v[156:159], v[48:63]
    ds_read_b64_tr_b16 a[244:245], v2 offset:12288
    ds_read_b64_tr_b16 a[246:247], v2 offset:40960
    v_mul_f32 v87, v246, v87
    v_cvt_pk_bf16_f32 v84, v84, v85
    v_cvt_pk_bf16_f32 v85, v86, v87
    s_waitcnt lgkmcnt(4)
    v_mfma_f32_32x32x16_bf16 v[32:47], a[224:227], v[160:163], v[32:47]
    ds_read_b64_tr_b16 a[248:249], v3 offset:12288
    ds_read_b64_tr_b16 a[250:251], v3 offset:40960
    buffer_store_dwordx2 v[84:85], v252, s[28:31], s65 offen offset:2560 sc1
    v_mul_f32_e64 v88, v246, v88
    v_mfma_f32_32x32x16_bf16 v[48:63], a[228:231], v[160:163], v[48:63]
    ds_read_b64_tr_b16 a[252:253], v4 offset:12288
    ds_read_b64_tr_b16 a[254:255], v4 offset:40960
    v_mul_f32 v89, v246, v89
    v_mul_f32 v90, v246, v90
    v_mul_f32_e64 v91, v246, v91
    v_cvt_pk_bf16_f32 v88, v88, v89
    v_mfma_f32_32x32x16_bf16 v[32:47], a[232:235], v[164:167], v[32:47]
    ds_read_b64_tr_b16 a[224:225], v1 offset:13312
    ds_read_b64_tr_b16 a[226:227], v1 offset:41984
    v_cvt_pk_bf16_f32 v89, v90, v91
    v_mul_f32 v92, v246, v92
    v_mul_f32 v93, v246, v93
    v_mul_f32_e64 v94, v246, v94
    v_mfma_f32_32x32x16_bf16 v[48:63], a[236:239], v[164:167], v[48:63]
    ds_read_b64_tr_b16 a[228:229], v2 offset:13312
    ds_read_b64_tr_b16 a[230:231], v2 offset:41984
    buffer_store_dwordx2 v[88:89], v252, s[28:31], s65 offen offset:3072 sc1
    s_waitcnt lgkmcnt(4)
    v_mfma_f32_32x32x16_bf16 v[32:47], a[240:243], v[168:171], v[32:47]
    ds_read_b64_tr_b16 a[232:233], v3 offset:13312
    ds_read_b64_tr_b16 a[234:235], v3 offset:41984
    v_mul_f32 v95, v246, v95
    v_cvt_pk_bf16_f32 v92, v92, v93
    v_cvt_pk_bf16_f32 v93, v94, v95
    v_mfma_f32_32x32x16_bf16 v[48:63], a[244:247], v[168:171], v[48:63]
    ds_read_b64_tr_b16 a[236:237], v4 offset:13312
    ds_read_b64_tr_b16 a[238:239], v4 offset:41984
    s_waitcnt vmcnt(15)
    s_barrier
    v_mfma_f32_32x32x16_bf16 v[32:47], a[248:251], v[172:175], v[32:47]
    ds_read_b64_tr_b16 a[240:241], v1 offset:14336
    ds_read_b64_tr_b16 a[242:243], v1 offset:43008
    buffer_store_dwordx2 v[92:93], v252, s[28:31], s65 offen offset:3584 sc1
    s_add_u32 m0, s55, 0
    s_add_u32 s57, s50, s54
    v_mfma_f32_32x32x16_bf16 v[48:63], a[252:255], v[172:175], v[48:63]
    ds_read_b64_tr_b16 a[244:245], v2 offset:14336
    ds_read_b64_tr_b16 a[246:247], v2 offset:43008
    buffer_load_dwordx4 v240, s[16:19], s57 offen offset:0 lds
    s_waitcnt lgkmcnt(4)
    s_nop 0
    v_mfma_f32_32x32x16_bf16 v[32:47], a[224:227], v[176:179], v[32:47]
    ds_read_b64_tr_b16 a[248:249], v3 offset:14336
    ds_read_b64_tr_b16 a[250:251], v3 offset:43008
    v_mfma_f32_32x32x16_bf16 v[48:63], a[228:231], v[176:179], v[48:63]
    ds_read_b64_tr_b16 a[252:253], v4 offset:14336
    ds_read_b64_tr_b16 a[254:255], v4 offset:43008
    buffer_load_dwordx4 v241, s[16:19], s57 offen offset:1024 lds
    v_mfma_f32_32x32x16_bf16 v[32:47], a[232:235], v[180:183], v[32:47]
    ds_read_b64_tr_b16 a[224:225], v1 offset:15360
    ds_read_b64_tr_b16 a[226:227], v1 offset:44032
    v_mfma_f32_32x32x16_bf16 v[48:63], a[236:239], v[180:183], v[48:63]
    ds_read_b64_tr_b16 a[228:229], v2 offset:15360
    ds_read_b64_tr_b16 a[230:231], v2 offset:44032
    buffer_load_dwordx4 v242, s[16:19], s57 offen offset:2048 lds
    s_waitcnt lgkmcnt(4)
    s_nop 0
    v_mfma_f32_32x32x16_bf16 v[32:47], a[240:243], v[184:187], v[32:47]
    ds_read_b64_tr_b16 a[232:233], v3 offset:15360
    ds_read_b64_tr_b16 a[234:235], v3 offset:44032
    v_mfma_f32_32x32x16_bf16 v[48:63], a[244:247], v[184:187], v[48:63]
    ds_read_b64_tr_b16 a[236:237], v4 offset:15360
    ds_read_b64_tr_b16 a[238:239], v4 offset:44032
    buffer_load_dwordx4 v243, s[16:19], s57 offen offset:3072 lds
    v_mfma_f32_32x32x16_bf16 v[32:47], a[248:251], v[188:191], v[32:47]
    ds_read_b64_tr_b16 a[240:241], v1 offset:16384
    ds_read_b64_tr_b16 a[242:243], v1 offset:45056
    s_add_u32 m0, s55, 4096
    s_add_u32 s57, s57, 458752
    v_mfma_f32_32x32x16_bf16 v[48:63], a[252:255], v[188:191], v[48:63]
    ds_read_b64_tr_b16 a[244:245], v2 offset:16384
    ds_read_b64_tr_b16 a[246:247], v2 offset:45056
    buffer_load_dwordx4 v240, s[16:19], s57 offen offset:0 lds
    s_waitcnt lgkmcnt(4)
    s_nop 0
    v_mfma_f32_32x32x16_bf16 v[32:47], a[224:227], v[192:195], v[32:47]
    ds_read_b64_tr_b16 a[248:249], v3 offset:16384
    ds_read_b64_tr_b16 a[250:251], v3 offset:45056
    v_mfma_f32_32x32x16_bf16 v[48:63], a[228:231], v[192:195], v[48:63]
    ds_read_b64_tr_b16 a[252:253], v4 offset:16384
    ds_read_b64_tr_b16 a[254:255], v4 offset:45056
    buffer_load_dwordx4 v241, s[16:19], s57 offen offset:1024 lds
    v_mfma_f32_32x32x16_bf16 v[32:47], a[232:235], v[196:199], v[32:47]
    ds_read_b64_tr_b16 a[224:225], v1 offset:17408
    ds_read_b64_tr_b16 a[226:227], v1 offset:46080
    v_mfma_f32_32x32x16_bf16 v[48:63], a[236:239], v[196:199], v[48:63]
    ds_read_b64_tr_b16 a[228:229], v2 offset:17408
    ds_read_b64_tr_b16 a[230:231], v2 offset:46080
    buffer_load_dwordx4 v242, s[16:19], s57 offen offset:2048 lds
    s_waitcnt lgkmcnt(4)
    s_nop 0
    v_mfma_f32_32x32x16_bf16 v[32:47], a[240:243], v[200:203], v[32:47]
    ds_read_b64_tr_b16 a[232:233], v3 offset:17408
    ds_read_b64_tr_b16 a[234:235], v3 offset:46080
    v_mfma_f32_32x32x16_bf16 v[48:63], a[244:247], v[200:203], v[48:63]
    ds_read_b64_tr_b16 a[236:237], v4 offset:17408
    ds_read_b64_tr_b16 a[238:239], v4 offset:46080
    v_mfma_f32_32x32x16_bf16 v[32:47], a[248:251], v[204:207], v[32:47]
    ds_read_b64_tr_b16 a[240:241], v1 offset:18432
    ds_read_b64_tr_b16 a[242:243], v1 offset:47104
    v_mfma_f32_32x32x16_bf16 v[48:63], a[252:255], v[204:207], v[48:63]
    ds_read_b64_tr_b16 a[244:245], v2 offset:18432
    ds_read_b64_tr_b16 a[246:247], v2 offset:47104
    s_waitcnt lgkmcnt(4)
    s_nop 0
    v_mfma_f32_32x32x16_bf16 v[32:47], a[224:227], v[208:211], v[32:47]
    ds_read_b64_tr_b16 a[248:249], v3 offset:18432
    ds_read_b64_tr_b16 a[250:251], v3 offset:47104
    v_mfma_f32_32x32x16_bf16 v[48:63], a[228:231], v[208:211], v[48:63]
    ds_read_b64_tr_b16 a[252:253], v4 offset:18432
    ds_read_b64_tr_b16 a[254:255], v4 offset:47104
    v_mfma_f32_32x32x16_bf16 v[32:47], a[232:235], v[212:215], v[32:47]
    ds_read_b64_tr_b16 a[224:225], v1 offset:19456
    ds_read_b64_tr_b16 a[226:227], v1 offset:48128
    v_mfma_f32_32x32x16_bf16 v[48:63], a[236:239], v[212:215], v[48:63]
    ds_read_b64_tr_b16 a[228:229], v2 offset:19456
    ds_read_b64_tr_b16 a[230:231], v2 offset:48128
    s_waitcnt lgkmcnt(4)
    s_nop 0
    v_mfma_f32_32x32x16_bf16 v[32:47], a[240:243], v[216:219], v[32:47]
    ds_read_b64_tr_b16 a[232:233], v3 offset:19456
    ds_read_b64_tr_b16 a[234:235], v3 offset:48128
    v_mfma_f32_32x32x16_bf16 v[48:63], a[244:247], v[216:219], v[48:63]
    ds_read_b64_tr_b16 a[236:237], v4 offset:19456
    ds_read_b64_tr_b16 a[238:239], v4 offset:48128
    v_mfma_f32_32x32x16_bf16 v[32:47], a[248:251], v[220:223], v[32:47]
    ds_read_b64_tr_b16 a[240:241], v1 offset:20480
    ds_read_b64_tr_b16 a[242:243], v1 offset:49152
    v_mfma_f32_32x32x16_bf16 v[48:63], a[252:255], v[220:223], v[48:63]
    ds_read_b64_tr_b16 a[244:245], v2 offset:20480
    ds_read_b64_tr_b16 a[246:247], v2 offset:49152
    s_waitcnt lgkmcnt(4)
    v_mfma_f32_32x32x16_bf16 v[32:47], a[224:227], v[224:227], v[32:47]
    ds_read_b64_tr_b16 a[248:249], v3 offset:20480
    ds_read_b64_tr_b16 a[250:251], v3 offset:49152
    s_waitcnt vmcnt(7)
    buffer_store_dword v255, v0, s[28:31], s71 offen sc1
    v_mfma_f32_32x32x16_bf16 v[48:63], a[228:231], v[224:227], v[48:63]
    ds_read_b64_tr_b16 a[252:253], v4 offset:20480
    ds_read_b64_tr_b16 a[254:255], v4 offset:49152
    s_barrier
    v_mfma_f32_32x32x16_bf16 v[32:47], a[232:235], v[228:231], v[32:47]
    ds_read_b64_tr_b16 a[224:225], v1 offset:21504
    ds_read_b64_tr_b16 a[226:227], v1 offset:50176
    v_mfma_f32_32x32x16_bf16 v[48:63], a[236:239], v[228:231], v[48:63]
    ds_read_b64_tr_b16 a[228:229], v2 offset:21504
    ds_read_b64_tr_b16 a[230:231], v2 offset:50176
    s_waitcnt lgkmcnt(4)
    v_mfma_f32_32x32x16_bf16 v[32:47], a[240:243], v[232:235], v[32:47]
    ds_read_b64_tr_b16 a[232:233], v3 offset:21504
    ds_read_b64_tr_b16 a[234:235], v3 offset:50176
    v_mfma_f32_32x32x16_bf16 v[48:63], a[244:247], v[232:235], v[48:63]
    ds_read_b64_tr_b16 a[236:237], v4 offset:21504
    ds_read_b64_tr_b16 a[238:239], v4 offset:50176
    v_mfma_f32_32x32x16_bf16 v[32:47], a[248:251], v[236:239], v[32:47]
    ds_read_b64_tr_b16 a[240:241], v1 offset:22528
    ds_read_b64_tr_b16 a[242:243], v1 offset:51200
    v_mfma_f32_32x32x16_bf16 v[48:63], a[252:255], v[236:239], v[48:63]
    ds_read_b64_tr_b16 a[244:245], v2 offset:22528
    ds_read_b64_tr_b16 a[246:247], v2 offset:51200
    s_waitcnt lgkmcnt(4)
    s_nop 0
    v_mfma_f32_32x32x16_bf16 v[96:111], a[224:227], v[128:131], 0
    ds_read_b64_tr_b16 a[248:249], v3 offset:22528
    ds_read_b64_tr_b16 a[250:251], v3 offset:51200
    buffer_load_dword v247, v244, s[28:31], 0 offen sc1
    v_mfma_f32_32x32x16_bf16 v[112:127], a[228:231], v[128:131], 0
    ds_read_b64_tr_b16 a[252:253], v4 offset:22528
    ds_read_b64_tr_b16 a[254:255], v4 offset:51200
    v_lshrrev_b32 v72, 9, v7
    v_lshlrev_b32 v72, 2, v72
    v_bfe_u32 v73, v7, 4, 5
    v_sub_u32_e64 v72, v73, v72
    v_mfma_f32_32x32x16_bf16 v[96:111], a[232:235], v[132:135], v[96:111]
    ds_read_b64_tr_b16 a[224:225], v1 offset:23552
    ds_read_b64_tr_b16 a[226:227], v1 offset:52224
    v_cmp_le_i32 s[8:9], 0, v72
    v_cmp_le_i32 s[10:11], 1, v72
    v_cmp_le_i32 s[12:13], 2, v72
    v_cmp_le_i32 s[14:15], 3, v72
    v_mfma_f32_32x32x16_bf16 v[112:127], a[236:239], v[132:135], v[112:127]
    ds_read_b64_tr_b16 a[228:229], v2 offset:23552
    ds_read_b64_tr_b16 a[230:231], v2 offset:52224
    v_cmp_le_i32 s[16:17], 8, v72
    v_cmp_le_i32 s[18:19], 9, v72
    v_cmp_le_i32 s[36:37], 10, v72
    s_waitcnt lgkmcnt(4)
    s_nop 0
    v_mfma_f32_32x32x16_bf16 v[96:111], a[240:243], v[136:139], v[96:111]
    ds_read_b64_tr_b16 a[232:233], v3 offset:23552
    ds_read_b64_tr_b16 a[234:235], v3 offset:52224
    v_cmp_le_i32 s[38:39], 11, v72
    v_cmp_le_i32 s[46:47], 16, v72
    v_cmp_le_i32 s[48:49], 17, v72
    v_cmp_le_i32 s[50:51], 18, v72
    v_mfma_f32_32x32x16_bf16 v[112:127], a[244:247], v[136:139], v[112:127]
    ds_read_b64_tr_b16 a[236:237], v4 offset:23552
    ds_read_b64_tr_b16 a[238:239], v4 offset:52224
    v_cmp_le_i32 s[52:53], 19, v72
    v_cmp_le_i32 s[64:65], 24, v72
    v_cmp_le_i32 s[66:67], 25, v72
    v_cmp_le_i32 s[68:69], 26, v72
    v_mfma_f32_32x32x16_bf16 v[96:111], a[248:251], v[140:143], v[96:111]
    ds_read_b64_tr_b16 a[240:241], v1 offset:24576
    ds_read_b64_tr_b16 a[242:243], v1 offset:53248
    v_cmp_le_i32 s[76:77], 27, v72
    v_mov_b32 v240, 0x3f803f80
    v_mov_b32 v241, 0x3f803f80
    v_mov_b32 v242, 0x3f803f80
    v_mfma_f32_32x32x16_bf16 v[112:127], a[252:255], v[140:143], v[112:127]
    ds_read_b64_tr_b16 a[244:245], v2 offset:24576
    ds_read_b64_tr_b16 a[246:247], v2 offset:53248
    v_mov_b32 v243, 0x3f803f80
    v_mov_b32_e64 v74, s86
    v_mov_b32 v75, s87
    s_waitcnt lgkmcnt(4)
    v_mfma_f32_32x32x16_bf16 v[96:111], a[224:227], v[144:147], v[96:111]
    ds_read_b64_tr_b16 a[248:249], v3 offset:24576
    ds_read_b64_tr_b16 a[250:251], v3 offset:53248
    v_mov_b32 v76, s88
    v_mov_b32 v77, 0x3f80
    v_readfirstlane_b32 s100, v255
    v_mfma_f32_32x32x16_bf16 v[112:127], a[228:231], v[144:147], v[112:127]
    ds_read_b64_tr_b16 a[252:253], v4 offset:24576
    ds_read_b64_tr_b16 a[254:255], v4 offset:53248
    s_cmp_lt_u32 s41, 28
    s_cselect_b32 s78, 0x3f, 0
    s_mov_b32 s79, 0
    v_mfma_f32_32x32x16_bf16 v[96:111], a[232:235], v[148:151], v[96:111]
    ds_read_b64_tr_b16 a[224:225], v1 offset:25600
    ds_read_b64_tr_b16 a[226:227], v1 offset:54272
    v_mfma_f32_32x32x16_bf16 v[112:127], a[236:239], v[148:151], v[112:127]
    ds_read_b64_tr_b16 a[228:229], v2 offset:25600
    ds_read_b64_tr_b16 a[230:231], v2 offset:54272
    s_waitcnt lgkmcnt(4)
    v_mfma_f32_32x32x16_bf16 v[96:111], a[240:243], v[152:155], v[96:111]
    ds_read_b64_tr_b16 a[232:233], v3 offset:25600
    ds_read_b64_tr_b16 a[234:235], v3 offset:54272
    v_mfma_f32_32x32x16_bf16 v[112:127], a[244:247], v[152:155], v[112:127]
    ds_read_b64_tr_b16 a[236:237], v4 offset:25600
    ds_read_b64_tr_b16 a[238:239], v4 offset:54272
    v_mfma_f32_32x32x16_bf16 v[96:111], a[248:251], v[156:159], v[96:111]
    ds_read_b64_tr_b16 a[240:241], v1 offset:26624
    ds_read_b64_tr_b16 a[242:243], v1 offset:55296
    v_mfma_f32_32x32x16_bf16 v[112:127], a[252:255], v[156:159], v[112:127]
    ds_read_b64_tr_b16 a[244:245], v2 offset:26624
    ds_read_b64_tr_b16 a[246:247], v2 offset:55296
    s_waitcnt lgkmcnt(4)
    s_nop 0
    v_mfma_f32_32x32x16_bf16 v[96:111], a[224:227], v[160:163], v[96:111]
    ds_read_b64_tr_b16 a[248:249], v3 offset:26624
    ds_read_b64_tr_b16 a[250:251], v3 offset:55296
    v_mfma_f32_32x32x16_bf16 v[112:127], a[228:231], v[160:163], v[112:127]
    ds_read_b64_tr_b16 a[252:253], v4 offset:26624
    ds_read_b64_tr_b16 a[254:255], v4 offset:55296
    v_mfma_f32_32x32x16_bf16 v[96:111], a[232:235], v[164:167], v[96:111]
    ds_read_b64_tr_b16 a[224:225], v1 offset:27648
    ds_read_b64_tr_b16 a[226:227], v1 offset:56320
    v_mfma_f32_32x32x16_bf16 v[112:127], a[236:239], v[164:167], v[112:127]
    ds_read_b64_tr_b16 a[228:229], v2 offset:27648
    ds_read_b64_tr_b16 a[230:231], v2 offset:56320
    s_waitcnt lgkmcnt(4)
    s_nop 0
    v_mfma_f32_32x32x16_bf16 v[96:111], a[240:243], v[168:171], v[96:111]
    ds_read_b64_tr_b16 a[232:233], v3 offset:27648
    ds_read_b64_tr_b16 a[234:235], v3 offset:56320
    v_mfma_f32_32x32x16_bf16 v[112:127], a[244:247], v[168:171], v[112:127]
    ds_read_b64_tr_b16 a[236:237], v4 offset:27648
    ds_read_b64_tr_b16 a[238:239], v4 offset:56320
    s_waitcnt vmcnt(2)
    s_barrier
    v_mfma_f32_32x32x16_bf16 v[96:111], a[248:251], v[172:175], v[96:111]
    ds_read_b64_tr_b16 a[240:241], v1 offset:0
    ds_read_b64_tr_b16 a[242:243], v1 offset:28672
    v_mfma_f32_32x32x16_bf16 v[112:127], a[252:255], v[172:175], v[112:127]
    ds_read_b64_tr_b16 a[244:245], v2 offset:0
    ds_read_b64_tr_b16 a[246:247], v2 offset:28672
    s_waitcnt lgkmcnt(4)
    v_mfma_f32_32x32x16_bf16 v[96:111], a[224:227], v[176:179], v[96:111]
    ds_read_b64_tr_b16 a[248:249], v3 offset:0
    ds_read_b64_tr_b16 a[250:251], v3 offset:28672
    s_waitcnt vmcnt(0)
    v_cmp_ne_u32_e64 vcc, v247, v255
    s_and_b64 vcc, vcc, s[90:91]
    s_cbranch_vccnz Lslow_15
Lback_16:
    v_mfma_f32_32x32x16_bf16 v[112:127], a[228:231], v[176:179], v[112:127]
    ds_read_b64_tr_b16 a[252:253], v4 offset:0
    ds_read_b64_tr_b16 a[254:255], v4 offset:28672
    s_add_u32 m0, s55, 7168
    v_mfma_f32_32x32x16_bf16 v[96:111], a[232:235], v[180:183], v[96:111]
    ds_read_b64_tr_b16 a[224:225], v1 offset:1024
    ds_read_b64_tr_b16 a[226:227], v1 offset:29696
    buffer_load_dwordx4 v7, s[28:31], s80 offen sc1 lds
    v_mfma_f32_32x32x16_bf16 v[112:127], a[236:239], v[180:183], v[112:127]
    ds_read_b64_tr_b16 a[228:229], v2 offset:1024
    ds_read_b64_tr_b16 a[230:231], v2 offset:29696
    buffer_load_dwordx4 v22, s[28:31], s80 offen offset:1024 sc1 lds
    s_waitcnt lgkmcnt(4)
    s_nop 0
    v_mfma_f32_32x32x16_bf16 v[96:111], a[240:243], v[184:187], v[96:111]
    ds_read_b64_tr_b16 a[232:233], v3 offset:1024
    ds_read_b64_tr_b16 a[234:235], v3 offset:29696
    s_add_u32 m0, s55, 11264
    v_mfma_f32_32x32x16_bf16 v[112:127], a[244:247], v[184:187], v[112:127]
    ds_read_b64_tr_b16 a[236:237], v4 offset:1024
    ds_read_b64_tr_b16 a[238:239], v4 offset:29696
    buffer_load_dwordx4 v7, s[28:31], s82 offen sc1 lds
    v_mfma_f32_32x32x16_bf16 v[96:111], a[248:251], v[188:191], v[96:111]
    ds_read_b64_tr_b16 a[240:241], v1 offset:2048
    ds_read_b64_tr_b16 a[242:243], v1 offset:30720
    v_mfma_f32_32x32x16_bf16 v[112:127], a[252:255], v[188:191], v[112:127]
    ds_read_b64_tr_b16 a[244:245], v2 offset:2048
    ds_read_b64_tr_b16 a[246:247], v2 offset:30720
    buffer_load_dwordx4 v22, s[28:31], s82 offen offset:1024 sc1 lds
    s_waitcnt lgkmcnt(4)
    s_nop 0
    v_mfma_f32_32x32x16_bf16 v[96:111], a[224:227], v[192:195], v[96:111]
    ds_read_b64_tr_b16 a[248:249], v3 offset:2048
    ds_read_b64_tr_b16 a[250:251], v3 offset:30720
    s_add_u32 m0, s55, 15360
    v_mfma_f32_32x32x16_bf16 v[112:127], a[228:231], v[192:195], v[112:127]
    ds_read_b64_tr_b16 a[252:253], v4 offset:2048
    ds_read_b64_tr_b16 a[254:255], v4 offset:30720
    buffer_load_dwordx4 v7, s[28:31], s84 offen sc1 lds
    v_mfma_f32_32x32x16_bf16 v[96:111], a[232:235], v[196:199], v[96:111]
    ds_read_b64_tr_b16 a[224:225], v1 offset:3072
    ds_read_b64_tr_b16 a[226:227], v1 offset:31744
    v_mfma_f32_32x32x16_bf16 v[112:127], a[236:239], v[196:199], v[112:127]
    ds_read_b64_tr_b16 a[228:229], v2 offset:3072
    ds_read_b64_tr_b16 a[230:231], v2 offset:31744
    buffer_load_dwordx4 v22, s[28:31], s84 offen offset:1024 sc1 lds
    s_waitcnt lgkmcnt(4)
    s_nop 0
    v_mfma_f32_32x32x16_bf16 v[96:111], a[240:243], v[200:203], v[96:111]
    ds_read_b64_tr_b16 a[232:233], v3 offset:3072
    ds_read_b64_tr_b16 a[234:235], v3 offset:31744
    buffer_load_dwordx2 v[64:65], v252, s[28:31], s96 offen offset:0 sc1
    v_mfma_f32_32x32x16_bf16 v[112:127], a[244:247], v[200:203], v[112:127]
    ds_read_b64_tr_b16 a[236:237], v4 offset:3072
    ds_read_b64_tr_b16 a[238:239], v4 offset:31744
    buffer_load_dwordx2 v[66:67], v252, s[28:31], s96 offen offset:512 sc1
    v_mfma_f32_32x32x16_bf16 v[96:111], a[248:251], v[204:207], v[96:111]
    ds_read_b64_tr_b16 a[240:241], v1 offset:4096
    ds_read_b64_tr_b16 a[242:243], v1 offset:32768
    buffer_load_dwordx2 v[68:69], v252, s[28:31], s96 offen offset:1024 sc1
    v_mfma_f32_32x32x16_bf16 v[112:127], a[252:255], v[204:207], v[112:127]
    ds_read_b64_tr_b16 a[244:245], v2 offset:4096
    ds_read_b64_tr_b16 a[246:247], v2 offset:32768
    buffer_load_dwordx2 v[70:71], v25, s[28:31], s96 offen offset:1536 sc1
    s_add_u32 m0, s55, 9216
    s_waitcnt lgkmcnt(4)
    s_nop 0
    v_mfma_f32_32x32x16_bf16 v[96:111], a[224:227], v[208:211], v[96:111]
    ds_read_b64_tr_b16 a[248:249], v3 offset:4096
    ds_read_b64_tr_b16 a[250:251], v3 offset:32768
    buffer_load_dwordx4 v23, s[28:31], s81 offen sc1 lds
    v_mfma_f32_32x32x16_bf16 v[112:127], a[228:231], v[208:211], v[112:127]
    ds_read_b64_tr_b16 a[252:253], v4 offset:4096
    ds_read_b64_tr_b16 a[254:255], v4 offset:32768
    v_mfma_f32_32x32x16_bf16 v[96:111], a[232:235], v[212:215], v[96:111]
    ds_read_b64_tr_b16 a[224:225], v1 offset:5120
    ds_read_b64_tr_b16 a[226:227], v1 offset:33792
    buffer_load_dwordx4 v24, s[28:31], s81 offen offset:1024 sc1 lds
    v_mfma_f32_32x32x16_bf16 v[112:127], a[236:239], v[212:215], v[112:127]
    ds_read_b64_tr_b16 a[228:229], v2 offset:5120
    ds_read_b64_tr_b16 a[230:231], v2 offset:33792
    s_add_u32 m0, s55, 13312
    s_waitcnt lgkmcnt(4)
    s_nop 0
    v_mfma_f32_32x32x16_bf16 v[96:111], a[240:243], v[216:219], v[96:111]
    ds_read_b64_tr_b16 a[232:233], v3 offset:5120
    ds_read_b64_tr_b16 a[234:235], v3 offset:33792
    buffer_load_dwordx4 v23, s[28:31], s83 offen sc1 lds
    v_mfma_f32_32x32x16_bf16 v[112:127], a[244:247], v[216:219], v[112:127]
    ds_read_b64_tr_b16 a[236:237], v4 offset:5120
    ds_read_b64_tr_b16 a[238:239], v4 offset:33792
    buffer_load_dwordx4 v24, s[28:31], s83 offen offset:1024 sc1 lds
    v_mfma_f32_32x32x16_bf16 v[96:111], a[248:251], v[220:223], v[96:111]
    ds_read_b64_tr_b16 a[240:241], v1 offset:6144
    ds_read_b64_tr_b16 a[242:243], v1 offset:34816
    s_add_u32 m0, s55, 17408
    v_mfma_f32_32x32x16_bf16 v[112:127], a[252:255], v[220:223], v[112:127]
    ds_read_b64_tr_b16 a[244:245], v2 offset:6144
    ds_read_b64_tr_b16 a[246:247], v2 offset:34816
    buffer_load_dwordx4 v23, s[28:31], s85 offen sc1 lds
    s_waitcnt lgkmcnt(4)
    s_nop 0
    v_mfma_f32_32x32x16_bf16 v[96:111], a[224:227], v[224:227], v[96:111]
    ds_read_b64_tr_b16 a[248:249], v3 offset:6144
    ds_read_b64_tr_b16 a[250:251], v3 offset:34816
    buffer_load_dwordx4 v24, s[28:31], s85 offen offset:1024 sc1 lds
    v_mfma_f32_32x32x16_bf16 v[112:127], a[228:231], v[224:227], v[112:127]
    ds_read_b64_tr_b16 a[252:253], v4 offset:6144
    ds_read_b64_tr_b16 a[254:255], v4 offset:34816
    v_mfma_f32_32x32x16_bf16 v[96:111], a[232:235], v[228:231], v[96:111]
    v_mfma_f32_32x32x16_bf16 v[112:127], a[236:239], v[228:231], v[112:127]
    s_waitcnt lgkmcnt(0)
    s_nop 0
    v_mfma_f32_32x32x16_bf16 v[96:111], a[240:243], v[232:235], v[96:111]
    v_mfma_f32_32x32x16_bf16 v[112:127], a[244:247], v[232:235], v[112:127]
    v_mfma_f32_32x32x16_bf16 v[96:111], a[248:251], v[236:239], v[96:111]
    v_mfma_f32_32x32x16_bf16 v[112:127], a[252:255], v[236:239], v[112:127]
L_att:
    buffer_load_dword v247, v26, s[28:31], 0 offen sc1
    v_cmp_gt_u32 vcc, 0x200, v7
    s_mov_b32 s101, s100
    v_add_u32 v25, 33024, v7
    s_nop 6
    v_pk_mul_f32 v[32:33], v[32:33], v[96:97]
    v_pk_mul_f32 v[34:35], v[34:35], v[98:99]
    v_pk_mul_f32 v[36:37], v[36:37], v[100:101]
    v_pk_mul_f32 v[38:39], v[38:39], v[102:103]
    v_pk_mul_f32 v[32:33], v[32:33], v[244:245] op_sel:[0,1] op_sel_hi:[1,1]
    v_pk_mul_f32 v[34:35], v[34:35], v[244:245] op_sel:[0,1] op_sel_hi:[1,1]
    v_pk_mul_f32 v[36:37], v[36:37], v[244:245] op_sel:[0,1] op_sel_hi:[1,1]
    v_pk_mul_f32 v[38:39], v[38:39], v[244:245] op_sel:[0,1] op_sel_hi:[1,1]
    v_cvt_pk_bf16_f32 v32, v32, v33
    v_cvt_pk_bf16_f32 v33, v34, v35
    v_cvt_pk_bf16_f32 v34, v36, v37
    v_cvt_pk_bf16_f32 v35, v38, v39
    buffer_store_dwordx4 v[32:35], v7, s[28:31], s73 offen offset:0 sc1
    v_pk_mul_f32 v[40:41], v[40:41], v[104:105]
    v_pk_mul_f32 v[42:43], v[42:43], v[106:107]
    v_pk_mul_f32 v[44:45], v[44:45], v[108:109]
    v_pk_mul_f32 v[46:47], v[46:47], v[110:111]
    v_pk_mul_f32 v[40:41], v[40:41], v[244:245] op_sel:[0,1] op_sel_hi:[1,1]
    v_pk_mul_f32 v[42:43], v[42:43], v[244:245] op_sel:[0,1] op_sel_hi:[1,1]
    v_pk_mul_f32 v[44:45], v[44:45], v[244:245] op_sel:[0,1] op_sel_hi:[1,1]
    v_pk_mul_f32 v[46:47], v[46:47], v[244:245] op_sel:[0,1] op_sel_hi:[1,1]
    v_cvt_pk_bf16_f32 v40, v40, v41
    v_cvt_pk_bf16_f32 v41, v42, v43
    v_cvt_pk_bf16_f32 v42, v44, v45
    v_cvt_pk_bf16_f32 v43, v46, v47
    buffer_store_dwordx4 v[40:43], v7, s[28:31], s73 offen offset:1024 sc1
    v_pk_mul_f32 v[48:49], v[48:49], v[112:113]
    v_pk_mul_f32 v[50:51], v[50:51], v[114:115]
    v_pk_mul_f32 v[52:53], v[52:53], v[116:117]
    v_pk_mul_f32 v[54:55], v[54:55], v[118:119]
    v_pk_mul_f32 v[48:49], v[48:49], v[244:245] op_sel:[0,1] op_sel_hi:[1,1]
    v_pk_mul_f32 v[50:51], v[50:51], v[244:245] op_sel:[0,1] op_sel_hi:[1,1]
    v_pk_mul_f32 v[52:53], v[52:53], v[244:245] op_sel:[0,1] op_sel_hi:[1,1]
    v_pk_mul_f32 v[54:55], v[54:55], v[244:245] op_sel:[0,1] op_sel_hi:[1,1]
    v_cvt_pk_bf16_f32 v48, v48, v49
    v_cvt_pk_bf16_f32 v49, v50, v51
    v_cvt_pk_bf16_f32 v50, v52, v53
    v_cvt_pk_bf16_f32 v51, v54, v55
    buffer_store_dwordx4 v[48:51], v7, s[28:31], s73 offen offset:2048 sc1
    v_pk_mul_f32 v[56:57], v[56:57], v[120:121]
    v_pk_mul_f32 v[58:59], v[58:59], v[122:123]
    v_pk_mul_f32 v[60:61], v[60:61], v[124:125]
    v_pk_mul_f32 v[62:63], v[62:63], v[126:127]
    v_pk_mul_f32 v[56:57], v[56:57], v[244:245] op_sel:[0,1] op_sel_hi:[1,1]
    v_pk_mul_f32 v[58:59], v[58:59], v[244:245] op_sel:[0,1] op_sel_hi:[1,1]
    v_pk_mul_f32 v[60:61], v[60:61], v[244:245] op_sel:[0,1] op_sel_hi:[1,1]
    v_pk_mul_f32 v[62:63], v[62:63], v[244:245] op_sel:[0,1] op_sel_hi:[1,1]
    v_cvt_pk_bf16_f32 v56, v56, v57
    v_cvt_pk_bf16_f32 v57, v58, v59
    v_cvt_pk_bf16_f32 v58, v60, v61
    v_cvt_pk_bf16_f32 v59, v62, v63
    buffer_store_dwordx4 v[56:59], v7, s[28:31], s73 offen offset:3072 sc1
    s_waitcnt vmcnt(15)
    ds_write_b32 v29, v74 offset:8960
    ds_write_b32 v29, v75 offset:13056
    ds_write_b32 v29, v76 offset:17152
    s_waitcnt lgkmcnt(0)
    s_barrier
    ds_read2st64_b64 v[128:131], v16 offset0:0 offset1:1
    ds_read2st64_b64 v[132:135], v16 offset0:2 offset1:3
    s_add_u32 m0, s55, 21504
    s_add_u32 s56, s89, 0
    buffer_load_dwordx4 v248, s[24:27], s56 offen offset:0 lds
    ds_read2st64_b64 v[136:139], v18 offset0:112 offset1:113
    ds_read2st64_b64 v[140:143], v18 offset0:114 offset1:115
    s_waitcnt vmcnt(12)
    v_cndmask_b32 v70, v77, v70, vcc
    v_readlane_b32 s92, v31, 16
    ds_read2st64_b64 v[144:147], v17 offset0:0 offset1:1
    ds_read2st64_b64 v[148:151], v17 offset0:2 offset1:3
    s_waitcnt lgkmcnt(4)
    v_mfma_f32_32x32x16_bf16 v[48:63], v[128:131], v[64:67], 0
    v_mfma_f32_32x32x16_bf16 v[48:63], v[132:135], v[68:71], v[48:63]
    buffer_load_dwordx4 v249, s[24:27], s56 offen offset:1024 lds
    s_waitcnt lgkmcnt(2)
    v_mfma_f32_32x32x16_bf16 v[72:87], v[136:139], v[64:67], 0
    ds_read2st64_b64 v[128:131], v18 offset0:0 offset1:1
    v_mfma_f32_32x32x16_bf16 v[72:87], v[140:143], v[68:71], v[72:87]
    ds_read2st64_b64 v[132:135], v18 offset0:2 offset1:3
    buffer_load_dwordx4 v250, s[24:27], s56 offen offset:2048 lds
    buffer_load_dwordx4 v251, s[24:27], s56 offen offset:3072 lds
    s_nop 7
    s_nop 0
    v_cndmask_b32 v32, v48, v72, s[8:9]
    v_cndmask_b32 v33, v49, v73, s[10:11]
    v_cndmask_b32 v34, v50, v74, s[12:13]
    v_cndmask_b32 v35, v51, v75, s[14:15]
    v_cndmask_b32 v36, v52, v76, s[16:17]
    v_cndmask_b32 v37, v53, v77, s[18:19]
    v_cndmask_b32 v38, v54, v78, s[36:37]
    v_cndmask_b32 v39, v55, v79, s[38:39]
    s_add_u32 m0, s55, 25600
    s_add_u32 s56, s89, 28672
    buffer_load_dwordx4 v248, s[24:27], s56 offen offset:0 lds
    v_cndmask_b32 v40, v56, v80, s[46:47]
    v_cndmask_b32 v41, v57, v81, s[48:49]
    v_cndmask_b32 v42, v58, v82, s[50:51]
    v_cndmask_b32 v43, v59, v83, s[52:53]
    v_cndmask_b32 v44, v60, v84, s[64:65]
    v_cndmask_b32 v45, v61, v85, s[66:67]
    v_cndmask_b32 v46, v62, v86, s[68:69]
    v_cndmask_b32 v47, v63, v87, s[76:77]
    s_waitcnt lgkmcnt(2)
    v_mfma_f32_32x32x16_bf16 v[48:63], v[144:147], v[64:67], 0
    v_exp_f32 v32, v32
    v_exp_f32_e64 v33, v33
    ds_read2st64_b64 v[136:139], v16 offset0:56 offset1:57
    v_exp_f32 v34, v34
    v_exp_f32 v35, v35
    v_mfma_f32_32x32x16_bf16 v[48:63], v[148:151], v[68:71], v[48:63]
    v_exp_f32 v36, v36
    v_exp_f32 v37, v37
    ds_read2st64_b64 v[140:143], v16 offset0:58 offset1:59
    v_exp_f32_e64 v38, v38
    v_exp_f32 v39, v39
    s_waitcnt lgkmcnt(2)
    v_mfma_f32_32x32x16_bf16 v[72:87], v[128:131], v[64:67], 0
    v_exp_f32 v40, v40
    v_exp_f32 v41, v41
    buffer_load_dwordx4 v249, s[24:27], s56 offen offset:1024 lds
    v_exp_f32 v42, v42
    v_exp_f32 v43, v43
    v_mfma_f32_32x32x16_bf16 v[72:87], v[132:135], v[68:71], v[72:87]
    v_exp_f32 v44, v44
    v_exp_f32 v45, v45
    buffer_load_dwordx4 v250, s[24:27], s56 offen offset:2048 lds
    v_exp_f32 v46, v46
    v_exp_f32 v47, v47
    s_waitcnt vmcnt(12)
    s_mov_b64 exec, 0xfff
    ds_write_b128 v28, v[240:243]
    s_mov_b64 exec, -1
    s_waitcnt lgkmcnt(0)
    s_barrier
    ds_read_b128 v[152:155], v19 offset:2048
    ds_read_b128 v[156:159], v19 offset:3072
    ds_read_b128 v[160:163], v21 offset:59392
    ds_read_b128 v[164:167], v21 offset:60416
    v_cvt_pk_bf16_f32 v88, v32, v33
    v_cvt_pk_bf16_f32 v89, v34, v35
    v_cvt_pk_bf16_f32 v90, v36, v37
    v_cvt_pk_bf16_f32 v91, v38, v39
    v_cvt_pk_bf16_f32 v92, v40, v41
    v_cvt_pk_bf16_f32 v93, v42, v43
    buffer_load_dwordx4 v251, s[24:27], s56 offen offset:3072 lds
    v_cvt_pk_bf16_f32 v94, v44, v45
    v_cvt_pk_bf16_f32 v95, v46, v47
    v_bfi_b32 v104, v8, 0, v88
    v_bfi_b32 v105, v9, 0, v89
    v_bfi_b32 v106, v10, 0, v90
    v_bfi_b32 v107, v11, 0, v91
    v_bfi_b32 v108, v12, 0, v92
    v_bfi_b32 v109, v13, 0, v93
    v_bfi_b32 v110, v14, 0, v94
    v_bfi_b32 v111, v15, 0, v95
    v_and_b32 v88, v8, v88
    v_and_b32 v89, v9, v89
    s_add_u32 m0, s55, 29696
    s_add_u32 s56, s89, 57344
    buffer_load_dwordx4 v248, s[24:27], s56 offen offset:0 lds
    v_and_b32 v90, v10, v90
    v_and_b32 v91, v11, v91
    v_and_b32 v92, v12, v92
    v_and_b32 v93, v13, v93
    v_and_b32 v94, v14, v94
    v_and_b32 v95, v15, v95
    s_waitcnt vmcnt(13)
    v_cmp_ne_u32 vcc, v247, v255
    s_and_b64 vcc, vcc, s[78:79]
    s_cbranch_vccnz Lslow_17
Lback_18:
    s_lshl_b32 s78, s78, 6
    s_lshl_b32 s58, s78, 2
    s_or_b32 s78, s78, s58
    s_waitcnt lgkmcnt(2)
    v_mfma_f32_32x32x16_bf16 v[112:127], v[152:155], v[104:107], 0
    v_exp_f32 v48, v48
    v_exp_f32 v49, v49
    buffer_load_dwordx4 v[168:171], v7, s[28:31], s92 offen offset:0 sc1
    v_readlane_b32 s57, v31, 17
    v_exp_f32 v50, v50
    v_exp_f32 v51, v51
    v_exp_f32_e64 v52, v52
    v_mfma_f32_32x32x16_bf16 v[112:127], v[156:159], v[108:111], v[112:127]
    v_exp_f32_e64 v53, v53
    buffer_load_dwordx4 v249, s[24:27], s56 offen offset:1024 lds
    v_exp_f32 v54, v54
    v_exp_f32 v55, v55
    v_exp_f32 v56, v56
    ds_read_b128 v[152:155], v20 offset:2048
    s_waitcnt lgkmcnt(1)
    v_mfma_f32_32x32x16_bf16 v[112:127], v[160:163], v[88:91], v[112:127]
    ds_read_b128 v[156:159], v20 offset:3072
    v_exp_f32_e64 v57, v57
    buffer_load_dwordx4 v[172:175], v30, s[28:31], s92 offen offset:0 sc1
    v_exp_f32 v58, v58
    v_exp_f32 v59, v59
    v_exp_f32_e64 v60, v60
    v_mfma_f32_32x32x16_bf16 v[112:127], v[164:167], v[92:95], v[112:127]
    v_exp_f32_e64 v61, v61
    buffer_load_dwordx4 v250, s[24:27], s56 offen offset:2048 lds
    v_exp_f32 v62, v62
    v_exp_f32 v63, v63
    ds_read2st64_b64 v[144:147], v17 offset0:56 offset1:57
    ds_read2st64_b64 v[148:151], v17 offset0:58 offset1:59
    ds_read_b128 v[160:163], v21 offset:2048
    ds_read_b128 v[164:167], v21 offset:3072
    v_cvt_pk_bf16_f32 v96, v48, v49
    v_cvt_pk_bf16_f32 v97, v50, v51
    v_cvt_pk_bf16_f32 v98, v52, v53
    v_cvt_pk_bf16_f32 v99, v54, v55
    v_cvt_pk_bf16_f32 v100, v56, v57
    v_cvt_pk_bf16_f32 v101, v58, v59
    v_cvt_pk_bf16_f32 v102, v60, v61
    v_cvt_pk_bf16_f32 v103, v62, v63
    v_mfma_f32_32x32x16_bf16 v[48:63], v[136:139], v[64:67], 0
    v_exp_f32 v72, v72
    v_exp_f32 v73, v73
    buffer_load_dwordx4 v[176:179], v7, s[28:31], s92 offen offset:1024 sc1
    v_exp_f32_e64 v74, v74
    v_exp_f32 v75, v75
    s_waitcnt lgkmcnt(4)
    v_mfma_f32_32x32x16_bf16 v[112:127], v[152:155], v[96:99], v[112:127]
    v_exp_f32 v76, v76
    v_exp_f32 v77, v77
    buffer_load_dwordx4 v251, s[24:27], s56 offen offset:3072 lds
    v_exp_f32 v78, v78
    v_exp_f32 v79, v79
    v_exp_f32_e64 v80, v80
    v_mfma_f32_32x32x16_bf16 v[48:63], v[140:143], v[68:71], v[48:63]
    v_exp_f32_e64 v81, v81
    buffer_load_dwordx4 v[180:183], v30, s[28:31], s92 offen offset:1024 sc1
    v_exp_f32 v82, v82
    v_exp_f32 v83, v83
    v_exp_f32_e64 v84, v84
    v_mfma_f32_32x32x16_bf16 v[112:127], v[156:159], v[100:103], v[112:127]
    v_exp_f32_e64 v85, v85
    s_add_u32 m0, s55, 33792
    s_add_u32 s56, s89, 86016
    buffer_load_dwordx4 v248, s[24:27], s56 offen offset:0 lds
    v_exp_f32 v86, v86
    v_exp_f32 v87, v87
    ds_read2st64_b64 v[128:131], v18 offset0:56 offset1:57
    ds_read2st64_b64 v[132:135], v18 offset0:58 offset1:59
    ds_read_b128 v[152:155], v19 offset:30720
    ds_read_b128 v[156:159], v19 offset:31744
    v_cvt_pk_bf16_f32 v88, v72, v73
    v_cvt_pk_bf16_f32 v89, v74, v75
    v_cvt_pk_bf16_f32 v90, v76, v77
    v_cvt_pk_bf16_f32 v91, v78, v79
    v_cvt_pk_bf16_f32 v92, v80, v81
    v_cvt_pk_bf16_f32 v93, v82, v83
    v_cvt_pk_bf16_f32 v94, v84, v85
    v_cvt_pk_bf16_f32 v95, v86, v87
    s_waitcnt lgkmcnt(6)
    v_mfma_f32_32x32x16_bf16 v[72:87], v[144:147], v[64:67], 0
    v_exp_f32 v48, v48
    v_exp_f32_e64 v49, v49
    buffer_load_dwordx4 v[184:187], v7, s[28:31], s57 offen offset:0 sc1
    v_readlane_b32 s92, v31, 18
    v_exp_f32_e64 v50, v50
    v_exp_f32 v51, v51
    s_waitcnt lgkmcnt(4)
    v_mfma_f32_32x32x16_bf16 v[112:127], v[160:163], v[88:91], v[112:127]
    v_exp_f32_e64 v52, v52
    buffer_load_dwordx4 v249, s[24:27], s56 offen offset:1024 lds
    v_exp_f32 v53, v53
    v_exp_f32 v54, v54
    v_exp_f32_e64 v55, v55
    buffer_load_dwordx4 v[188:191], v30, s[28:31], s57 offen offset:0 sc1
    v_mfma_f32_32x32x16_bf16 v[72:87], v[148:151], v[68:71], v[72:87]
    v_exp_f32 v56, v56
    v_exp_f32 v57, v57
    v_exp_f32 v58, v58
    v_exp_f32 v59, v59
    v_readlane_b32 s56, v31, 12
    s_add_u32 m0, s62, 32768
    s_nop 3
    buffer_load_dwordx4 v248, s[20:23], s56 offen offset:0 lds
    v_exp_f32 v60, v60
    v_mfma_f32_32x32x16_bf16 v[112:127], v[164:167], v[92:95], v[112:127]
    v_exp_f32_e64 v61, v61
    v_exp_f32 v62, v62
    s_waitcnt vmcnt(21)
    buffer_store_dword v255, v0, s[28:31], s75 offen sc1
    v_exp_f32_e64 v63, v63
    ds_read2st64_b64 v[136:139], v16 offset0:112 offset1:113
    ds_read2st64_b64 v[140:143], v16 offset0:114 offset1:115
    ds_read_b128 v[160:163], v20 offset:30720
    ds_read_b128 v[164:167], v20 offset:31744
    v_cvt_pk_bf16_f32 v96, v48, v49
    v_cvt_pk_bf16_f32 v97, v50, v51
    v_cvt_pk_bf16_f32 v98, v52, v53
    v_cvt_pk_bf16_f32 v99, v54, v55
    v_cvt_pk_bf16_f32 v100, v56, v57
    v_cvt_pk_bf16_f32 v101, v58, v59
    v_cvt_pk_bf16_f32 v102, v60, v61
    v_cvt_pk_bf16_f32 v103, v62, v63
    s_waitcnt lgkmcnt(6)
    v_mfma_f32_32x32x16_bf16 v[48:63], v[128:131], v[64:67], 0
    v_exp_f32 v72, v72
    v_exp_f32_e64 v73, v73
    buffer_load_dwordx4 v[192:195], v7, s[28:31], s57 offen offset:1024 sc1
    v_exp_f32_e64 v74, v74
    v_exp_f32 v75, v75
    s_waitcnt lgkmcnt(4)
    v_mfma_f32_32x32x16_bf16 v[112:127], v[152:155], v[96:99], v[112:127]
    v_exp_f32_e64 v76, v76
    buffer_load_dwordx4 v249, s[20:23], s56 offen offset:1024 lds
    v_exp_f32 v77, v77
    v_exp_f32 v78, v78
    v_exp_f32_e64 v79, v79
    buffer_load_dwordx4 v[196:199], v30, s[28:31], s57 offen offset:1024 sc1
    v_mfma_f32_32x32x16_bf16 v[48:63], v[132:135], v[68:71], v[48:63]
    v_exp_f32 v80, v80
    v_exp_f32 v81, v81
    v_exp_f32 v82, v82
    v_exp_f32 v83, v83
    buffer_load_dwordx4 v[200:203], v7, s[28:31], s92 offen offset:0 sc1
    v_readlane_b32 s57, v31, 19
    v_exp_f32_e64 v84, v84
    v_mfma_f32_32x32x16_bf16 v[112:127], v[156:159], v[100:103], v[112:127]
    v_exp_f32 v85, v85
    v_exp_f32 v86, v86
    buffer_load_dwordx4 v250, s[20:23], s56 offen offset:2048 lds
    v_exp_f32_e64 v87, v87
    ds_read2st64_b64 v[144:147], v17 offset0:112 offset1:113
    ds_read2st64_b64 v[148:151], v17 offset0:114 offset1:115
    ds_read_b128 v[152:155], v21 offset:30720
    ds_read_b128 v[156:159], v21 offset:31744
    v_cvt_pk_bf16_f32 v88, v72, v73
    v_cvt_pk_bf16_f32 v89, v74, v75
    v_cvt_pk_bf16_f32 v90, v76, v77
    v_cvt_pk_bf16_f32 v91, v78, v79
    v_cvt_pk_bf16_f32 v92, v80, v81
    v_cvt_pk_bf16_f32 v93, v82, v83
    v_cvt_pk_bf16_f32 v94, v84, v85
    v_cvt_pk_bf16_f32 v95, v86, v87
    s_waitcnt lgkmcnt(6)
    v_mfma_f32_32x32x16_bf16 v[72:87], v[136:139], v[64:67], 0
    v_exp_f32 v48, v48
    v_exp_f32_e64 v49, v49
    buffer_load_dwordx4 v[204:207], v30, s[28:31], s92 offen offset:0 sc1
    v_exp_f32_e64 v50, v50
    v_exp_f32 v51, v51
    s_waitcnt lgkmcnt(4)
    v_mfma_f32_32x32x16_bf16 v[112:127], v[160:163], v[88:91], v[112:127]
    v_exp_f32_e64 v52, v52
    buffer_load_dwordx4 v251, s[20:23], s56 offen offset:3072 lds
    v_exp_f32 v53, v53
    v_exp_f32 v54, v54
    v_exp_f32_e64 v55, v55
    v_mfma_f32_32x32x16_bf16 v[72:87], v[140:143], v[68:71], v[72:87]
    buffer_load_dwordx4 v[208:211], v7, s[28:31], s92 offen offset:1024 sc1
    v_exp_f32 v56, v56
    v_exp_f32 v57, v57
    v_exp_f32 v58, v58
    v_exp_f32 v59, v59
    v_mfma_f32_32x32x16_bf16 v[112:127], v[164:167], v[92:95], v[112:127]
    buffer_load_dwordx4 v[212:215], v30, s[28:31], s92 offen offset:1024 sc1
    v_exp_f32 v60, v60
    v_exp_f32 v61, v61
    v_exp_f32_e64 v62, v62
    v_readlane_b32 s56, v31, 13
    s_add_u32 m0, s62, 16384
    s_nop 3
    buffer_load_dwordx4 v248, s[20:23], s56 offen offset:0 lds
    v_exp_f32 v63, v63
    ds_read_b128 v[160:163], v19 offset:59392
    ds_read_b128 v[164:167], v19 offset:60416
    v_cvt_pk_bf16_f32 v96, v48, v49
    v_cvt_pk_bf16_f32 v97, v50, v51
    v_cvt_pk_bf16_f32 v98, v52, v53
    v_cvt_pk_bf16_f32 v99, v54, v55
    v_cvt_pk_bf16_f32 v100, v56, v57
    v_cvt_pk_bf16_f32 v101, v58, v59
    v_cvt_pk_bf16_f32 v102, v60, v61
    v_cvt_pk_bf16_f32 v103, v62, v63
    s_waitcnt lgkmcnt(4)
    v_mfma_f32_32x32x16_bf16 v[48:63], v[144:147], v[64:67], 0
    v_exp_f32 v72, v72
    v_exp_f32_e64 v73, v73
    buffer_load_dwordx4 v[216:219], v7, s[28:31], s57 offen offset:0 sc1
    v_readlane_b32 s92, v31, 20
    v_exp_f32_e64 v74, v74
    v_exp_f32 v75, v75
    s_waitcnt lgkmcnt(2)
    v_mfma_f32_32x32x16_bf16 v[112:127], v[152:155], v[96:99], v[112:127]
    v_exp_f32_e64 v76, v76
    buffer_load_dwordx4 v249, s[20:23], s56 offen offset:1024 lds
    v_exp_f32 v77, v77
    v_exp_f32 v78, v78
    v_exp_f32_e64 v79, v79
    v_mfma_f32_32x32x16_bf16 v[48:63], v[148:151], v[68:71], v[48:63]
    buffer_load_dwordx4 v[220:223], v30, s[28:31], s57 offen offset:0 sc1
    v_exp_f32 v80, v80
    v_exp_f32 v81, v81
    v_exp_f32 v82, v82
    v_exp_f32 v83, v83
    v_mfma_f32_32x32x16_bf16 v[112:127], v[156:159], v[100:103], v[112:127]
    buffer_load_dwordx4 v[224:227], v7, s[28:31], s57 offen offset:1024 sc1
    v_exp_f32 v84, v84
    v_exp_f32 v85, v85
    v_exp_f32_e64 v86, v86
    buffer_load_dwordx4 v250, s[20:23], s56 offen offset:2048 lds
    v_exp_f32_e64 v87, v87
    ds_read_b128 v[152:155], v20 offset:59392
    ds_read_b128 v[156:159], v20 offset:60416
    v_cvt_pk_bf16_f32 v88, v72, v73
    v_cvt_pk_bf16_f32 v89, v74, v75
    v_cvt_pk_bf16_f32 v90, v76, v77
    v_cvt_pk_bf16_f32 v91, v78, v79
    v_cvt_pk_bf16_f32 v92, v80, v81
    v_cvt_pk_bf16_f32 v93, v82, v83
    v_cvt_pk_bf16_f32 v94, v84, v85
    v_cvt_pk_bf16_f32 v95, v86, v87
    s_waitcnt lgkmcnt(2)
    v_mfma_f32_32x32x16_bf16 v[112:127], v[160:163], v[88:91], v[112:127]
    v_exp_f32 v48, v48
    v_exp_f32_e64 v49, v49
    buffer_load_dwordx4 v[228:231], v30, s[28:31], s57 offen offset:1024 sc1
    v_exp_f32 v50, v50
    v_exp_f32 v51, v51
    buffer_load_dwordx4 v[232:235], v7, s[28:31], s92 offen offset:0 sc1
    v_readlane_b32 s57, v31, 21
    v_exp_f32 v52, v52
    v_exp_f32 v53, v53
    v_exp_f32_e64 v54, v54
    buffer_load_dwordx4 v[236:239], v30, s[28:31], s92 offen offset:0 sc1
    v_exp_f32_e64 v55, v55
    v_mfma_f32_32x32x16_bf16 v[112:127], v[164:167], v[92:95], v[112:127]
    v_exp_f32 v56, v56
    v_exp_f32 v57, v57
    buffer_load_dwordx4 v251, s[20:23], s56 offen offset:3072 lds
    v_exp_f32 v58, v58
    v_exp_f32 v59, v59
    buffer_load_dwordx4 v[128:131], v7, s[28:31], s92 offen offset:1024 sc1
    v_exp_f32 v60, v60
    v_exp_f32 v61, v61
    v_exp_f32_e64 v62, v62
    buffer_load_dword v247, v26, s[28:31], 0 offen sc1
    v_exp_f32_e64 v63, v63
    v_cvt_pk_bf16_f32 v96, v48, v49
    v_cvt_pk_bf16_f32 v97, v50, v51
    v_cvt_pk_bf16_f32 v98, v52, v53
    v_cvt_pk_bf16_f32 v99, v54, v55
    v_cvt_pk_bf16_f32 v100, v56, v57
    v_cvt_pk_bf16_f32 v101, v58, v59
    v_cvt_pk_bf16_f32 v102, v60, v61
    v_cvt_pk_bf16_f32 v103, v62, v63
    s_nop 1
    s_waitcnt lgkmcnt(0)
    v_mfma_f32_32x32x16_bf16 v[112:127], v[152:155], v[96:99], v[112:127]
    v_mfma_f32_32x32x16_bf16 v[112:127], v[156:159], v[100:103], v[112:127]
    s_movk_i32 s58, 0x200
    s_nop 0
    buffer_load_dwordx4 v[132:135], v30, s[28:31], s92 offen offset:1024 sc1
    buffer_load_dwordx4 v[136:139], v7, s[28:31], s57 offen offset:0 sc1
    v_readlane_b32 s92, v31, 22
    buffer_load_dwordx4 v[140:143], v30, s[28:31], s57 offen offset:0 sc1
    buffer_load_dwordx4 v[144:147], v7, s[28:31], s57 offen offset:1024 sc1
    buffer_load_dwordx4 v[148:151], v30, s[28:31], s57 offen offset:1024 sc1
    s_nop 4
    v_mov_b32 v240, v124
    v_mov_b32_e64 v241, v124
    s_nop 1
    v_permlane32_swap_b32 v240, v241
    v_bfe_u32 v240, v241, 23, 8
    v_subrev_u32_e64 v240, 63, v240
    v_cmp_lt_u32 vcc, 0x80, v240
    s_cbranch_vccnz L_truemax
L_norm:
    v_cmp_gt_u32 vcc, s58, v7
    v_rcp_f32 v241, v241
    s_nop 0
    v_cndmask_b32_e64 v240, 0, v241, vcc
    v_pk_mul_f32 v[112:113], v[112:113], v[240:241] op_sel:[0,1] op_sel_hi:[1,1]
    v_pk_mul_f32 v[114:115], v[114:115], v[240:241] op_sel:[0,1] op_sel_hi:[1,1]
    v_pk_mul_f32 v[116:117], v[116:117], v[240:241] op_sel:[0,1] op_sel_hi:[1,1]
    v_pk_mul_f32 v[118:119], v[118:119], v[240:241] op_sel:[0,1] op_sel_hi:[1,1]
    v_cvt_pk_bf16_f32 v112, v112, v113
    v_cvt_pk_bf16_f32 v113, v114, v115
    v_cvt_pk_bf16_f32 v114, v116, v117
    v_cvt_pk_bf16_f32 v115, v118, v119
    buffer_store_dwordx4 v[112:115], v7, s[28:31], s43 offen offset:0 sc1
    v_pk_mul_f32 v[120:121], v[120:121], v[240:241] op_sel:[0,1] op_sel_hi:[1,1]
    v_pk_mul_f32 v[122:123], v[122:123], v[240:241] op_sel:[0,1] op_sel_hi:[1,1]
    v_pk_mul_f32 v[124:125], v[124:125], v[240:241] op_sel:[0,0] op_sel_hi:[1,0]
    v_pk_mul_f32 v[126:127], v[126:127], v[240:241] op_sel:[0,0] op_sel_hi:[1,0]
    v_cvt_pk_bf16_f32 v120, v120, v121
    v_cvt_pk_bf16_f32 v121, v122, v123
    v_cvt_pk_bf16_f32 v122, v124, v125
    v_cvt_pk_bf16_f32 v123, v126, v127
    buffer_store_dwordx4 v[120:123], v7, s[28:31], s43 offen offset:1024 sc1
    s_cmp_ge_u32 s41, 28
    s_cbranch_scc1 L_nog2
    s_waitcnt vmcnt(38)
    s_nop 0
    v_mfma_f32_32x32x16_bf16 v[32:47], a[0:3], v[168:171], 0
    v_mfma_f32_32x32x16_bf16 v[48:63], a[0:3], v[172:175], 0
    v_mfma_f32_32x32x16_bf16 v[72:87], a[4:7], v[168:171], 0
    v_mfma_f32_32x32x16_bf16 v[96:111], a[4:7], v[172:175], 0
    buffer_load_dwordx4 v[16:19], v27, s[4:7], s44 offen
    s_waitcnt vmcnt(35)
    v_mfma_f32_32x32x16_bf16 v[32:47], a[8:11], v[176:179], v[32:47]
    v_mfma_f32_32x32x16_bf16 v[48:63], a[8:11], v[180:183], v[48:63]
    v_mfma_f32_32x32x16_bf16 v[72:87], a[12:15], v[176:179], v[72:87]
    v_mfma_f32_32x32x16_bf16 v[96:111], a[12:15], v[180:183], v[96:111]
    s_waitcnt vmcnt(31)
    v_mfma_f32_32x32x16_bf16 v[32:47], a[16:19], v[184:187], v[32:47]
    v_mfma_f32_32x32x16_bf16 v[48:63], a[16:19], v[188:191], v[48:63]
    v_mfma_f32_32x32x16_bf16 v[72:87], a[20:23], v[184:187], v[72:87]
    v_mfma_f32_32x32x16_bf16 v[96:111], a[20:23], v[188:191], v[96:111]
    s_add_u32 s94, s44, 7168
    buffer_load_dwordx4 v[20:23], v27, s[4:7], s94 offen
    s_waitcnt vmcnt(27)
    v_mfma_f32_32x32x16_bf16 v[32:47], a[24:27], v[192:195], v[32:47]
    s_waitcnt vmcnt(9)
    v_cmp_ne_u32_e64 vcc, v247, v255
    s_and_b64 vcc, vcc, s[78:79]
    s_cbranch_vccnz Lslow_19
Lback_20:
    buffer_load_dwordx4 v[160:163], v7, s[28:31], s92 offen offset:0 sc1
    v_readlane_b32 s57, v31, 23
    v_mfma_f32_32x32x16_bf16 v[48:63], a[24:27], v[196:199], v[48:63]
    buffer_load_dwordx4 v[164:167], v30, s[28:31], s92 offen offset:0 sc1
    v_mfma_f32_32x32x16_bf16 v[72:87], a[28:31], v[192:195], v[72:87]
    ds_read_b64_tr_b16 a[192:193], v5 offset:32768
    ds_read_b64_tr_b16 a[194:195], v5 offset:33792
    v_mfma_f32_32x32x16_bf16 v[96:111], a[28:31], v[196:199], v[96:111]
    ds_read_b64_tr_b16 a[196:197], v6 offset:32768
    ds_read_b64_tr_b16 a[198:199], v6 offset:33792
    v_mfma_f32_32x32x16_bf16 v[32:47], a[32:35], v[200:203], v[32:47]
    buffer_load_dwordx4 v[152:155], v7, s[28:31], s92 offen offset:1024 sc1
    v_mfma_f32_32x32x16_bf16 v[48:63], a[32:35], v[204:207], v[48:63]
    buffer_load_dwordx4 v[156:159], v30, s[28:31], s92 offen offset:1024 sc1
    ds_read_b64_tr_b16 a[200:201], v5 offset:34816
    v_mfma_f32_32x32x16_bf16 v[72:87], a[36:39], v[200:203], v[72:87]
    ds_read_b64_tr_b16 a[202:203], v5 offset:35840
    v_mfma_f32_32x32x16_bf16 v[96:111], a[36:39], v[204:207], v[96:111]
    ds_read_b64_tr_b16 a[204:205], v6 offset:34816
    ds_read_b64_tr_b16 a[206:207], v6 offset:35840
    v_mfma_f32_32x32x16_bf16 v[32:47], a[40:43], v[208:211], v[32:47]
    buffer_load_dwordx4 v[168:171], v7, s[28:31], s57 offen offset:0 sc1
    v_readlane_b32 s92, v31, 24
    v_mfma_f32_32x32x16_bf16 v[48:63], a[40:43], v[212:215], v[48:63]
    buffer_load_dwordx4 v[172:175], v30, s[28:31], s57 offen offset:0 sc1
    v_mfma_f32_32x32x16_bf16 v[72:87], a[44:47], v[208:211], v[72:87]
    ds_read_b64_tr_b16 a[208:209], v5 offset:16384
    ds_read_b64_tr_b16 a[210:211], v5 offset:17408
    v_mfma_f32_32x32x16_bf16 v[96:111], a[44:47], v[212:215], v[96:111]
    ds_read_b64_tr_b16 a[212:213], v6 offset:16384
    ds_read_b64_tr_b16 a[214:215], v6 offset:17408
    v_mfma_f32_32x32x16_bf16 v[32:47], a[48:51], v[216:219], v[32:47]
    buffer_load_dwordx4 v[176:179], v7, s[28:31], s57 offen offset:1024 sc1
    buffer_load_dwordx4 v[180:183], v30, s[28:31], s57 offen offset:1024 sc1
    ds_read_b64_tr_b16 a[216:217], v5 offset:18432
    v_mfma_f32_32x32x16_bf16 v[48:63], a[48:51], v[220:223], v[48:63]
    ds_read_b64_tr_b16 a[218:219], v5 offset:19456
    ds_read_b64_tr_b16 a[220:221], v6 offset:18432
    ds_read_b64_tr_b16 a[222:223], v6 offset:19456
    s_mul_i32 s58, s40, 24576
    v_mfma_f32_32x32x16_bf16 v[72:87], a[52:55], v[216:219], v[72:87]
    s_sub_u32 s58, s58, 93184
    v_add_u32 v28, s58, v5
    v_add_u32 v29, s58, v6
    v_mfma_f32_32x32x16_bf16 v[96:111], a[52:55], v[220:223], v[96:111]
    v_lshrrev_b32 v24, 9, v7
    v_lshlrev_b32 v24, 9, v24
    v_sub_u32 v26, v29, v24
    v_sub_u32 v24, v28, v24
    v_mfma_f32_32x32x16_bf16 v[32:47], a[56:59], v[224:227], v[32:47]
    v_mfma_f32_32x32x16_bf16 v[48:63], a[56:59], v[228:231], v[48:63]
    buffer_load_dwordx4 v[184:187], v7, s[28:31], s92 offen offset:0 sc1
    v_readlane_b32 s57, v31, 25
    v_mfma_f32_32x32x16_bf16 v[72:87], a[60:63], v[224:227], v[72:87]
    buffer_load_dwordx4 v[188:191], v30, s[28:31], s92 offen offset:0 sc1
    v_mfma_f32_32x32x16_bf16 v[96:111], a[60:63], v[228:231], v[96:111]
    s_waitcnt vmcnt(12)
    s_nop 0
    buffer_store_dword v255, v0, s[28:31], s3 offen sc1
    v_mfma_f32_32x32x16_bf16 v[32:47], a[64:67], v[232:235], v[32:47]
    v_mfma_f32_32x32x16_bf16 v[48:63], a[64:67], v[236:239], v[48:63]
    buffer_load_dwordx4 v[192:195], v7, s[28:31], s92 offen offset:1024 sc1
    v_mfma_f32_32x32x16_bf16 v[72:87], a[68:71], v[232:235], v[72:87]
    v_mfma_f32_32x32x16_bf16 v[96:111], a[68:71], v[236:239], v[96:111]
    buffer_load_dwordx4 v[196:199], v30, s[28:31], s92 offen offset:1024 sc1
    v_mfma_f32_32x32x16_bf16 v[32:47], a[72:75], v[128:131], v[32:47]
    v_mfma_f32_32x32x16_bf16 v[48:63], a[72:75], v[132:135], v[48:63]
    buffer_load_dwordx4 v[200:203], v7, s[28:31], s57 offen offset:0 sc1
    v_readlane_b32 s92, v31, 26
    v_mfma_f32_32x32x16_bf16 v[72:87], a[76:79], v[128:131], v[72:87]
    v_mfma_f32_32x32x16_bf16 v[96:111], a[76:79], v[132:135], v[96:111]
    buffer_load_dwordx4 v[204:207], v30, s[28:31], s57 offen offset:0 sc1
    v_mfma_f32_32x32x16_bf16 v[32:47], a[80:83], v[136:139], v[32:47]
    v_mfma_f32_32x32x16_bf16 v[48:63], a[80:83], v[140:143], v[48:63]
    buffer_load_dwordx4 v[208:211], v7, s[28:31], s57 offen offset:1024 sc1
    v_mfma_f32_32x32x16_bf16 v[72:87], a[84:87], v[136:139], v[72:87]
    v_mfma_f32_32x32x16_bf16 v[96:111], a[84:87], v[140:143], v[96:111]
    buffer_load_dwordx4 v[212:215], v30, s[28:31], s57 offen offset:1024 sc1
    v_mfma_f32_32x32x16_bf16 v[32:47], a[88:91], v[144:147], v[32:47]
    v_mfma_f32_32x32x16_bf16 v[48:63], a[88:91], v[148:151], v[48:63]
    buffer_load_dwordx4 v[216:219], v7, s[28:31], s92 offen offset:0 sc1
    v_readlane_b32 s57, v31, 27
    v_mfma_f32_32x32x16_bf16 v[72:87], a[92:95], v[144:147], v[72:87]
    v_mfma_f32_32x32x16_bf16 v[96:111], a[92:95], v[148:151], v[96:111]
    buffer_load_dwordx4 v[220:223], v30, s[28:31], s92 offen offset:0 sc1
    s_waitcnt vmcnt(17)
    v_mfma_f32_32x32x16_bf16 v[32:47], a[96:99], v[160:163], v[32:47]
    v_mfma_f32_32x32x16_bf16 v[48:63], a[96:99], v[164:167], v[48:63]
    buffer_load_dwordx4 v[224:227], v7, s[28:31], s92 offen offset:1024 sc1
    v_mfma_f32_32x32x16_bf16 v[72:87], a[100:103], v[160:163], v[72:87]
    buffer_load_dwordx4 v[228:231], v30, s[28:31], s92 offen offset:1024 sc1
    v_mfma_f32_32x32x16_bf16 v[96:111], a[100:103], v[164:167], v[96:111]
    s_waitcnt lgkmcnt(0)
    s_barrier
    s_waitcnt vmcnt(17)
    v_mfma_f32_32x32x16_bf16 v[32:47], a[104:107], v[152:155], v[32:47]
    v_mfma_f32_32x32x16_bf16 v[48:63], a[104:107], v[156:159], v[48:63]
    buffer_load_dwordx4 v[232:235], v7, s[28:31], s57 offen offset:0 sc1
    v_readlane_b32 s92, v31, 28
    v_mfma_f32_32x32x16_bf16 v[72:87], a[108:111], v[152:155], v[72:87]
    v_mfma_f32_32x32x16_bf16 v[96:111], a[108:111], v[156:159], v[96:111]
    buffer_load_dwordx4 v[236:239], v30, s[28:31], s57 offen offset:0 sc1
    s_waitcnt vmcnt(17)
    v_mfma_f32_32x32x16_bf16 v[32:47], a[112:115], v[168:171], v[32:47]
    v_mfma_f32_32x32x16_bf16 v[48:63], a[112:115], v[172:175], v[48:63]
    buffer_load_dwordx4 v[128:131], v7, s[28:31], s57 offen offset:1024 sc1
    v_mfma_f32_32x32x16_bf16 v[72:87], a[116:119], v[168:171], v[72:87]
    v_mfma_f32_32x32x16_bf16 v[96:111], a[116:119], v[172:175], v[96:111]
    buffer_load_dwordx4 v[132:135], v30, s[28:31], s57 offen offset:1024 sc1
    s_waitcnt vmcnt(17)
    v_mfma_f32_32x32x16_bf16 v[32:47], a[120:123], v[176:179], v[32:47]
    v_mfma_f32_32x32x16_bf16 v[48:63], a[120:123], v[180:183], v[48:63]
    buffer_load_dwordx4 v[136:139], v7, s[28:31], s92 offen offset:0 sc1
    v_readlane_b32 s57, v31, 29
    v_mfma_f32_32x32x16_bf16 v[72:87], a[124:127], v[176:179], v[72:87]
    v_mfma_f32_32x32x16_bf16 v[96:111], a[124:127], v[180:183], v[96:111]
    buffer_load_dwordx4 v[140:143], v30, s[28:31], s92 offen offset:0 sc1
    s_waitcnt vmcnt(17)
    s_nop 0
    v_mfma_f32_32x32x16_bf16 v[32:47], a[128:131], v[184:187], v[32:47]
    v_mfma_f32_32x32x16_bf16 v[48:63], a[128:131], v[188:191], v[48:63]
    buffer_load_dwordx4 v[144:147], v7, s[28:31], s92 offen offset:1024 sc1
    v_mfma_f32_32x32x16_bf16 v[72:87], a[132:135], v[184:187], v[72:87]
    buffer_load_dwordx4 v[148:151], v30, s[28:31], s92 offen offset:1024 sc1
    v_mfma_f32_32x32x16_bf16 v[96:111], a[132:135], v[188:191], v[96:111]
    s_load_dwordx4 s[64:67], s[28:29], s45
    s_add_u32 s58, s45, 512
    s_load_dwordx4 s[68:71], s[28:29], s58
    s_waitcnt vmcnt(16)
    v_mfma_f32_32x32x16_bf16 v[32:47], a[136:139], v[192:195], v[32:47]
    v_mfma_f32_32x32x16_bf16 v[48:63], a[136:139], v[196:199], v[48:63]
    buffer_load_dwordx4 v[160:163], v7, s[28:31], s57 offen offset:0 sc1
    v_mfma_f32_32x32x16_bf16 v[72:87], a[140:143], v[192:195], v[72:87]
    v_mfma_f32_32x32x16_bf16 v[96:111], a[140:143], v[196:199], v[96:111]
    buffer_load_dwordx4 v[164:167], v30, s[28:31], s57 offen offset:0 sc1
    s_waitcnt vmcnt(16)
    v_mfma_f32_32x32x16_bf16 v[32:47], a[144:147], v[200:203], v[32:47]
    v_mfma_f32_32x32x16_bf16 v[48:63], a[144:147], v[204:207], v[48:63]
    buffer_load_dwordx4 v[152:155], v7, s[28:31], s57 offen offset:1024 sc1
    v_mfma_f32_32x32x16_bf16 v[72:87], a[148:151], v[200:203], v[72:87]
    v_mfma_f32_32x32x16_bf16 v[96:111], a[148:151], v[204:207], v[96:111]
    buffer_load_dwordx4 v[156:159], v30, s[28:31], s57 offen offset:1024 sc1
    s_waitcnt vmcnt(16)
    v_mfma_f32_32x32x16_bf16 v[32:47], a[152:155], v[208:211], v[32:47]
    v_mfma_f32_32x32x16_bf16 v[48:63], a[152:155], v[212:215], v[48:63]
    s_waitcnt lgkmcnt(0)
    s_cmp_eq_u64 s[64:65], s[100:101]
    s_cbranch_scc0 Lslow_21
    s_cmp_eq_u64 s[66:67], s[100:101]
    s_cbranch_scc0 Lslow_21
    s_cmp_eq_u64 s[68:69], s[100:101]
    s_cbranch_scc0 Lslow_21
    s_cmp_eq_u64 s[70:71], s[100:101]
    s_cbranch_scc0 Lslow_21
Lback_22:
    v_mfma_f32_32x32x16_bf16 v[72:87], a[156:159], v[208:211], v[72:87]
    s_add_u32 s57, s95, 0
    buffer_load_dwordx4 v[168:171], v7, s[28:31], s57 offen offset:0 sc1
    v_mfma_f32_32x32x16_bf16 v[96:111], a[156:159], v[212:215], v[96:111]
    buffer_load_dwordx4 v[172:175], v25, s[28:31], s57 offen offset:0 sc1
    s_waitcnt vmcnt(16)
    v_mfma_f32_32x32x16_bf16 v[32:47], a[160:163], v[216:219], v[32:47]
    v_mfma_f32_32x32x16_bf16 v[48:63], a[160:163], v[220:223], v[48:63]
    buffer_load_dwordx4 v[176:179], v7, s[28:31], s57 offen offset:1024 sc1
    v_mfma_f32_32x32x16_bf16 v[72:87], a[164:167], v[216:219], v[72:87]
    v_mfma_f32_32x32x16_bf16 v[96:111], a[164:167], v[220:223], v[96:111]
    buffer_load_dwordx4 v[180:183], v25, s[28:31], s57 offen offset:1024 sc1
    s_waitcnt vmcnt(16)
    s_nop 0
    v_mfma_f32_32x32x16_bf16 v[32:47], a[168:171], v[224:227], v[32:47]
    buffer_load_dwordx4 v[184:187], v7, s[28:31], s57 offen offset:2048 sc1
    buffer_load_dwordx4 v[188:191], v25, s[28:31], s57 offen offset:2048 sc1
    v_mfma_f32_32x32x16_bf16 v[48:63], a[168:171], v[228:231], v[48:63]
    v_bfe_u32 v1, v7, 4, 2
    v_mul_u32_u24 v1, 1088, v1
    v_lshrrev_b32_e64 v2, 7, v7
    v_mfma_f32_32x32x16_bf16 v[72:87], a[172:175], v[224:227], v[72:87]
    v_lshl_add_u32 v1, v2, 4, v1
    v_bfe_u32 v3, v7, 6, 1
    v_mfma_f32_32x32x16_bf16 v[96:111], a[172:175], v[228:231], v[96:111]
    s_and_b32 s58, s40, 1
    s_lshl_b32 s58, s58, 8
    v_add_u32 v1, s58, v1
    s_waitcnt vmcnt(16)
    v_mfma_f32_32x32x16_bf16 v[32:47], a[176:179], v[232:235], v[32:47]
    buffer_load_dwordx4 v[192:195], v7, s[28:31], s57 offen offset:3072 sc1
    buffer_load_dwordx4 v[196:199], v25, s[28:31], s57 offen offset:3072 sc1
    v_mfma_f32_32x32x16_bf16 v[48:63], a[176:179], v[236:239], v[48:63]
    v_mul_u32_u24 v2, 8704, v3
    v_mul_u32_u24 v3, 57344, v3
    s_lshr_b32 s58, s40, 1
    s_nop 0
    v_mfma_f32_32x32x16_bf16 v[72:87], a[180:183], v[232:235], v[72:87]
    s_mul_i32 s97, s58, 4352
    s_add_u32 s97, s97, 122880
    v_add3_u32 v2, v1, v2, s97
    v_mfma_f32_32x32x16_bf16 v[96:111], a[180:183], v[236:239], v[96:111]
    s_mul_i32 s58, s58, 28672
    s_add_u32 s58, s58, 7168
    v_add3_u32 v1, v1, v3, s58
    s_waitcnt vmcnt(16)
    v_mfma_f32_32x32x16_bf16 v[32:47], a[184:187], v[128:131], v[32:47]
    v_mfma_f32_32x32x16_bf16 v[48:63], a[184:187], v[132:135], v[48:63]
    s_add_u32 s57, s95, 4096
    buffer_load_dwordx4 v[200:203], v7, s[28:31], s57 offen offset:0 sc1
    v_mfma_f32_32x32x16_bf16 v[72:87], a[188:191], v[128:131], v[72:87]
    v_mfma_f32_32x32x16_bf16 v[96:111], a[188:191], v[132:135], v[96:111]
    buffer_load_dwordx4 v[204:207], v25, s[28:31], s57 offen offset:0 sc1
    s_waitcnt vmcnt(16)
    v_mfma_f32_32x32x16_bf16 v[32:47], a[192:195], v[136:139], v[32:47]
    v_mfma_f32_32x32x16_bf16 v[48:63], a[192:195], v[140:143], v[48:63]
    buffer_load_dwordx4 v[208:211], v7, s[28:31], s57 offen offset:1024 sc1
    v_mfma_f32_32x32x16_bf16 v[72:87], a[196:199], v[136:139], v[72:87]
    v_mfma_f32_32x32x16_bf16 v[96:111], a[196:199], v[140:143], v[96:111]
    buffer_load_dwordx4 v[212:215], v25, s[28:31], s57 offen offset:1024 sc1
    s_waitcnt vmcnt(16)
    v_mfma_f32_32x32x16_bf16 v[32:47], a[200:203], v[144:147], v[32:47]
    v_mfma_f32_32x32x16_bf16 v[48:63], a[200:203], v[148:151], v[48:63]
    buffer_load_dwordx4 v[216:219], v7, s[28:31], s57 offen offset:2048 sc1
    v_mfma_f32_32x32x16_bf16 v[72:87], a[204:207], v[144:147], v[72:87]
    v_mfma_f32_32x32x16_bf16 v[96:111], a[204:207], v[148:151], v[96:111]
    buffer_load_dwordx4 v[220:223], v25, s[28:31], s57 offen offset:2048 sc1
    s_waitcnt vmcnt(16)
    v_mfma_f32_32x32x16_bf16 v[32:47], a[208:211], v[160:163], v[32:47]
    buffer_load_dwordx4 v[224:227], v7, s[28:31], s57 offen offset:3072 sc1
    v_mfma_f32_32x32x16_bf16 v[48:63], a[208:211], v[164:167], v[48:63]
    buffer_load_dwordx4 v[228:231], v25, s[28:31], s57 offen offset:3072 sc1
    v_mfma_f32_32x32x16_bf16 v[72:87], a[212:215], v[160:163], v[72:87]
    ds_read_b64_tr_b16 v[88:89], v28 offset:0
    ds_read_b64_tr_b16 v[90:91], v28 offset:1024
    v_mfma_f32_32x32x16_bf16 v[96:111], a[212:215], v[164:167], v[96:111]
    ds_read_b64_tr_b16 v[92:93], v29 offset:0
    ds_read_b64_tr_b16 v[94:95], v29 offset:1024
    s_waitcnt vmcnt(16)
    s_nop 0
    v_mfma_f32_32x32x16_bf16 v[32:47], a[216:219], v[152:155], v[32:47]
    ds_read_b64_tr_b16 v[64:65], v28 offset:2048
    v_mfma_f32_32x32x16_bf16 v[48:63], a[216:219], v[156:159], v[48:63]
    ds_read_b64_tr_b16 v[66:67], v28 offset:3072
    v_mfma_f32_32x32x16_bf16 v[72:87], a[220:223], v[152:155], v[72:87]
    ds_read_b64_tr_b16 v[68:69], v29 offset:2048
    v_mfma_f32_32x32x16_bf16 v[96:111], a[220:223], v[156:159], v[96:111]
    ds_read_b64_tr_b16 v[70:71], v29 offset:3072
    s_waitcnt vmcnt(14)
    s_waitcnt lgkmcnt(4)
    v_mfma_f32_32x32x16_bf16 v[32:47], v[88:91], v[168:171], v[32:47]
    ds_read_b64_tr_b16 v[8:9], v28 offset:3584
    v_mfma_f32_32x32x16_bf16 v[48:63], v[88:91], v[172:175], v[48:63]
    ds_read_b64_tr_b16 v[10:11], v28 offset:4608
    v_mfma_f32_32x32x16_bf16 v[72:87], v[92:95], v[168:171], v[72:87]
    ds_read_b64_tr_b16 v[12:13], v29 offset:3584
    v_mfma_f32_32x32x16_bf16 v[96:111], v[92:95], v[172:175], v[96:111]
    ds_read_b64_tr_b16 v[14:15], v29 offset:4608
    s_waitcnt vmcnt(12)
    s_waitcnt lgkmcnt(4)
    v_mfma_f32_32x32x16_bf16 v[32:47], v[64:67], v[176:179], v[32:47]
    ds_read_b64_tr_b16 v[240:241], v28 offset:5632
    v_mfma_f32_32x32x16_bf16 v[48:63], v[64:67], v[180:183], v[48:63]
    ds_read_b64_tr_b16 v[242:243], v28 offset:6656
    v_mfma_f32_32x32x16_bf16 v[72:87], v[68:71], v[176:179], v[72:87]
    ds_read_b64_tr_b16 v[244:245], v29 offset:5632
    v_mfma_f32_32x32x16_bf16 v[96:111], v[68:71], v[180:183], v[96:111]
    ds_read_b64_tr_b16 v[246:247], v29 offset:6656
    s_waitcnt vmcnt(10)
    s_waitcnt lgkmcnt(4)
    v_mfma_f32_32x32x16_bf16 v[32:47], v[8:11], v[184:187], v[32:47]
    ds_read_b64_tr_b16 v[88:89], v28 offset:7168
    v_mfma_f32_32x32x16_bf16 v[48:63], v[8:11], v[188:191], v[48:63]
    ds_read_b64_tr_b16 v[90:91], v28 offset:8192
    v_mfma_f32_32x32x16_bf16 v[72:87], v[12:15], v[184:187], v[72:87]
    ds_read_b64_tr_b16 v[92:93], v29 offset:7168
    v_mfma_f32_32x32x16_bf16 v[96:111], v[12:15], v[188:191], v[96:111]
    ds_read_b64_tr_b16 v[94:95], v29 offset:8192
    s_waitcnt vmcnt(8)
    s_waitcnt lgkmcnt(4)
    v_mfma_f32_32x32x16_bf16 v[32:47], v[240:243], v[192:195], v[32:47]
    ds_read_b64_tr_b16 v[64:65], v28 offset:9216
    v_mfma_f32_32x32x16_bf16 v[48:63], v[240:243], v[196:199], v[48:63]
    ds_read_b64_tr_b16 v[66:67], v28 offset:10240
    v_mfma_f32_32x32x16_bf16 v[72:87], v[244:247], v[192:195], v[72:87]
    ds_read_b64_tr_b16 v[68:69], v29 offset:9216
    v_mfma_f32_32x32x16_bf16 v[96:111], v[244:247], v[196:199], v[96:111]
    ds_read_b64_tr_b16 v[70:71], v29 offset:10240
    s_cmp_eq_u32 s40, 3
    s_mul_i32 s58, s40, 4352
    s_mov_b32 s56, 28672
    s_cselect_b32 s56, 4352, s56
    s_add_u32 s58, s58, 7168
    s_cmp_eq_u32 s40, 3
    s_cselect_b32 s58, 122880, s58
    v_add_u32 v25, s58, v7
    v_add_u32 v30, s56, v25
    v_add_u32_e64 v4, s56, v30
    v_add_u32 v5, s56, v4
    s_waitcnt vmcnt(4) lgkmcnt(0)
    v_mfma_f32_32x32x16_bf16 v[32:47], v[88:91], v[200:203], v[32:47]
    ds_read_b64_tr_b16 v[8:9], v28 offset:10752
    ds_read_b64_tr_b16 v[10:11], v28 offset:11776
    v_mfma_f32_32x32x16_bf16 v[32:47], v[64:67], v[208:211], v[32:47]
    ds_read_b64_tr_b16 v[12:13], v29 offset:10752
    ds_read_b64_tr_b16 v[14:15], v29 offset:11776
    v_mfma_f32_32x32x16_bf16 v[48:63], v[88:91], v[204:207], v[48:63]
    ds_read_b64_tr_b16 v[240:241], v28 offset:12800
    ds_read_b64_tr_b16 v[242:243], v24 offset:13824
    v_mfma_f32_32x32x16_bf16 v[48:63], v[64:67], v[212:215], v[48:63]
    ds_read_b64_tr_b16 v[244:245], v29 offset:12800
    ds_read_b64_tr_b16 v[246:247], v26 offset:13824
    v_mfma_f32_32x32x16_bf16 v[72:87], v[92:95], v[200:203], v[72:87]
    v_lshlrev_b32_e64 v112, 16, v16
    v_mfma_f32_32x32x16_bf16 v[72:87], v[68:71], v[208:211], v[72:87]
    v_and_b32 v113, 0xffff0000, v16
    v_lshlrev_b32_e64 v114, 16, v17
    v_mfma_f32_32x32x16_bf16 v[96:111], v[92:95], v[204:207], v[96:111]
    v_and_b32 v115, 0xffff0000, v17
    v_lshlrev_b32_e64 v116, 16, v18
    v_mfma_f32_32x32x16_bf16 v[96:111], v[68:71], v[212:215], v[96:111]
    v_and_b32 v117, 0xffff0000, v18
    v_lshlrev_b32 v118, 16, v19
    s_waitcnt vmcnt(0) lgkmcnt(0)
    v_mfma_f32_32x32x16_bf16 v[32:47], v[8:11], v[216:219], v[32:47]
    v_and_b32 v119, 0xffff0000, v19
    v_lshlrev_b32_e64 v120, 16, v20
    v_and_b32 v121, 0xffff0000, v20
    v_mfma_f32_32x32x16_bf16 v[32:47], v[240:243], v[224:227], v[32:47]
    v_lshlrev_b32_e64 v122, 16, v21
    v_and_b32 v123, 0xffff0000, v21
    v_lshlrev_b32_e64 v124, 16, v22
    v_mfma_f32_32x32x16_bf16 v[48:63], v[8:11], v[220:223], v[48:63]
    v_and_b32 v125, 0xffff0000, v22
    v_lshlrev_b32_e64 v126, 16, v23
    v_and_b32 v127, 0xffff0000, v23
    v_mfma_f32_32x32x16_bf16 v[48:63], v[240:243], v[228:231], v[48:63]
    v_mfma_f32_32x32x16_bf16 v[72:87], v[12:15], v[216:219], v[72:87]
    s_nop 2
    ds_write_b128 v25, v[32:35] offset:0
    ds_write_b128 v25, v[36:39] offset:1088
    v_mfma_f32_32x32x16_bf16 v[72:87], v[244:247], v[224:227], v[72:87]
    ds_write_b128 v25, v[40:43] offset:2176
    ds_write_b128 v25, v[44:47] offset:3264
    v_mfma_f32_32x32x16_bf16 v[96:111], v[12:15], v[220:223], v[96:111]
    s_nop 1
    ds_write_b128 v30, v[48:51] offset:0
    ds_write_b128 v30, v[52:55] offset:1088
    v_mfma_f32_32x32x16_bf16 v[96:111], v[244:247], v[228:231], v[96:111]
    ds_write_b128 v30, v[56:59] offset:2176
    ds_write_b128 v30, v[60:63] offset:3264
    s_nop 1
    ds_write_b128 v4, v[72:75] offset:0
    ds_write_b128 v4, v[76:79] offset:1088
    ds_write_b128 v4, v[80:83] offset:2176
    ds_write_b128 v4, v[84:87] offset:3264
    s_nop 3
    ds_write_b128 v5, v[96:99] offset:0
    ds_write_b128 v5, v[100:103] offset:1088
    ds_write_b128 v5, v[104:107] offset:2176
    ds_write_b128 v5, v[108:111] offset:3264
    s_waitcnt lgkmcnt(0)
    s_barrier
    ds_read_b128 v[128:131], v1 offset:0
    ds_read_b128 v[132:135], v1 offset:512
    ds_read_b128 v[136:139], v1 offset:4352
    ds_read_b128 v[140:143], v1 offset:4864
    ds_read_b128 v[144:147], v1 offset:8704
    ds_read_b128 v[148:151], v1 offset:9216
    ds_read_b128 v[152:155], v2 offset:0
    ds_read_b128 v[156:159], v2 offset:512
    ds_read_b128 v[160:163], v1 offset:128
    ds_read_b128 v[164:167], v1 offset:640
    ds_read_b128 v[168:171], v1 offset:4480
    ds_read_b128 v[172:175], v1 offset:4992
    ds_read_b128 v[176:179], v1 offset:8832
    ds_read_b128 v[180:183], v1 offset:9344
    ds_read_b128 v[184:187], v2 offset:128
    ds_read_b128 v[188:191], v2 offset:640
    s_waitcnt lgkmcnt(15)
    v_pk_add_f32 v[112:113], v[112:113], v[128:129]
    v_pk_add_f32 v[114:115], v[114:115], v[130:131]
    s_waitcnt lgkmcnt(14)
    v_pk_add_f32 v[116:117], v[116:117], v[132:133]
    v_pk_add_f32 v[118:119], v[118:119], v[134:135]
    s_waitcnt lgkmcnt(13)
    v_pk_add_f32 v[112:113], v[112:113], v[136:137]
    v_pk_add_f32 v[114:115], v[114:115], v[138:139]
    s_waitcnt lgkmcnt(12)
    v_pk_add_f32 v[116:117], v[116:117], v[140:141]
    v_pk_add_f32 v[118:119], v[118:119], v[142:143]
    s_waitcnt lgkmcnt(11)
    v_pk_add_f32 v[112:113], v[112:113], v[144:145]
    v_pk_add_f32 v[114:115], v[114:115], v[146:147]
    s_waitcnt lgkmcnt(10)
    v_pk_add_f32 v[116:117], v[116:117], v[148:149]
    v_pk_add_f32 v[118:119], v[118:119], v[150:151]
    s_waitcnt lgkmcnt(9)
    v_pk_add_f32 v[112:113], v[112:113], v[152:153]
    v_pk_add_f32 v[114:115], v[114:115], v[154:155]
    s_waitcnt lgkmcnt(8)
    v_pk_add_f32 v[116:117], v[116:117], v[156:157]
    v_pk_add_f32 v[118:119], v[118:119], v[158:159]
    v_cvt_pk_bf16_f32 v16, v112, v113
    v_cvt_pk_bf16_f32 v17, v114, v115
    v_cvt_pk_bf16_f32 v18, v116, v117
    v_cvt_pk_bf16_f32 v19, v118, v119
    buffer_store_dwordx4 v[16:19], v27, s[32:35], s44 offen sc1
    s_waitcnt lgkmcnt(7)
    v_pk_add_f32 v[120:121], v[120:121], v[160:161]
    v_pk_add_f32 v[122:123], v[122:123], v[162:163]
    s_waitcnt lgkmcnt(6)
    v_pk_add_f32 v[124:125], v[124:125], v[164:165]
    v_pk_add_f32 v[126:127], v[126:127], v[166:167]
    s_waitcnt lgkmcnt(5)
    v_pk_add_f32 v[120:121], v[120:121], v[168:169]
    v_pk_add_f32 v[122:123], v[122:123], v[170:171]
    s_waitcnt lgkmcnt(4)
    v_pk_add_f32 v[124:125], v[124:125], v[172:173]
    v_pk_add_f32 v[126:127], v[126:127], v[174:175]
    s_waitcnt lgkmcnt(3)
    v_pk_add_f32 v[120:121], v[120:121], v[176:177]
    v_pk_add_f32 v[122:123], v[122:123], v[178:179]
    s_waitcnt lgkmcnt(2)
    v_pk_add_f32 v[124:125], v[124:125], v[180:181]
    v_pk_add_f32 v[126:127], v[126:127], v[182:183]
    s_waitcnt lgkmcnt(1)
    v_pk_add_f32 v[120:121], v[120:121], v[184:185]
    v_pk_add_f32 v[122:123], v[122:123], v[186:187]
    s_waitcnt lgkmcnt(0)
    v_pk_add_f32 v[124:125], v[124:125], v[188:189]
    v_pk_add_f32 v[126:127], v[126:127], v[190:191]
    v_cvt_pk_bf16_f32 v20, v120, v121
    v_cvt_pk_bf16_f32 v21, v122, v123
    v_cvt_pk_bf16_f32 v22, v124, v125
    v_cvt_pk_bf16_f32 v23, v126, v127
    buffer_store_dwordx4 v[20:23], v27, s[32:35], s94 offen sc1
    s_endpgm
L_nog2:
    s_waitcnt vmcnt(0)
    buffer_store_dword v255, v0, s[28:31], s3 offen sc1
    s_endpgm
Lslow_1:
    s_mov_b32 s97, 0
Lspin_23:
    buffer_load_dword v255, off, s[36:39], 0 sc1
    s_add_u32 s97, s97, 1
    s_waitcnt vmcnt(0)
    v_cmp_eq_u32_e64 vcc, 0, v255
    s_cmp_lt_u32 s97, 200000
    s_cselect_b64 vcc, vcc, 0
    s_cbranch_vccnz Lspin_23
    s_branch Lback_2
Lslow_3:
    s_mov_b32 s97, 0
Lspin_24:
    buffer_load_dword v247, v244, s[28:31], 0 offen sc1
    s_add_u32 s97, s97, 1
    s_waitcnt vmcnt(0)
    v_cmp_ne_u32 vcc, v247, v255
    s_and_b64 vcc, vcc, s[90:91]
    s_cmp_lt_u32 s97, 200000
    s_cselect_b64 vcc, vcc, 0
    s_cbranch_vccnz Lspin_24
    s_branch Lback_4
Lslow_5:
    s_mov_b32 s97, 0
Lspin_25:
    buffer_load_dword v255, off, s[36:39], 0 sc1
    s_add_u32 s97, s97, 1
    s_waitcnt vmcnt(0)
    v_cmp_eq_u32_e64 vcc, 0, v255
    s_cmp_lt_u32 s97, 200000
    s_cselect_b64 vcc, vcc, 0
    s_cbranch_vccnz Lspin_25
    s_branch Lback_6
Lslow_7:
    s_mov_b32 s97, 0
Lspin_26:
    buffer_load_dword v247, v244, s[28:31], 0 offen sc1
    s_add_u32 s97, s97, 1
    s_waitcnt vmcnt(0)
    v_cmp_ne_u32 vcc, v247, v255
    s_and_b64 vcc, vcc, s[90:91]
    s_cmp_lt_u32 s97, 200000
    s_cselect_b64 vcc, vcc, 0
    s_cbranch_vccnz Lspin_26
    s_branch Lback_8
Lslow_9:
    s_mov_b32 s97, 0
Lspin_27:
    buffer_load_dword v255, off, s[36:39], 0 sc1
    s_add_u32 s97, s97, 1
    s_waitcnt vmcnt(0)
    v_cmp_eq_u32_e64 vcc, 0, v255
    s_cmp_lt_u32 s97, 200000
    s_cselect_b64 vcc, vcc, 0
    s_cbranch_vccnz Lspin_27
    s_branch Lback_10
Lslow_11:
    s_mov_b32 s97, 0
Lspin_28:
    buffer_load_dword v247, v244, s[28:31], 0 offen sc1
    s_add_u32 s97, s97, 1
    s_waitcnt vmcnt(0)
    v_cmp_ne_u32 vcc, v247, v255
    s_and_b64 vcc, vcc, s[90:91]
    s_cmp_lt_u32 s97, 200000
    s_cselect_b64 vcc, vcc, 0
    s_cbranch_vccnz Lspin_28
    s_branch Lback_12
Lslow_13:
    s_mov_b32 s97, 0
Lspin_29:
    buffer_load_dword v255, off, s[36:39], 0 sc1
    s_add_u32 s97, s97, 1
    s_waitcnt vmcnt(0)
    v_cmp_eq_u32_e64 vcc, 0, v255
    s_cmp_lt_u32 s97, 200000
    s_cselect_b64 vcc, vcc, 0
    s_cbranch_vccnz Lspin_29
    s_branch Lback_14
Lslow_15:
    s_mov_b32 s97, 0
Lspin_30:
    buffer_load_dword v247, v244, s[28:31], 0 offen sc1
    s_add_u32 s97, s97, 1
    s_waitcnt vmcnt(0)
    v_cmp_ne_u32 vcc, v247, v255
    s_and_b64 vcc, vcc, s[90:91]
    s_cmp_lt_u32 s97, 200000
    s_cselect_b64 vcc, vcc, 0
    s_cbranch_vccnz Lspin_30
    s_branch Lback_16
Lslow_17:
    s_mov_b32 s97, 0
Lspin_31:
    buffer_load_dword v247, v26, s[28:31], 0 offen sc1
    s_add_u32 s97, s97, 1
    s_waitcnt vmcnt(0)
    v_cmp_ne_u32 vcc, v247, v255
    s_and_b64 vcc, vcc, s[78:79]
    s_cmp_lt_u32 s97, 200000
    s_cselect_b64 vcc, vcc, 0
    s_cbranch_vccnz Lspin_31
    s_branch Lback_18
L_truemax:
    s_waitcnt lgkmcnt(0)
    v_mov_b32 v88, 0xf149f2ca
    v_mov_b32 v240, 0xf149f2ca
    ds_read2st64_b64 v[96:99], v16 offset0:0 offset1:1
    ds_read2st64_b64 v[100:103], v16 offset0:2 offset1:3
    s_waitcnt lgkmcnt(0)
    s_nop 0
    v_mfma_f32_32x32x16_bf16 v[48:63], v[96:99], v[64:67], 0
    v_mfma_f32_32x32x16_bf16 v[48:63], v[100:103], v[68:71], v[48:63]
    s_nop 7
    s_nop 3
    v_cndmask_b32 v48, v48, v88, s[8:9]
    v_cndmask_b32 v49, v49, v88, s[10:11]
    v_cndmask_b32 v50, v50, v88, s[12:13]
    v_cndmask_b32 v51, v51, v88, s[14:15]
    v_cndmask_b32 v52, v52, v88, s[16:17]
    v_cndmask_b32 v53, v53, v88, s[18:19]
    v_cndmask_b32 v54, v54, v88, s[36:37]
    v_cndmask_b32 v55, v55, v88, s[38:39]
    v_cndmask_b32 v56, v56, v88, s[46:47]
    v_cndmask_b32 v57, v57, v88, s[48:49]
    v_cndmask_b32 v58, v58, v88, s[50:51]
    v_cndmask_b32 v59, v59, v88, s[52:53]
    v_cndmask_b32 v60, v60, v88, s[64:65]
    v_cndmask_b32 v61, v61, v88, s[66:67]
    v_cndmask_b32 v62, v62, v88, s[68:69]
    v_cndmask_b32 v63, v63, v88, s[76:77]
    v_max3_f32 v240, v48, v49, v240
    v_max3_f32 v240, v50, v51, v240
    v_max3_f32 v240, v52, v53, v240
    v_max3_f32 v240, v54, v55, v240
    v_max3_f32 v240, v56, v57, v240
    v_max3_f32 v240, v58, v59, v240
    v_max3_f32 v240, v60, v61, v240
    v_max3_f32 v240, v62, v63, v240
    ds_read2st64_b64 v[96:99], v17 offset0:0 offset1:1
    ds_read2st64_b64 v[100:103], v17 offset0:2 offset1:3
    s_waitcnt lgkmcnt(0)
    s_nop 0
    v_mfma_f32_32x32x16_bf16 v[48:63], v[96:99], v[64:67], 0
    v_mfma_f32_32x32x16_bf16 v[48:63], v[100:103], v[68:71], v[48:63]
    s_nop 7
    s_nop 3
    v_max3_f32 v240, v48, v49, v240
    v_max3_f32 v240, v50, v51, v240
    v_max3_f32 v240, v52, v53, v240
    v_max3_f32 v240, v54, v55, v240
    v_max3_f32 v240, v56, v57, v240
    v_max3_f32 v240, v58, v59, v240
    v_max3_f32 v240, v60, v61, v240
    v_max3_f32 v240, v62, v63, v240
    ds_read2st64_b64 v[96:99], v18 offset0:0 offset1:1
    ds_read2st64_b64 v[100:103], v18 offset0:2 offset1:3
    s_waitcnt lgkmcnt(0)
    s_nop 0
    v_mfma_f32_32x32x16_bf16 v[48:63], v[96:99], v[64:67], 0
    v_mfma_f32_32x32x16_bf16 v[48:63], v[100:103], v[68:71], v[48:63]
    s_nop 7
    s_nop 3
    v_max3_f32 v240, v48, v49, v240
    v_max3_f32 v240, v50, v51, v240
    v_max3_f32 v240, v52, v53, v240
    v_max3_f32 v240, v54, v55, v240
    v_max3_f32 v240, v56, v57, v240
    v_max3_f32 v240, v58, v59, v240
    v_max3_f32 v240, v60, v61, v240
    v_max3_f32 v240, v62, v63, v240
    ds_read2st64_b64 v[96:99], v16 offset0:56 offset1:57
    ds_read2st64_b64 v[100:103], v16 offset0:58 offset1:59
    s_waitcnt lgkmcnt(0)
    s_nop 0
    v_mfma_f32_32x32x16_bf16 v[48:63], v[96:99], v[64:67], 0
    v_mfma_f32_32x32x16_bf16 v[48:63], v[100:103], v[68:71], v[48:63]
    s_nop 7
    s_nop 3
    v_max3_f32 v240, v48, v49, v240
    v_max3_f32 v240, v50, v51, v240
    v_max3_f32 v240, v52, v53, v240
    v_max3_f32 v240, v54, v55, v240
    v_max3_f32 v240, v56, v57, v240
    v_max3_f32 v240, v58, v59, v240
    v_max3_f32 v240, v60, v61, v240
    v_max3_f32 v240, v62, v63, v240
    ds_read2st64_b64 v[96:99], v17 offset0:56 offset1:57
    ds_read2st64_b64 v[100:103], v17 offset0:58 offset1:59
    s_waitcnt lgkmcnt(0)
    s_nop 0
    v_mfma_f32_32x32x16_bf16 v[48:63], v[96:99], v[64:67], 0
    v_mfma_f32_32x32x16_bf16 v[48:63], v[100:103], v[68:71], v[48:63]
    s_nop 7
    s_nop 3
    v_max3_f32 v240, v48, v49, v240
    v_max3_f32 v240, v50, v51, v240
    v_max3_f32 v240, v52, v53, v240
    v_max3_f32 v240, v54, v55, v240
    v_max3_f32 v240, v56, v57, v240
    v_max3_f32 v240, v58, v59, v240
    v_max3_f32 v240, v60, v61, v240
    v_max3_f32 v240, v62, v63, v240
    ds_read2st64_b64 v[96:99], v18 offset0:56 offset1:57
    ds_read2st64_b64 v[100:103], v18 offset0:58 offset1:59
    s_waitcnt lgkmcnt(0)
    s_nop 0
    v_mfma_f32_32x32x16_bf16 v[48:63], v[96:99], v[64:67], 0
    v_mfma_f32_32x32x16_bf16 v[48:63], v[100:103], v[68:71], v[48:63]
    s_nop 7
    s_nop 3
    v_max3_f32 v240, v48, v49, v240
    v_max3_f32 v240, v50, v51, v240
    v_max3_f32 v240, v52, v53, v240
    v_max3_f32 v240, v54, v55, v240
    v_max3_f32 v240, v56, v57, v240
    v_max3_f32 v240, v58, v59, v240
    v_max3_f32 v240, v60, v61, v240
    v_max3_f32 v240, v62, v63, v240
    ds_read2st64_b64 v[96:99], v16 offset0:112 offset1:113
    ds_read2st64_b64 v[100:103], v16 offset0:114 offset1:115
    s_waitcnt lgkmcnt(0)
    s_nop 0
    v_mfma_f32_32x32x16_bf16 v[48:63], v[96:99], v[64:67], 0
    v_mfma_f32_32x32x16_bf16 v[48:63], v[100:103], v[68:71], v[48:63]
    s_nop 7
    s_nop 3
    v_max3_f32 v240, v48, v49, v240
    v_max3_f32 v240, v50, v51, v240
    v_max3_f32 v240, v52, v53, v240
    v_max3_f32 v240, v54, v55, v240
    v_max3_f32 v240, v56, v57, v240
    v_max3_f32 v240, v58, v59, v240
    v_max3_f32 v240, v60, v61, v240
    v_max3_f32 v240, v62, v63, v240
    ds_read2st64_b64 v[96:99], v17 offset0:112 offset1:113
    ds_read2st64_b64 v[100:103], v17 offset0:114 offset1:115
    s_waitcnt lgkmcnt(0)
    s_nop 0
    v_mfma_f32_32x32x16_bf16 v[48:63], v[96:99], v[64:67], 0
    v_mfma_f32_32x32x16_bf16 v[48:63], v[100:103], v[68:71], v[48:63]
    s_nop 7
    s_nop 3
    v_max3_f32 v240, v48, v49, v240
    v_max3_f32 v240, v50, v51, v240
    v_max3_f32 v240, v52, v53, v240
    v_max3_f32 v240, v54, v55, v240
    v_max3_f32 v240, v56, v57, v240
    v_max3_f32 v240, v58, v59, v240
    v_max3_f32 v240, v60, v61, v240
    v_max3_f32 v240, v62, v63, v240
    ds_read2st64_b64 v[96:99], v18 offset0:112 offset1:113
    ds_read2st64_b64 v[100:103], v18 offset0:114 offset1:115
    s_waitcnt lgkmcnt(0)
    s_nop 0
    v_mfma_f32_32x32x16_bf16 v[48:63], v[96:99], v[64:67], 0
    v_mfma_f32_32x32x16_bf16 v[48:63], v[100:103], v[68:71], v[48:63]
    s_nop 7
    s_nop 3
    v_cndmask_b32 v48, v88, v48, s[8:9]
    v_cndmask_b32 v49, v88, v49, s[10:11]
    v_cndmask_b32 v50, v88, v50, s[12:13]
    v_cndmask_b32 v51, v88, v51, s[14:15]
    v_cndmask_b32 v52, v88, v52, s[16:17]
    v_cndmask_b32 v53, v88, v53, s[18:19]
    v_cndmask_b32 v54, v88, v54, s[36:37]
    v_cndmask_b32 v55, v88, v55, s[38:39]
    v_cndmask_b32 v56, v88, v56, s[46:47]
    v_cndmask_b32 v57, v88, v57, s[48:49]
    v_cndmask_b32 v58, v88, v58, s[50:51]
    v_cndmask_b32 v59, v88, v59, s[52:53]
    v_cndmask_b32 v60, v88, v60, s[64:65]
    v_cndmask_b32 v61, v88, v61, s[66:67]
    v_cndmask_b32 v62, v88, v62, s[68:69]
    v_cndmask_b32 v63, v88, v63, s[76:77]
    v_max3_f32 v240, v48, v49, v240
    v_max3_f32 v240, v50, v51, v240
    v_max3_f32 v240, v52, v53, v240
    v_max3_f32 v240, v54, v55, v240
    v_max3_f32 v240, v56, v57, v240
    v_max3_f32 v240, v58, v59, v240
    v_max3_f32 v240, v60, v61, v240
    v_max3_f32 v240, v62, v63, v240
    v_mov_b32 v241, v240
    s_nop 1
    v_permlane32_swap_b32 v240, v241
    v_max_f32 v240, v240, v241
    v_sub_f32 v72, 0, v240
    v_sub_f32 v73, 0, v240
    v_sub_f32 v74, 0, v240
    v_sub_f32 v75, 0, v240
    v_sub_f32 v76, 0, v240
    v_sub_f32 v77, 0, v240
    v_sub_f32 v78, 0, v240
    v_sub_f32 v79, 0, v240
    v_sub_f32 v80, 0, v240
    v_sub_f32 v81, 0, v240
    v_sub_f32 v82, 0, v240
    v_sub_f32 v83, 0, v240
    v_sub_f32 v84, 0, v240
    v_sub_f32 v85, 0, v240
    v_sub_f32 v86, 0, v240
    v_sub_f32 v87, 0, v240
    s_nop 1
    ds_read2st64_b64 v[96:99], v16 offset0:0 offset1:1
    ds_read2st64_b64 v[100:103], v16 offset0:2 offset1:3
    ds_read_b128 v[152:155], v19 offset:2048
    ds_read_b128 v[156:159], v19 offset:3072
    s_waitcnt lgkmcnt(2)
    v_mfma_f32_32x32x16_bf16 v[48:63], v[96:99], v[64:67], v[72:87]
    v_mfma_f32_32x32x16_bf16 v[48:63], v[100:103], v[68:71], v[48:63]
    s_nop 7
    s_nop 3
    v_cndmask_b32 v48, v48, v88, s[8:9]
    v_cndmask_b32 v49, v49, v88, s[10:11]
    v_cndmask_b32 v50, v50, v88, s[12:13]
    v_cndmask_b32 v51, v51, v88, s[14:15]
    v_cndmask_b32 v52, v52, v88, s[16:17]
    v_cndmask_b32 v53, v53, v88, s[18:19]
    v_cndmask_b32 v54, v54, v88, s[36:37]
    v_cndmask_b32 v55, v55, v88, s[38:39]
    v_cndmask_b32 v56, v56, v88, s[46:47]
    v_cndmask_b32 v57, v57, v88, s[48:49]
    v_cndmask_b32 v58, v58, v88, s[50:51]
    v_cndmask_b32 v59, v59, v88, s[52:53]
    v_cndmask_b32 v60, v60, v88, s[64:65]
    v_cndmask_b32 v61, v61, v88, s[66:67]
    v_cndmask_b32 v62, v62, v88, s[68:69]
    v_cndmask_b32 v63, v63, v88, s[76:77]
    v_exp_f32 v48, v48
    v_exp_f32 v49, v49
    v_exp_f32 v50, v50
    v_exp_f32 v51, v51
    v_exp_f32 v52, v52
    v_exp_f32 v53, v53
    v_exp_f32 v54, v54
    v_exp_f32 v55, v55
    v_exp_f32 v56, v56
    v_exp_f32 v57, v57
    v_exp_f32 v58, v58
    v_exp_f32 v59, v59
    v_exp_f32 v60, v60
    v_exp_f32 v61, v61
    v_exp_f32_e64 v62, v62
    v_exp_f32 v63, v63
    s_nop 0
    v_cvt_pk_bf16_f32 v104, v48, v49
    v_cvt_pk_bf16_f32 v105, v50, v51
    v_cvt_pk_bf16_f32 v106, v52, v53
    v_cvt_pk_bf16_f32 v107, v54, v55
    v_cvt_pk_bf16_f32 v108, v56, v57
    v_cvt_pk_bf16_f32 v109, v58, v59
    v_cvt_pk_bf16_f32 v110, v60, v61
    v_cvt_pk_bf16_f32 v111, v62, v63
    s_nop 1
    s_waitcnt lgkmcnt(0)
    v_mfma_f32_32x32x16_bf16 v[112:127], v[152:155], v[104:107], 0
    v_mfma_f32_32x32x16_bf16 v[112:127], v[156:159], v[108:111], v[112:127]
    ds_read2st64_b64 v[96:99], v17 offset0:0 offset1:1
    ds_read2st64_b64 v[100:103], v17 offset0:2 offset1:3
    ds_read_b128 v[152:155], v20 offset:2048
    ds_read_b128 v[156:159], v20 offset:3072
    s_waitcnt lgkmcnt(2)
    v_mfma_f32_32x32x16_bf16 v[48:63], v[96:99], v[64:67], v[72:87]
    v_mfma_f32_32x32x16_bf16 v[48:63], v[100:103], v[68:71], v[48:63]
    s_nop 7
    s_nop 3
    v_exp_f32 v48, v48
    v_exp_f32 v49, v49
    v_exp_f32 v50, v50
    v_exp_f32 v51, v51
    v_exp_f32 v52, v52
    v_exp_f32 v53, v53
    v_exp_f32 v54, v54
    v_exp_f32 v55, v55
    v_exp_f32 v56, v56
    v_exp_f32 v57, v57
    v_exp_f32 v58, v58
    v_exp_f32 v59, v59
    v_exp_f32 v60, v60
    v_exp_f32 v61, v61
    v_exp_f32 v62, v62
    v_exp_f32 v63, v63
    s_nop 0
    v_cvt_pk_bf16_f32 v104, v48, v49
    v_cvt_pk_bf16_f32 v105, v50, v51
    v_cvt_pk_bf16_f32 v106, v52, v53
    v_cvt_pk_bf16_f32 v107, v54, v55
    v_cvt_pk_bf16_f32 v108, v56, v57
    v_cvt_pk_bf16_f32 v109, v58, v59
    v_cvt_pk_bf16_f32 v110, v60, v61
    v_cvt_pk_bf16_f32 v111, v62, v63
    s_nop 1
    s_waitcnt lgkmcnt(0)
    v_mfma_f32_32x32x16_bf16 v[112:127], v[152:155], v[104:107], v[112:127]
    v_mfma_f32_32x32x16_bf16 v[112:127], v[156:159], v[108:111], v[112:127]
    ds_read2st64_b64 v[96:99], v18 offset0:0 offset1:1
    ds_read2st64_b64 v[100:103], v18 offset0:2 offset1:3
    ds_read_b128 v[152:155], v21 offset:2048
    ds_read_b128 v[156:159], v21 offset:3072
    s_waitcnt lgkmcnt(2)
    v_mfma_f32_32x32x16_bf16 v[48:63], v[96:99], v[64:67], v[72:87]
    v_mfma_f32_32x32x16_bf16 v[48:63], v[100:103], v[68:71], v[48:63]
    s_nop 7
    s_nop 3
    v_exp_f32 v48, v48
    v_exp_f32 v49, v49
    v_exp_f32 v50, v50
    v_exp_f32 v51, v51
    v_exp_f32 v52, v52
    v_exp_f32 v53, v53
    v_exp_f32 v54, v54
    v_exp_f32 v55, v55
    v_exp_f32 v56, v56
    v_exp_f32 v57, v57
    v_exp_f32 v58, v58
    v_exp_f32 v59, v59
    v_exp_f32 v60, v60
    v_exp_f32 v61, v61
    v_exp_f32 v62, v62
    v_exp_f32 v63, v63
    s_nop 0
    v_cvt_pk_bf16_f32 v104, v48, v49
    v_cvt_pk_bf16_f32 v105, v50, v51
    v_cvt_pk_bf16_f32 v106, v52, v53
    v_cvt_pk_bf16_f32 v107, v54, v55
    v_cvt_pk_bf16_f32 v108, v56, v57
    v_cvt_pk_bf16_f32 v109, v58, v59
    v_cvt_pk_bf16_f32 v110, v60, v61
    v_cvt_pk_bf16_f32 v111, v62, v63
    s_nop 1
    s_waitcnt lgkmcnt(0)
    v_mfma_f32_32x32x16_bf16 v[112:127], v[152:155], v[104:107], v[112:127]
    v_mfma_f32_32x32x16_bf16 v[112:127], v[156:159], v[108:111], v[112:127]
    ds_read2st64_b64 v[96:99], v16 offset0:56 offset1:57
    ds_read2st64_b64 v[100:103], v16 offset0:58 offset1:59
    ds_read_b128 v[152:155], v19 offset:30720
    ds_read_b128 v[156:159], v19 offset:31744
    s_waitcnt lgkmcnt(2)
    v_mfma_f32_32x32x16_bf16 v[48:63], v[96:99], v[64:67], v[72:87]
    v_mfma_f32_32x32x16_bf16 v[48:63], v[100:103], v[68:71], v[48:63]
    s_nop 7
    s_nop 3
    v_exp_f32 v48, v48
    v_exp_f32 v49, v49
    v_exp_f32 v50, v50
    v_exp_f32 v51, v51
    v_exp_f32 v52, v52
    v_exp_f32 v53, v53
    v_exp_f32 v54, v54
    v_exp_f32 v55, v55
    v_exp_f32 v56, v56
    v_exp_f32 v57, v57
    v_exp_f32 v58, v58
    v_exp_f32 v59, v59
    v_exp_f32 v60, v60
    v_exp_f32 v61, v61
    v_exp_f32 v62, v62
    v_exp_f32 v63, v63
    s_nop 0
    v_cvt_pk_bf16_f32 v104, v48, v49
    v_cvt_pk_bf16_f32 v105, v50, v51
    v_cvt_pk_bf16_f32 v106, v52, v53
    v_cvt_pk_bf16_f32 v107, v54, v55
    v_cvt_pk_bf16_f32 v108, v56, v57
    v_cvt_pk_bf16_f32 v109, v58, v59
    v_cvt_pk_bf16_f32 v110, v60, v61
    v_cvt_pk_bf16_f32 v111, v62, v63
    s_nop 1
    s_waitcnt lgkmcnt(0)
    v_mfma_f32_32x32x16_bf16 v[112:127], v[152:155], v[104:107], v[112:127]
    v_mfma_f32_32x32x16_bf16 v[112:127], v[156:159], v[108:111], v[112:127]
    ds_read2st64_b64 v[96:99], v17 offset0:56 offset1:57
    ds_read2st64_b64 v[100:103], v17 offset0:58 offset1:59
    ds_read_b128 v[152:155], v20 offset:30720
    ds_read_b128 v[156:159], v20 offset:31744
    s_waitcnt lgkmcnt(2)
    v_mfma_f32_32x32x16_bf16 v[48:63], v[96:99], v[64:67], v[72:87]
    v_mfma_f32_32x32x16_bf16 v[48:63], v[100:103], v[68:71], v[48:63]
    s_nop 7
    s_nop 3
    v_exp_f32 v48, v48
    v_exp_f32 v49, v49
    v_exp_f32 v50, v50
    v_exp_f32 v51, v51
    v_exp_f32 v52, v52
    v_exp_f32 v53, v53
    v_exp_f32 v54, v54
    v_exp_f32 v55, v55
    v_exp_f32 v56, v56
    v_exp_f32 v57, v57
    v_exp_f32 v58, v58
    v_exp_f32 v59, v59
    v_exp_f32 v60, v60
    v_exp_f32 v61, v61
    v_exp_f32 v62, v62
    v_exp_f32 v63, v63
    s_nop 0
    v_cvt_pk_bf16_f32 v104, v48, v49
    v_cvt_pk_bf16_f32 v105, v50, v51
    v_cvt_pk_bf16_f32 v106, v52, v53
    v_cvt_pk_bf16_f32 v107, v54, v55
    v_cvt_pk_bf16_f32 v108, v56, v57
    v_cvt_pk_bf16_f32 v109, v58, v59
    v_cvt_pk_bf16_f32 v110, v60, v61
    v_cvt_pk_bf16_f32 v111, v62, v63
    s_nop 1
    s_waitcnt lgkmcnt(0)
    v_mfma_f32_32x32x16_bf16 v[112:127], v[152:155], v[104:107], v[112:127]
    v_mfma_f32_32x32x16_bf16 v[112:127], v[156:159], v[108:111], v[112:127]
    ds_read2st64_b64 v[96:99], v18 offset0:56 offset1:57
    ds_read2st64_b64 v[100:103], v18 offset0:58 offset1:59
    ds_read_b128 v[152:155], v21 offset:30720
    ds_read_b128 v[156:159], v21 offset:31744
    s_waitcnt lgkmcnt(2)
    v_mfma_f32_32x32x16_bf16 v[48:63], v[96:99], v[64:67], v[72:87]
    v_mfma_f32_32x32x16_bf16 v[48:63], v[100:103], v[68:71], v[48:63]
    s_nop 7
    s_nop 3
    v_exp_f32 v48, v48
    v_exp_f32 v49, v49
    v_exp_f32 v50, v50
    v_exp_f32 v51, v51
    v_exp_f32 v52, v52
    v_exp_f32 v53, v53
    v_exp_f32 v54, v54
    v_exp_f32 v55, v55
    v_exp_f32 v56, v56
    v_exp_f32 v57, v57
    v_exp_f32 v58, v58
    v_exp_f32 v59, v59
    v_exp_f32 v60, v60
    v_exp_f32 v61, v61
    v_exp_f32 v62, v62
    v_exp_f32 v63, v63
    s_nop 0
    v_cvt_pk_bf16_f32 v104, v48, v49
    v_cvt_pk_bf16_f32 v105, v50, v51
    v_cvt_pk_bf16_f32 v106, v52, v53
    v_cvt_pk_bf16_f32 v107, v54, v55
    v_cvt_pk_bf16_f32 v108, v56, v57
    v_cvt_pk_bf16_f32 v109, v58, v59
    v_cvt_pk_bf16_f32 v110, v60, v61
    v_cvt_pk_bf16_f32 v111, v62, v63
    s_nop 1
    s_waitcnt lgkmcnt(0)
    v_mfma_f32_32x32x16_bf16 v[112:127], v[152:155], v[104:107], v[112:127]
    v_mfma_f32_32x32x16_bf16 v[112:127], v[156:159], v[108:111], v[112:127]
    ds_read2st64_b64 v[96:99], v16 offset0:112 offset1:113
    ds_read2st64_b64 v[100:103], v16 offset0:114 offset1:115
    ds_read_b128 v[152:155], v19 offset:59392
    ds_read_b128 v[156:159], v19 offset:60416
    s_waitcnt lgkmcnt(2)
    v_mfma_f32_32x32x16_bf16 v[48:63], v[96:99], v[64:67], v[72:87]
    v_mfma_f32_32x32x16_bf16 v[48:63], v[100:103], v[68:71], v[48:63]
    s_nop 7
    s_nop 3
    v_exp_f32 v48, v48
    v_exp_f32 v49, v49
    v_exp_f32 v50, v50
    v_exp_f32 v51, v51
    v_exp_f32 v52, v52
    v_exp_f32 v53, v53
    v_exp_f32 v54, v54
    v_exp_f32 v55, v55
    v_exp_f32 v56, v56
    v_exp_f32 v57, v57
    v_exp_f32 v58, v58
    v_exp_f32 v59, v59
    v_exp_f32 v60, v60
    v_exp_f32 v61, v61
    v_exp_f32 v62, v62
    v_exp_f32 v63, v63
    s_nop 0
    v_cvt_pk_bf16_f32 v104, v48, v49
    v_cvt_pk_bf16_f32 v105, v50, v51
    v_cvt_pk_bf16_f32 v106, v52, v53
    v_cvt_pk_bf16_f32 v107, v54, v55
    v_cvt_pk_bf16_f32 v108, v56, v57
    v_cvt_pk_bf16_f32 v109, v58, v59
    v_cvt_pk_bf16_f32 v110, v60, v61
    v_cvt_pk_bf16_f32 v111, v62, v63
    s_nop 1
    s_waitcnt lgkmcnt(0)
    v_mfma_f32_32x32x16_bf16 v[112:127], v[152:155], v[104:107], v[112:127]
    v_mfma_f32_32x32x16_bf16 v[112:127], v[156:159], v[108:111], v[112:127]
    ds_read2st64_b64 v[96:99], v17 offset0:112 offset1:113
    ds_read2st64_b64 v[100:103], v17 offset0:114 offset1:115
    ds_read_b128 v[152:155], v20 offset:59392
    ds_read_b128 v[156:159], v20 offset:60416
    s_waitcnt lgkmcnt(2)
    v_mfma_f32_32x32x16_bf16 v[48:63], v[96:99], v[64:67], v[72:87]
    v_mfma_f32_32x32x16_bf16 v[48:63], v[100:103], v[68:71], v[48:63]
    s_nop 7
    s_nop 3
    v_exp_f32 v48, v48
    v_exp_f32 v49, v49
    v_exp_f32 v50, v50
    v_exp_f32 v51, v51
    v_exp_f32 v52, v52
    v_exp_f32 v53, v53
    v_exp_f32 v54, v54
    v_exp_f32 v55, v55
    v_exp_f32 v56, v56
    v_exp_f32 v57, v57
    v_exp_f32 v58, v58
    v_exp_f32 v59, v59
    v_exp_f32 v60, v60
    v_exp_f32 v61, v61
    v_exp_f32 v62, v62
    v_exp_f32 v63, v63
    s_nop 0
    v_cvt_pk_bf16_f32 v104, v48, v49
    v_cvt_pk_bf16_f32 v105, v50, v51
    v_cvt_pk_bf16_f32 v106, v52, v53
    v_cvt_pk_bf16_f32 v107, v54, v55
    v_cvt_pk_bf16_f32 v108, v56, v57
    v_cvt_pk_bf16_f32 v109, v58, v59
    v_cvt_pk_bf16_f32 v110, v60, v61
    v_cvt_pk_bf16_f32 v111, v62, v63
    s_nop 1
    s_waitcnt lgkmcnt(0)
    v_mfma_f32_32x32x16_bf16 v[112:127], v[152:155], v[104:107], v[112:127]
    v_mfma_f32_32x32x16_bf16 v[112:127], v[156:159], v[108:111], v[112:127]
    ds_read2st64_b64 v[96:99], v18 offset0:112 offset1:113
    ds_read2st64_b64 v[100:103], v18 offset0:114 offset1:115
    ds_read_b128 v[152:155], v21 offset:59392
    ds_read_b128 v[156:159], v21 offset:60416
    s_waitcnt lgkmcnt(2)
    s_nop 0
    v_mfma_f32_32x32x16_bf16 v[48:63], v[96:99], v[64:67], v[72:87]
    v_mfma_f32_32x32x16_bf16 v[48:63], v[100:103], v[68:71], v[48:63]
    s_nop 7
    s_nop 3
    v_cndmask_b32 v48, v88, v48, s[8:9]
    v_cndmask_b32 v49, v88, v49, s[10:11]
    v_cndmask_b32 v50, v88, v50, s[12:13]
    v_cndmask_b32 v51, v88, v51, s[14:15]
    v_cndmask_b32 v52, v88, v52, s[16:17]
    v_cndmask_b32 v53, v88, v53, s[18:19]
    v_cndmask_b32 v54, v88, v54, s[36:37]
    v_cndmask_b32 v55, v88, v55, s[38:39]
    v_cndmask_b32 v56, v88, v56, s[46:47]
    v_cndmask_b32 v57, v88, v57, s[48:49]
    v_cndmask_b32 v58, v88, v58, s[50:51]
    v_cndmask_b32 v59, v88, v59, s[52:53]
    v_cndmask_b32 v60, v88, v60, s[64:65]
    v_cndmask_b32 v61, v88, v61, s[66:67]
    v_cndmask_b32 v62, v88, v62, s[68:69]
    v_cndmask_b32 v63, v88, v63, s[76:77]
    v_exp_f32 v48, v48
    v_exp_f32 v49, v49
    v_exp_f32 v50, v50
    v_exp_f32 v51, v51
    v_exp_f32 v52, v52
    v_exp_f32 v53, v53
    v_exp_f32 v54, v54
    v_exp_f32 v55, v55
    v_exp_f32 v56, v56
    v_exp_f32 v57, v57
    v_exp_f32 v58, v58
    v_exp_f32 v59, v59
    v_exp_f32 v60, v60
    v_exp_f32 v61, v61
    v_exp_f32_e64 v62, v62
    v_exp_f32 v63, v63
    s_nop 0
    v_cvt_pk_bf16_f32 v104, v48, v49
    v_cvt_pk_bf16_f32 v105, v50, v51
    v_cvt_pk_bf16_f32 v106, v52, v53
    v_cvt_pk_bf16_f32 v107, v54, v55
    v_cvt_pk_bf16_f32 v108, v56, v57
    v_cvt_pk_bf16_f32 v109, v58, v59
    v_cvt_pk_bf16_f32 v110, v60, v61
    v_cvt_pk_bf16_f32 v111, v62, v63
    s_nop 1
    s_waitcnt lgkmcnt(0)
    v_mfma_f32_32x32x16_bf16 v[112:127], v[152:155], v[104:107], v[112:127]
    v_mfma_f32_32x32x16_bf16 v[112:127], v[156:159], v[108:111], v[112:127]
    s_nop 7
    s_nop 3
    v_mov_b32_e64 v240, v124
    v_mov_b32 v241, v124
    s_nop 1
    v_permlane32_swap_b32 v240, v241
    s_waitcnt lgkmcnt(0)
    s_branch L_norm
Lslow_19:
    s_mov_b32 s97, 0
Lspin_32:
    buffer_load_dword v247, v26, s[28:31], 0 offen sc1
    s_add_u32 s97, s97, 1
    s_waitcnt vmcnt(0)
    v_cmp_ne_u32 vcc, v247, v255
    s_and_b64 vcc, vcc, s[78:79]
    s_cmp_lt_u32 s97, 200000
    s_cselect_b64 vcc, vcc, 0
    s_cbranch_vccnz Lspin_32
    s_branch Lback_20
Lslow_21:
    v_lshrrev_b32 v88, 4, v7
    v_and_b32 v89, 3, v88
    v_lshrrev_b32 v90, 2, v88
    v_lshlrev_b32_e64 v90, 9, v90
    v_lshl_add_u32 v90, v89, 2, v90
    v_add_u32_e64 v90, s45, v90
    v_cmp_gt_u32 s[64:65], 8, v88
    v_mov_b32 v89, 2146435072
    s_nop 0
    v_cndmask_b32 v90, v89, v90, s[64:65]
    s_mov_b32 s97, 0
Lspin_33:
    buffer_load_dword v91, v90, s[28:31], 0 offen sc1
    s_add_u32 s97, s97, 1
    s_waitcnt vmcnt(0)
    v_cmp_ne_u32 vcc, v91, v255
    s_and_b64 vcc, vcc, s[64:65]
    s_cmp_lt_u32 s97, 200000
    s_cselect_b64 vcc, vcc, 0
    s_cbranch_vccnz Lspin_33
    s_branch Lback_22
L_exit:
    s_endpgm
L_codeend:
.section .rodata,"a"
.p2align 6
.amdhsa_kernel parallel_sum__sliding_block__glu_gated_bilinear__prompt_kernel
  .amdhsa_next_free_vgpr 512
  .amdhsa_next_free_sgpr 102
  .amdhsa_accum_offset 256
  .amdhsa_group_segment_fixed_size 0
  .amdhsa_kernarg_size 80
  .amdhsa_user_sgpr_count 2
  .amdhsa_user_sgpr_kernarg_segment_ptr 1
  .amdhsa_system_sgpr_workgroup_id_x 1
  .amdhsa_float_denorm_mode_32 3
.end_amdhsa_kernel
```
